```python
import torch

def _softmax(x, axis=-1):
    return torch.softmax(x, dim=axis)

def _gelu(x):
    return torch.nn.functional.gelu(x, approximate='tanh')

def _silu(x):
    return torch.nn.functional.silu(x)

def _sigmoid(x):
    return torch.sigmoid(x)

def _layernorm(x, axis=-1, eps=1e-05):
    m = x.mean(dim=axis, keepdim=True)
    v = x.var(dim=axis, keepdim=True, unbiased=False)
    return (x - m) / torch.sqrt(v + eps)

def _scatter_add(tgt, idx, src, axis=0):
    return tgt.clone().index_add_(axis, idx, src)

def _segment_sum(src, seg, n):
    out = torch.zeros((n,) + src.shape[1:], dtype=src.dtype)
    return out.index_add_(0, seg, src)

def _pad(x, pw):
    flat = tuple((v for pair in reversed(pw) for v in pair))
    return torch.nn.functional.pad(x, flat)
kernel_name = 'standalone__autoregressive_conv_wavernn__speech'

def setup_inputs():

    _w = lambda a: (lambda t: t.to(torch.bfloat16) if t.is_floating_point() else t)(torch.as_tensor(a))
    B, T, D, K = (2, 1000, 256, 31)
    return {'x': _w((lambda *s: torch.randn(*s, dtype=torch.bfloat16) * 0.05)(B, T, D)), 'w': _w((lambda *s: torch.randn(*s, dtype=torch.bfloat16) * 0.05)(K, D, 2 * D))}

def reference(x, w):
    B, T, D = x.shape
    K = w.shape[0]
    dil = 2
    pad = (K - 1) * dil
    xp = _pad(x, ((0, 0), (pad, 0), (0, 0)))
    h = torch.einsum('btd,de->bte', xp[:, 0:T, :], w[0])
    for i in range(1, K):
        h = h + torch.einsum('btd,de->bte', xp[:, i * dil:i * dil + T, :], w[i])
    f, g = (h[..., :D].clone(), h[..., D:].clone())
    return torch.tanh(f) * _sigmoid(g)
```

```asm
; @launch grid=(256,1,1) block=(512,1,1) lds=163840
.amdgcn_target "amdgcn-amd-amdhsa--gfx950"
.text
.globl standalone__autoregressive_conv_wavernn__speech_kernel
.p2align 8
.type standalone__autoregressive_conv_wavernn__speech_kernel,@function
standalone__autoregressive_conv_wavernn__speech_kernel:
s_load_dwordx8 s[4:11], s[0:1], 0
s_load_dwordx2 s[12:13], s[0:1], 32
s_cmp_ge_u32 s2, 256
s_cbranch_scc1 L_end
s_getpc_b64 s[14:15]
L_pc:
v_lshrrev_b32 v48, 6, v0
v_and_b32 v1, 63, v0
v_readfirstlane_b32 s32, v48
s_bfe_u32 s40, s2, 262147
s_lshl_b32 s40, s40, 7
v_mul_u32_u24 v49, 2048, v0
v_add_u32 v49, s40, v49
v_cmp_gt_u32 vcc, (L_codeend-L_pc-4), v49
s_and_saveexec_b64 s[50:51], vcc
s_cbranch_execz L_nocpf
global_load_dword v0, v49, s[14:15]
L_nocpf:
s_mov_b64 exec, -1
s_and_b32 s33, s2, 1
s_lshr_b32 s36, s2, 4
s_and_b32 s42, s32, 3
v_lshrrev_b32 v48, 3, v1
v_and_b32 v51, 7, v1
s_bfe_u32 s40, s2, 0x20004
s_lshl_b32 s40, s40, 7
s_add_i32 s40, s40, s42
s_lshl_b32 s40, s40, 10
s_bfe_u32 s48, s2, 0x10006
s_lshl_b32 s41, s48, 1
s_or_b32 s41, s41, s33
s_lshl_b32 s41, s41, 8
s_add_i32 s40, s40, s41
s_add_i32 s40, s40, -30720
v_and_b32 v49, 6, v48
v_xor_b32 v49, v49, v51
v_lshl_add_u32 v49, v49, 4, s40
v_lshl_add_u32 v56, v48, 13, v49
s_bfe_u32 s47, s2, 0x30001
s_lshl_b32 s47, s47, 7
s_lshl_b32 s41, s33, 17
s_or_b32 s47, s47, s41
s_lshl_b32 s41, s32, 2
v_and_b32 v49, 2, v48
v_and_or_b32 v49, s41, 4, v49
v_xor_b32 v49, v49, v51
s_lshl_b32 s41, s42, 13
s_add_u32 s41, s41, s47
v_lshl_add_u32 v49, v49, 4, s41
v_lshl_add_u32 v57, v48, 10, v49
v_lshl_add_u32 v58, v1, 10, s47
s_lshr_b32 s49, s2, 7
s_mul_i32 s49, s49, 512000
s_mul_i32 s43, s42, 2560
s_mov_b32 s18, 512000
s_mov_b32 s19, 0x20000
s_mov_b32 s22, 8126464
s_mov_b32 s23, 0x20000
s_lshl_b32 s45, s42, 10
s_add_u32 s45, s45, 40960
s_lshl_b32 s54, s36, 18
s_cmp_ge_u32 s32, 4
s_cbranch_scc1 L_hinit
v_add_u32 v52, 65536, v56
v_add_u32 v53, 4096, v56
v_add_u32 v54, 69632, v56
s_mov_b32 m0, s45
s_waitcnt lgkmcnt(0)
s_mov_b32 s20, s6
s_mov_b32 s21, s7
s_add_u32 s16, s4, s49
s_addc_u32 s17, s5, 0
s_cmp_ge_u32 s32, 1
s_cbranch_scc1 L_nog0
s_mov_b32 exec_hi, 0
buffer_load_dword v0, v58, s[20:23], s54 offen
s_mov_b64 exec, -1
L_nog0:
buffer_load_dwordx4 v57, s[20:23], 0 offen lds
s_add_u32 m0, s43, 0
s_nop 0
buffer_load_dwordx4 v56, s[16:19], 0 offen lds
s_add_u32 m0, s43, 1024
s_nop 0
buffer_load_dwordx4 v52, s[16:19], 0 offen lds
s_add_u32 m0, s45, 4096
s_mov_b32 s46, 262144
buffer_load_dwordx4 v57, s[20:23], s46 offen lds
s_add_u32 m0, s43, 10240
s_nop 0
buffer_load_dwordx4 v53, s[16:19], 0 offen lds
s_add_u32 m0, s43, 11264
s_nop 0
buffer_load_dwordx4 v54, s[16:19], 0 offen lds
s_branch L_join
L_ret:
s_setpc_b64 s[50:51]
L_hinit:
v_add_u32 v52, 131072, v56
v_add_u32 v53, 135168, v56
s_waitcnt lgkmcnt(0)
s_mov_b32 s20, s6
s_mov_b32 s21, s7
s_add_u32 s16, s4, s49
s_addc_u32 s17, s5, 0
s_add_u32 m0, s45, 8192
s_mov_b32 s46, 524288
buffer_load_dwordx4 v57, s[20:23], s46 offen lds
s_add_u32 m0, s43, 2048
s_mov_b32 exec_hi, 0
buffer_load_dwordx4 v52, s[16:19], 0 offen lds
s_mov_b64 exec, -1
s_add_u32 m0, s45, 12288
s_mov_b32 s46, 786432
buffer_load_dwordx4 v57, s[20:23], s46 offen lds
s_add_u32 m0, s43, 12288
s_mov_b32 exec_hi, 0
buffer_load_dwordx4 v53, s[16:19], 0 offen lds
s_mov_b64 exec, -1
L_join:
s_bfe_u32 s34, s2, 0x20001
s_bfe_u32 s35, s2, 0x10003
s_lshl_b32 s37, s35, 1
s_or_b32 s37, s37, s33
s_lshl_b32 s38, s36, 2
s_or_b32 s38, s38, s34
s_mul_i32 s44, s38, 49408
s_lshl_b32 s40, s42, 10
s_add_u32 s44, s44, s40
v_lshlrev_b32 v14, 4, v1
s_cmp_ge_u32 s32, 4
s_cbranch_scc1 L_helper
s_setprio 2
v_and_b32 v51, 15, v1
v_lshrrev_b32 v52, 4, v1
v_add_u32 v50, 0, v51
v_and_b32 v2, 6, v50
v_xor_b32 v2, v2, v52
v_lshlrev_b32 v2, 4, v2
v_lshl_add_u32 v2, v50, 7, v2
v_xor_b32 v3, 64, v2
v_add_u32 v50, 1, v51
v_and_b32 v4, 6, v50
v_xor_b32 v4, v4, v52
v_lshlrev_b32 v4, 4, v4
v_lshl_add_u32 v4, v50, 7, v4
v_xor_b32 v5, 64, v4
v_add_u32 v50, 2, v51
v_and_b32 v6, 6, v50
v_xor_b32 v6, v6, v52
v_lshlrev_b32 v6, 4, v6
v_lshl_add_u32 v6, v50, 7, v6
v_xor_b32 v7, 64, v6
v_add_u32 v50, 3, v51
v_and_b32 v8, 6, v50
v_xor_b32 v8, v8, v52
v_lshlrev_b32 v8, 4, v8
v_lshl_add_u32 v8, v50, 7, v8
v_xor_b32 v9, 64, v8
v_add_u32 v50, 4, v51
v_and_b32 v10, 6, v50
v_xor_b32 v10, v10, v52
v_lshlrev_b32 v10, 4, v10
v_lshl_add_u32 v10, v50, 7, v10
v_xor_b32 v11, 64, v10
v_bfe_u32 v50, v1, 2, 2
v_lshl_add_u32 v12, v52, 3, v50
v_lshlrev_b32 v12, 7, v12
v_lshrrev_b32 v50, 1, v50
v_and_b32 v13, 1, v52
v_lshl_or_b32 v50, v13, 1, v50
v_xor_b32 v50, s32, v50
v_lshl_add_u32 v12, v50, 5, v12
v_and_b32 v50, 3, v1
v_lshl_add_u32 v12, v50, 3, v12
v_add_u32 v12, 40960, v12
v_add_u32 v13, 0x10000, v12
s_and_b32 s40, s36, 3
s_lshl_b32 s40, s40, 7
s_lshl_b32 s42, s37, 1
s_add_u32 s40, s40, s42
s_lshl_b32 s40, s40, 1
s_add_u32 s40, s40, s48
s_lshl_b32 s40, s40, 9
s_lshl_b32 s42, s34, 7
s_add_u32 s40, s40, s42
s_lshl_b32 s42, s32, 5
s_add_u32 s40, s40, s42
v_lshlrev_b32 v15, 13, v51
v_lshl_add_u32 v15, v52, 3, v15
v_add_u32 v15, s40, v15
s_lshl_b32 s42, s32, 12
v_add_u32 v1, s42, v14
s_mov_b32 s45, 0x4038aa3b
s_mov_b32 s46, 0xbfb8aa3b
v_mov_b32 v16, 0
v_mov_b32 v17, 0
v_mov_b32 v18, 0
v_mov_b32 v19, 0
v_mov_b32 v20, 0
v_mov_b32 v21, 0
v_mov_b32 v22, 0
v_mov_b32 v23, 0
v_mov_b32 v24, 0
v_mov_b32 v25, 0
v_mov_b32 v26, 0
v_mov_b32 v27, 0
v_mov_b32 v28, 0
v_mov_b32 v29, 0
v_mov_b32 v30, 0
v_mov_b32 v31, 0
v_mov_b32 v32, 0
v_mov_b32 v33, 0
v_mov_b32 v34, 0
v_mov_b32 v35, 0
v_mov_b32 v36, 0
v_mov_b32 v37, 0
v_mov_b32 v38, 0
v_mov_b32 v39, 0
v_mov_b32 v40, 0
v_mov_b32 v41, 0
v_mov_b32 v42, 0
v_mov_b32 v43, 0
v_mov_b32 v44, 0
v_mov_b32 v45, 0
v_mov_b32 v46, 0
v_mov_b32 v47, 0
s_add_u32 s24, s8, s49
s_addc_u32 s25, s9, 0
s_mov_b32 s26, 512000
s_mov_b32 s27, 0x20000
s_mov_b32 s28, s12
s_mov_b32 s29, s13
s_mov_b32 s30, 0x10000000
s_mov_b32 s31, 0x20000
s_cmp_eq_u32 0, 1
s_waitcnt vmcnt(0)
s_barrier
ds_read_b64_tr_b16 v[48:49], v12 offset:0
ds_read_b64_tr_b16 v[50:51], v12 offset:512
ds_read_b128 v[52:55], v2 offset:0
ds_read_b64_tr_b16 v[56:57], v12 offset:4096
ds_read_b64_tr_b16 v[58:59], v12 offset:4608
ds_read_b128 v[60:63], v2 offset:2560
ds_read_b128 v[64:67], v2 offset:5120
ds_read_b128 v[68:71], v2 offset:7680
ds_read_b128 v[72:75], v2 offset:10240
ds_read_b128 v[76:79], v2 offset:12800
ds_read_b128 v[80:83], v2 offset:15360
ds_read_b128 v[84:87], v2 offset:17920
s_waitcnt lgkmcnt(9)
v_mfma_f32_16x16x32_bf16 v[16:19], v[48:51], v[52:55], v[16:19]
s_waitcnt lgkmcnt(6)
v_mfma_f32_16x16x32_bf16 v[16:19], v[56:59], v[60:63], v[16:19]
v_mfma_f32_16x16x32_bf16 v[20:23], v[48:51], v[60:63], v[20:23]
s_waitcnt lgkmcnt(5)
v_mfma_f32_16x16x32_bf16 v[20:23], v[56:59], v[64:67], v[20:23]
v_mfma_f32_16x16x32_bf16 v[24:27], v[48:51], v[64:67], v[24:27]
s_waitcnt lgkmcnt(4)
v_mfma_f32_16x16x32_bf16 v[24:27], v[56:59], v[68:71], v[24:27]
v_mfma_f32_16x16x32_bf16 v[28:31], v[48:51], v[68:71], v[28:31]
s_waitcnt lgkmcnt(3)
v_mfma_f32_16x16x32_bf16 v[28:31], v[56:59], v[72:75], v[28:31]
v_mfma_f32_16x16x32_bf16 v[32:35], v[48:51], v[72:75], v[32:35]
s_barrier
ds_read_b128 v[52:55], v4 offset:0
s_waitcnt lgkmcnt(3)
v_mfma_f32_16x16x32_bf16 v[32:35], v[56:59], v[76:79], v[32:35]
ds_read_b64_tr_b16 v[60:61], v12 offset:8192
v_mfma_f32_16x16x32_bf16 v[36:39], v[48:51], v[76:79], v[36:39]
ds_read_b64_tr_b16 v[62:63], v12 offset:8704
s_waitcnt lgkmcnt(4)
v_mfma_f32_16x16x32_bf16 v[36:39], v[56:59], v[80:83], v[36:39]
ds_read_b64_tr_b16 v[88:89], v12 offset:12288
v_mfma_f32_16x16x32_bf16 v[40:43], v[48:51], v[80:83], v[40:43]
ds_read_b64_tr_b16 v[90:91], v12 offset:12800
s_waitcnt lgkmcnt(5)
v_mfma_f32_16x16x32_bf16 v[40:43], v[56:59], v[84:87], v[40:43]
v_mfma_f32_16x16x32_bf16 v[44:47], v[48:51], v[84:87], v[44:47]
s_waitcnt lgkmcnt(4)
v_mfma_f32_16x16x32_bf16 v[44:47], v[56:59], v[52:55], v[44:47]
ds_read_b128 v[48:51], v4 offset:2560
s_waitcnt lgkmcnt(3)
v_mfma_f32_16x16x32_bf16 v[16:19], v[60:63], v[64:67], v[16:19]
s_waitcnt lgkmcnt(1)
v_mfma_f32_16x16x32_bf16 v[16:19], v[88:91], v[68:71], v[16:19]
ds_read_b128 v[56:59], v4 offset:5120
v_mfma_f32_16x16x32_bf16 v[20:23], v[60:63], v[68:71], v[20:23]
s_barrier
ds_read_b64_tr_b16 v[64:65], v12 offset:16384
v_mfma_f32_16x16x32_bf16 v[20:23], v[88:91], v[72:75], v[20:23]
ds_read_b64_tr_b16 v[66:67], v12 offset:16896
v_mfma_f32_16x16x32_bf16 v[24:27], v[60:63], v[72:75], v[24:27]
ds_read_b64_tr_b16 v[68:69], v12 offset:20480
v_mfma_f32_16x16x32_bf16 v[24:27], v[88:91], v[76:79], v[24:27]
ds_read_b64_tr_b16 v[70:71], v12 offset:20992
v_mfma_f32_16x16x32_bf16 v[28:31], v[60:63], v[76:79], v[28:31]
v_mfma_f32_16x16x32_bf16 v[28:31], v[88:91], v[80:83], v[28:31]
v_mfma_f32_16x16x32_bf16 v[32:35], v[60:63], v[80:83], v[32:35]
v_mfma_f32_16x16x32_bf16 v[32:35], v[88:91], v[84:87], v[32:35]
v_mfma_f32_16x16x32_bf16 v[36:39], v[60:63], v[84:87], v[36:39]
v_mfma_f32_16x16x32_bf16 v[36:39], v[88:91], v[52:55], v[36:39]
v_mfma_f32_16x16x32_bf16 v[40:43], v[60:63], v[52:55], v[40:43]
s_waitcnt lgkmcnt(5)
v_mfma_f32_16x16x32_bf16 v[40:43], v[88:91], v[48:51], v[40:43]
v_mfma_f32_16x16x32_bf16 v[44:47], v[60:63], v[48:51], v[44:47]
s_waitcnt lgkmcnt(4)
v_mfma_f32_16x16x32_bf16 v[44:47], v[88:91], v[56:59], v[44:47]
ds_read_b128 v[60:63], v4 offset:7680
s_waitcnt lgkmcnt(3)
v_mfma_f32_16x16x32_bf16 v[16:19], v[64:67], v[72:75], v[16:19]
s_waitcnt lgkmcnt(1)
v_mfma_f32_16x16x32_bf16 v[16:19], v[68:71], v[76:79], v[16:19]
ds_read_b128 v[72:75], v4 offset:10240
v_mfma_f32_16x16x32_bf16 v[20:23], v[64:67], v[76:79], v[20:23]
ds_read_b64_tr_b16 v[76:77], v12 offset:24576
v_mfma_f32_16x16x32_bf16 v[20:23], v[68:71], v[80:83], v[20:23]
ds_read_b64_tr_b16 v[78:79], v12 offset:25088
v_mfma_f32_16x16x32_bf16 v[24:27], v[64:67], v[80:83], v[24:27]
ds_read_b64_tr_b16 v[88:89], v12 offset:28672
v_mfma_f32_16x16x32_bf16 v[24:27], v[68:71], v[84:87], v[24:27]
ds_read_b64_tr_b16 v[90:91], v12 offset:29184
v_mfma_f32_16x16x32_bf16 v[28:31], v[64:67], v[84:87], v[28:31]
v_mfma_f32_16x16x32_bf16 v[28:31], v[68:71], v[52:55], v[28:31]
v_mfma_f32_16x16x32_bf16 v[32:35], v[64:67], v[52:55], v[32:35]
v_mfma_f32_16x16x32_bf16 v[32:35], v[68:71], v[48:51], v[32:35]
v_mfma_f32_16x16x32_bf16 v[36:39], v[64:67], v[48:51], v[36:39]
v_mfma_f32_16x16x32_bf16 v[36:39], v[68:71], v[56:59], v[36:39]
v_mfma_f32_16x16x32_bf16 v[40:43], v[64:67], v[56:59], v[40:43]
s_waitcnt lgkmcnt(5)
v_mfma_f32_16x16x32_bf16 v[40:43], v[68:71], v[60:63], v[40:43]
v_mfma_f32_16x16x32_bf16 v[44:47], v[64:67], v[60:63], v[44:47]
s_waitcnt lgkmcnt(4)
v_mfma_f32_16x16x32_bf16 v[44:47], v[68:71], v[72:75], v[44:47]
ds_read_b128 v[64:67], v4 offset:12800
s_waitcnt lgkmcnt(3)
v_mfma_f32_16x16x32_bf16 v[16:19], v[76:79], v[80:83], v[16:19]
s_waitcnt lgkmcnt(1)
v_mfma_f32_16x16x32_bf16 v[16:19], v[88:91], v[84:87], v[16:19]
ds_read_b128 v[68:71], v4 offset:15360
v_mfma_f32_16x16x32_bf16 v[20:23], v[76:79], v[84:87], v[20:23]
s_barrier
ds_read_b64_tr_b16 v[80:81], v12 offset:32768
v_mfma_f32_16x16x32_bf16 v[20:23], v[88:91], v[52:55], v[20:23]
ds_read_b64_tr_b16 v[82:83], v12 offset:33280
v_mfma_f32_16x16x32_bf16 v[24:27], v[76:79], v[52:55], v[24:27]
ds_read_b64_tr_b16 v[84:85], v12 offset:36864
v_mfma_f32_16x16x32_bf16 v[24:27], v[88:91], v[48:51], v[24:27]
ds_read_b64_tr_b16 v[86:87], v12 offset:37376
v_mfma_f32_16x16x32_bf16 v[28:31], v[76:79], v[48:51], v[28:31]
v_mfma_f32_16x16x32_bf16 v[28:31], v[88:91], v[56:59], v[28:31]
v_mfma_f32_16x16x32_bf16 v[32:35], v[76:79], v[56:59], v[32:35]
v_mfma_f32_16x16x32_bf16 v[32:35], v[88:91], v[60:63], v[32:35]
v_mfma_f32_16x16x32_bf16 v[36:39], v[76:79], v[60:63], v[36:39]
v_mfma_f32_16x16x32_bf16 v[36:39], v[88:91], v[72:75], v[36:39]
v_mfma_f32_16x16x32_bf16 v[40:43], v[76:79], v[72:75], v[40:43]
s_waitcnt lgkmcnt(5)
v_mfma_f32_16x16x32_bf16 v[40:43], v[88:91], v[64:67], v[40:43]
v_mfma_f32_16x16x32_bf16 v[44:47], v[76:79], v[64:67], v[44:47]
s_waitcnt lgkmcnt(4)
v_mfma_f32_16x16x32_bf16 v[44:47], v[88:91], v[68:71], v[44:47]
ds_read_b128 v[76:79], v4 offset:17920
s_waitcnt lgkmcnt(3)
v_mfma_f32_16x16x32_bf16 v[16:19], v[80:83], v[52:55], v[16:19]
s_waitcnt lgkmcnt(1)
v_mfma_f32_16x16x32_bf16 v[16:19], v[84:87], v[48:51], v[16:19]
ds_read_b128 v[52:55], v6 offset:0
v_mfma_f32_16x16x32_bf16 v[20:23], v[80:83], v[48:51], v[20:23]
ds_read_b64_tr_b16 v[48:49], v12 offset:40960
v_mfma_f32_16x16x32_bf16 v[20:23], v[84:87], v[56:59], v[20:23]
ds_read_b64_tr_b16 v[50:51], v12 offset:41472
v_mfma_f32_16x16x32_bf16 v[24:27], v[80:83], v[56:59], v[24:27]
ds_read_b64_tr_b16 v[88:89], v12 offset:45056
v_mfma_f32_16x16x32_bf16 v[24:27], v[84:87], v[60:63], v[24:27]
ds_read_b64_tr_b16 v[90:91], v12 offset:45568
v_mfma_f32_16x16x32_bf16 v[28:31], v[80:83], v[60:63], v[28:31]
v_mfma_f32_16x16x32_bf16 v[28:31], v[84:87], v[72:75], v[28:31]
v_mfma_f32_16x16x32_bf16 v[32:35], v[80:83], v[72:75], v[32:35]
v_mfma_f32_16x16x32_bf16 v[32:35], v[84:87], v[64:67], v[32:35]
v_mfma_f32_16x16x32_bf16 v[36:39], v[80:83], v[64:67], v[36:39]
v_mfma_f32_16x16x32_bf16 v[36:39], v[84:87], v[68:71], v[36:39]
v_mfma_f32_16x16x32_bf16 v[40:43], v[80:83], v[68:71], v[40:43]
s_waitcnt lgkmcnt(5)
v_mfma_f32_16x16x32_bf16 v[40:43], v[84:87], v[76:79], v[40:43]
v_mfma_f32_16x16x32_bf16 v[44:47], v[80:83], v[76:79], v[44:47]
s_waitcnt lgkmcnt(4)
v_mfma_f32_16x16x32_bf16 v[44:47], v[84:87], v[52:55], v[44:47]
ds_read_b128 v[80:83], v6 offset:2560
s_waitcnt lgkmcnt(3)
v_mfma_f32_16x16x32_bf16 v[16:19], v[48:51], v[56:59], v[16:19]
s_waitcnt lgkmcnt(1)
v_mfma_f32_16x16x32_bf16 v[16:19], v[88:91], v[60:63], v[16:19]
ds_read_b128 v[56:59], v6 offset:5120
v_mfma_f32_16x16x32_bf16 v[20:23], v[48:51], v[60:63], v[20:23]
s_barrier
ds_read_b64_tr_b16 v[60:61], v12 offset:49152
v_mfma_f32_16x16x32_bf16 v[20:23], v[88:91], v[72:75], v[20:23]
ds_read_b64_tr_b16 v[62:63], v12 offset:49664
v_mfma_f32_16x16x32_bf16 v[24:27], v[48:51], v[72:75], v[24:27]
ds_read_b64_tr_b16 v[84:85], v12 offset:53248
v_mfma_f32_16x16x32_bf16 v[24:27], v[88:91], v[64:67], v[24:27]
ds_read_b64_tr_b16 v[86:87], v12 offset:53760
v_mfma_f32_16x16x32_bf16 v[28:31], v[48:51], v[64:67], v[28:31]
v_mfma_f32_16x16x32_bf16 v[28:31], v[88:91], v[68:71], v[28:31]
v_mfma_f32_16x16x32_bf16 v[32:35], v[48:51], v[68:71], v[32:35]
v_mfma_f32_16x16x32_bf16 v[32:35], v[88:91], v[76:79], v[32:35]
v_mfma_f32_16x16x32_bf16 v[36:39], v[48:51], v[76:79], v[36:39]
v_mfma_f32_16x16x32_bf16 v[36:39], v[88:91], v[52:55], v[36:39]
v_mfma_f32_16x16x32_bf16 v[40:43], v[48:51], v[52:55], v[40:43]
s_waitcnt lgkmcnt(5)
v_mfma_f32_16x16x32_bf16 v[40:43], v[88:91], v[80:83], v[40:43]
v_mfma_f32_16x16x32_bf16 v[44:47], v[48:51], v[80:83], v[44:47]
s_waitcnt lgkmcnt(4)
v_mfma_f32_16x16x32_bf16 v[44:47], v[88:91], v[56:59], v[44:47]
ds_read_b128 v[48:51], v6 offset:7680
s_waitcnt lgkmcnt(3)
v_mfma_f32_16x16x32_bf16 v[16:19], v[60:63], v[72:75], v[16:19]
s_waitcnt lgkmcnt(1)
v_mfma_f32_16x16x32_bf16 v[16:19], v[84:87], v[64:67], v[16:19]
ds_read_b128 v[72:75], v6 offset:10240
v_mfma_f32_16x16x32_bf16 v[20:23], v[60:63], v[64:67], v[20:23]
ds_read_b64_tr_b16 v[64:65], v12 offset:57344
v_mfma_f32_16x16x32_bf16 v[20:23], v[84:87], v[68:71], v[20:23]
ds_read_b64_tr_b16 v[66:67], v12 offset:57856
v_mfma_f32_16x16x32_bf16 v[24:27], v[60:63], v[68:71], v[24:27]
ds_read_b64_tr_b16 v[88:89], v12 offset:61440
v_mfma_f32_16x16x32_bf16 v[24:27], v[84:87], v[76:79], v[24:27]
ds_read_b64_tr_b16 v[90:91], v12 offset:61952
v_mfma_f32_16x16x32_bf16 v[28:31], v[60:63], v[76:79], v[28:31]
v_mfma_f32_16x16x32_bf16 v[28:31], v[84:87], v[52:55], v[28:31]
v_mfma_f32_16x16x32_bf16 v[32:35], v[60:63], v[52:55], v[32:35]
v_mfma_f32_16x16x32_bf16 v[32:35], v[84:87], v[80:83], v[32:35]
v_mfma_f32_16x16x32_bf16 v[36:39], v[60:63], v[80:83], v[36:39]
v_mfma_f32_16x16x32_bf16 v[36:39], v[84:87], v[56:59], v[36:39]
v_mfma_f32_16x16x32_bf16 v[40:43], v[60:63], v[56:59], v[40:43]
s_waitcnt lgkmcnt(5)
v_mfma_f32_16x16x32_bf16 v[40:43], v[84:87], v[48:51], v[40:43]
v_mfma_f32_16x16x32_bf16 v[44:47], v[60:63], v[48:51], v[44:47]
s_waitcnt lgkmcnt(4)
v_mfma_f32_16x16x32_bf16 v[44:47], v[84:87], v[72:75], v[44:47]
ds_read_b128 v[60:63], v6 offset:12800
s_waitcnt lgkmcnt(3)
v_mfma_f32_16x16x32_bf16 v[16:19], v[64:67], v[68:71], v[16:19]
s_waitcnt lgkmcnt(1)
v_mfma_f32_16x16x32_bf16 v[16:19], v[88:91], v[76:79], v[16:19]
ds_read_b128 v[68:71], v6 offset:15360
v_mfma_f32_16x16x32_bf16 v[20:23], v[64:67], v[76:79], v[20:23]
s_barrier
ds_read_b64_tr_b16 v[76:77], v13 offset:0
v_mfma_f32_16x16x32_bf16 v[20:23], v[88:91], v[52:55], v[20:23]
ds_read_b64_tr_b16 v[78:79], v13 offset:512
v_mfma_f32_16x16x32_bf16 v[24:27], v[64:67], v[52:55], v[24:27]
ds_read_b64_tr_b16 v[84:85], v13 offset:4096
v_mfma_f32_16x16x32_bf16 v[24:27], v[88:91], v[80:83], v[24:27]
ds_read_b64_tr_b16 v[86:87], v13 offset:4608
v_mfma_f32_16x16x32_bf16 v[28:31], v[64:67], v[80:83], v[28:31]
v_mfma_f32_16x16x32_bf16 v[28:31], v[88:91], v[56:59], v[28:31]
v_mfma_f32_16x16x32_bf16 v[32:35], v[64:67], v[56:59], v[32:35]
v_mfma_f32_16x16x32_bf16 v[32:35], v[88:91], v[48:51], v[32:35]
v_mfma_f32_16x16x32_bf16 v[36:39], v[64:67], v[48:51], v[36:39]
v_mfma_f32_16x16x32_bf16 v[36:39], v[88:91], v[72:75], v[36:39]
v_mfma_f32_16x16x32_bf16 v[40:43], v[64:67], v[72:75], v[40:43]
s_waitcnt lgkmcnt(5)
v_mfma_f32_16x16x32_bf16 v[40:43], v[88:91], v[60:63], v[40:43]
v_mfma_f32_16x16x32_bf16 v[44:47], v[64:67], v[60:63], v[44:47]
s_waitcnt lgkmcnt(4)
v_mfma_f32_16x16x32_bf16 v[44:47], v[88:91], v[68:71], v[44:47]
ds_read_b128 v[64:67], v6 offset:17920
s_waitcnt lgkmcnt(3)
v_mfma_f32_16x16x32_bf16 v[16:19], v[76:79], v[52:55], v[16:19]
s_waitcnt lgkmcnt(1)
v_mfma_f32_16x16x32_bf16 v[16:19], v[84:87], v[80:83], v[16:19]
ds_read_b128 v[52:55], v8 offset:0
v_mfma_f32_16x16x32_bf16 v[20:23], v[76:79], v[80:83], v[20:23]
ds_read_b64_tr_b16 v[80:81], v13 offset:8192
v_mfma_f32_16x16x32_bf16 v[20:23], v[84:87], v[56:59], v[20:23]
ds_read_b64_tr_b16 v[82:83], v13 offset:8704
v_mfma_f32_16x16x32_bf16 v[24:27], v[76:79], v[56:59], v[24:27]
ds_read_b64_tr_b16 v[88:89], v13 offset:12288
v_mfma_f32_16x16x32_bf16 v[24:27], v[84:87], v[48:51], v[24:27]
ds_read_b64_tr_b16 v[90:91], v13 offset:12800
v_mfma_f32_16x16x32_bf16 v[28:31], v[76:79], v[48:51], v[28:31]
v_mfma_f32_16x16x32_bf16 v[28:31], v[84:87], v[72:75], v[28:31]
v_mfma_f32_16x16x32_bf16 v[32:35], v[76:79], v[72:75], v[32:35]
v_mfma_f32_16x16x32_bf16 v[32:35], v[84:87], v[60:63], v[32:35]
v_mfma_f32_16x16x32_bf16 v[36:39], v[76:79], v[60:63], v[36:39]
v_mfma_f32_16x16x32_bf16 v[36:39], v[84:87], v[68:71], v[36:39]
v_mfma_f32_16x16x32_bf16 v[40:43], v[76:79], v[68:71], v[40:43]
s_waitcnt lgkmcnt(5)
v_mfma_f32_16x16x32_bf16 v[40:43], v[84:87], v[64:67], v[40:43]
v_mfma_f32_16x16x32_bf16 v[44:47], v[76:79], v[64:67], v[44:47]
s_waitcnt lgkmcnt(4)
v_mfma_f32_16x16x32_bf16 v[44:47], v[84:87], v[52:55], v[44:47]
ds_read_b128 v[76:79], v8 offset:2560
s_waitcnt lgkmcnt(3)
v_mfma_f32_16x16x32_bf16 v[16:19], v[80:83], v[56:59], v[16:19]
s_waitcnt lgkmcnt(1)
v_mfma_f32_16x16x32_bf16 v[16:19], v[88:91], v[48:51], v[16:19]
ds_read_b128 v[56:59], v8 offset:5120
v_mfma_f32_16x16x32_bf16 v[20:23], v[80:83], v[48:51], v[20:23]
s_barrier
ds_read_b64_tr_b16 v[48:49], v13 offset:16384
v_mfma_f32_16x16x32_bf16 v[20:23], v[88:91], v[72:75], v[20:23]
ds_read_b64_tr_b16 v[50:51], v13 offset:16896
v_mfma_f32_16x16x32_bf16 v[24:27], v[80:83], v[72:75], v[24:27]
ds_read_b64_tr_b16 v[84:85], v13 offset:20480
v_mfma_f32_16x16x32_bf16 v[24:27], v[88:91], v[60:63], v[24:27]
ds_read_b64_tr_b16 v[86:87], v13 offset:20992
v_mfma_f32_16x16x32_bf16 v[28:31], v[80:83], v[60:63], v[28:31]
v_mfma_f32_16x16x32_bf16 v[28:31], v[88:91], v[68:71], v[28:31]
v_mfma_f32_16x16x32_bf16 v[32:35], v[80:83], v[68:71], v[32:35]
v_mfma_f32_16x16x32_bf16 v[32:35], v[88:91], v[64:67], v[32:35]
v_mfma_f32_16x16x32_bf16 v[36:39], v[80:83], v[64:67], v[36:39]
v_mfma_f32_16x16x32_bf16 v[36:39], v[88:91], v[52:55], v[36:39]
v_mfma_f32_16x16x32_bf16 v[40:43], v[80:83], v[52:55], v[40:43]
s_waitcnt lgkmcnt(5)
v_mfma_f32_16x16x32_bf16 v[40:43], v[88:91], v[76:79], v[40:43]
v_mfma_f32_16x16x32_bf16 v[44:47], v[80:83], v[76:79], v[44:47]
s_waitcnt lgkmcnt(4)
v_mfma_f32_16x16x32_bf16 v[44:47], v[88:91], v[56:59], v[44:47]
ds_read_b128 v[80:83], v8 offset:7680
s_waitcnt lgkmcnt(3)
v_mfma_f32_16x16x32_bf16 v[16:19], v[48:51], v[72:75], v[16:19]
s_waitcnt lgkmcnt(1)
v_mfma_f32_16x16x32_bf16 v[16:19], v[84:87], v[60:63], v[16:19]
ds_read_b128 v[72:75], v8 offset:10240
v_mfma_f32_16x16x32_bf16 v[20:23], v[48:51], v[60:63], v[20:23]
ds_read_b64_tr_b16 v[60:61], v13 offset:24576
v_mfma_f32_16x16x32_bf16 v[20:23], v[84:87], v[68:71], v[20:23]
ds_read_b64_tr_b16 v[62:63], v13 offset:25088
v_mfma_f32_16x16x32_bf16 v[24:27], v[48:51], v[68:71], v[24:27]
ds_read_b64_tr_b16 v[88:89], v13 offset:28672
v_mfma_f32_16x16x32_bf16 v[24:27], v[84:87], v[64:67], v[24:27]
ds_read_b64_tr_b16 v[90:91], v13 offset:29184
v_mfma_f32_16x16x32_bf16 v[28:31], v[48:51], v[64:67], v[28:31]
v_mfma_f32_16x16x32_bf16 v[28:31], v[84:87], v[52:55], v[28:31]
v_mfma_f32_16x16x32_bf16 v[32:35], v[48:51], v[52:55], v[32:35]
v_mfma_f32_16x16x32_bf16 v[32:35], v[84:87], v[76:79], v[32:35]
v_mfma_f32_16x16x32_bf16 v[36:39], v[48:51], v[76:79], v[36:39]
v_mfma_f32_16x16x32_bf16 v[36:39], v[84:87], v[56:59], v[36:39]
v_mfma_f32_16x16x32_bf16 v[40:43], v[48:51], v[56:59], v[40:43]
s_waitcnt lgkmcnt(5)
v_mfma_f32_16x16x32_bf16 v[40:43], v[84:87], v[80:83], v[40:43]
v_mfma_f32_16x16x32_bf16 v[44:47], v[48:51], v[80:83], v[44:47]
s_waitcnt lgkmcnt(4)
v_mfma_f32_16x16x32_bf16 v[44:47], v[84:87], v[72:75], v[44:47]
ds_read_b128 v[48:51], v8 offset:12800
s_waitcnt lgkmcnt(3)
v_mfma_f32_16x16x32_bf16 v[16:19], v[60:63], v[68:71], v[16:19]
s_waitcnt lgkmcnt(1)
v_mfma_f32_16x16x32_bf16 v[16:19], v[88:91], v[64:67], v[16:19]
ds_read_b128 v[68:71], v8 offset:15360
v_mfma_f32_16x16x32_bf16 v[20:23], v[60:63], v[64:67], v[20:23]
s_barrier
ds_read_b64_tr_b16 v[64:65], v13 offset:32768
v_mfma_f32_16x16x32_bf16 v[20:23], v[88:91], v[52:55], v[20:23]
ds_read_b64_tr_b16 v[66:67], v13 offset:33280
v_mfma_f32_16x16x32_bf16 v[24:27], v[60:63], v[52:55], v[24:27]
ds_read_b64_tr_b16 v[84:85], v13 offset:36864
v_mfma_f32_16x16x32_bf16 v[24:27], v[88:91], v[76:79], v[24:27]
ds_read_b64_tr_b16 v[86:87], v13 offset:37376
v_mfma_f32_16x16x32_bf16 v[28:31], v[60:63], v[76:79], v[28:31]
v_mfma_f32_16x16x32_bf16 v[28:31], v[88:91], v[56:59], v[28:31]
v_mfma_f32_16x16x32_bf16 v[32:35], v[60:63], v[56:59], v[32:35]
v_mfma_f32_16x16x32_bf16 v[32:35], v[88:91], v[80:83], v[32:35]
v_mfma_f32_16x16x32_bf16 v[36:39], v[60:63], v[80:83], v[36:39]
v_mfma_f32_16x16x32_bf16 v[36:39], v[88:91], v[72:75], v[36:39]
ds_read_b128 v[92:95], v3 offset:0
v_mfma_f32_16x16x32_bf16 v[40:43], v[60:63], v[72:75], v[40:43]
s_waitcnt lgkmcnt(6)
v_mfma_f32_16x16x32_bf16 v[40:43], v[88:91], v[48:51], v[40:43]
v_mfma_f32_16x16x32_bf16 v[44:47], v[60:63], v[48:51], v[44:47]
s_waitcnt lgkmcnt(5)
v_mfma_f32_16x16x32_bf16 v[44:47], v[88:91], v[68:71], v[44:47]
ds_read_b128 v[60:63], v8 offset:17920
s_waitcnt lgkmcnt(4)
v_mfma_f32_16x16x32_bf16 v[16:19], v[64:67], v[52:55], v[16:19]
s_waitcnt lgkmcnt(2)
v_mfma_f32_16x16x32_bf16 v[16:19], v[84:87], v[76:79], v[16:19]
ds_read_b128 v[52:55], v10 offset:0
v_mfma_f32_16x16x32_bf16 v[20:23], v[64:67], v[76:79], v[20:23]
ds_read_b64_tr_b16 v[76:77], v13 offset:40960
v_mfma_f32_16x16x32_bf16 v[20:23], v[84:87], v[56:59], v[20:23]
ds_read_b64_tr_b16 v[78:79], v13 offset:41472
v_mfma_f32_16x16x32_bf16 v[24:27], v[64:67], v[56:59], v[24:27]
ds_read_b128 v[88:91], v3 offset:2560
v_mfma_f32_16x16x32_bf16 v[24:27], v[84:87], v[80:83], v[24:27]
ds_read_b64_tr_b16 v[96:97], v13 offset:45056
v_mfma_f32_16x16x32_bf16 v[28:31], v[64:67], v[80:83], v[28:31]
ds_read_b64_tr_b16 v[98:99], v13 offset:45568
v_mfma_f32_16x16x32_bf16 v[28:31], v[84:87], v[72:75], v[28:31]
v_mfma_f32_16x16x32_bf16 v[32:35], v[64:67], v[72:75], v[32:35]
v_mfma_f32_16x16x32_bf16 v[32:35], v[84:87], v[48:51], v[32:35]
ds_read_b128 v[100:103], v3 offset:5120
v_mfma_f32_16x16x32_bf16 v[36:39], v[64:67], v[48:51], v[36:39]
v_mfma_f32_16x16x32_bf16 v[36:39], v[84:87], v[68:71], v[36:39]
v_mfma_f32_16x16x32_bf16 v[40:43], v[64:67], v[68:71], v[40:43]
s_waitcnt lgkmcnt(7)
v_mfma_f32_16x16x32_bf16 v[40:43], v[84:87], v[60:63], v[40:43]
v_mfma_f32_16x16x32_bf16 v[44:47], v[64:67], v[60:63], v[44:47]
s_waitcnt lgkmcnt(6)
v_mfma_f32_16x16x32_bf16 v[44:47], v[84:87], v[52:55], v[44:47]
ds_read_b128 v[64:67], v10 offset:2560
s_waitcnt lgkmcnt(5)
v_mfma_f32_16x16x32_bf16 v[16:19], v[76:79], v[56:59], v[16:19]
ds_read_b128 v[56:59], v3 offset:7680
s_waitcnt lgkmcnt(3)
v_mfma_f32_16x16x32_bf16 v[16:19], v[96:99], v[80:83], v[16:19]
ds_read_b128 v[84:87], v10 offset:5120
v_mfma_f32_16x16x32_bf16 v[20:23], v[76:79], v[80:83], v[20:23]
s_barrier
ds_read_b64_tr_b16 v[80:81], v12 offset:0
v_mfma_f32_16x16x32_bf16 v[20:23], v[96:99], v[72:75], v[20:23]
ds_read_b64_tr_b16 v[82:83], v12 offset:512
v_mfma_f32_16x16x32_bf16 v[24:27], v[76:79], v[72:75], v[24:27]
ds_read_b64_tr_b16 v[104:105], v12 offset:4096
v_mfma_f32_16x16x32_bf16 v[24:27], v[96:99], v[48:51], v[24:27]
ds_read_b64_tr_b16 v[106:107], v12 offset:4608
v_mfma_f32_16x16x32_bf16 v[28:31], v[76:79], v[48:51], v[28:31]
v_mfma_f32_16x16x32_bf16 v[28:31], v[96:99], v[68:71], v[28:31]
ds_read_b128 v[108:111], v3 offset:10240
v_mfma_f32_16x16x32_bf16 v[32:35], v[76:79], v[68:71], v[32:35]
v_mfma_f32_16x16x32_bf16 v[32:35], v[96:99], v[60:63], v[32:35]
v_mfma_f32_16x16x32_bf16 v[36:39], v[76:79], v[60:63], v[36:39]
v_mfma_f32_16x16x32_bf16 v[36:39], v[96:99], v[52:55], v[36:39]
v_mfma_f32_16x16x32_bf16 v[40:43], v[76:79], v[52:55], v[40:43]
s_waitcnt lgkmcnt(7)
v_mfma_f32_16x16x32_bf16 v[40:43], v[96:99], v[64:67], v[40:43]
v_mfma_f32_16x16x32_bf16 v[44:47], v[76:79], v[64:67], v[44:47]
ds_read_b128 v[76:79], v3 offset:12800
s_waitcnt lgkmcnt(6)
v_mfma_f32_16x16x32_bf16 v[44:47], v[96:99], v[84:87], v[44:47]
ds_read_b128 v[96:99], v10 offset:7680
s_waitcnt lgkmcnt(5)
v_mfma_f32_16x16x32_bf16 v[16:19], v[80:83], v[72:75], v[16:19]
s_waitcnt lgkmcnt(3)
v_mfma_f32_16x16x32_bf16 v[16:19], v[104:107], v[48:51], v[16:19]
ds_read_b128 v[72:75], v10 offset:10240
v_mfma_f32_16x16x32_bf16 v[20:23], v[80:83], v[48:51], v[20:23]
ds_read_b64_tr_b16 v[48:49], v12 offset:8192
v_mfma_f32_16x16x32_bf16 v[20:23], v[104:107], v[68:71], v[20:23]
ds_read_b64_tr_b16 v[50:51], v12 offset:8704
v_mfma_f32_16x16x32_bf16 v[24:27], v[80:83], v[68:71], v[24:27]
ds_read_b64_tr_b16 v[112:113], v12 offset:12288
v_mfma_f32_16x16x32_bf16 v[24:27], v[104:107], v[60:63], v[24:27]
ds_read_b64_tr_b16 v[114:115], v12 offset:12800
v_mfma_f32_16x16x32_bf16 v[28:31], v[80:83], v[60:63], v[28:31]
ds_read_b128 v[116:119], v3 offset:15360
v_mfma_f32_16x16x32_bf16 v[28:31], v[104:107], v[52:55], v[28:31]
v_mfma_f32_16x16x32_bf16 v[32:35], v[80:83], v[52:55], v[32:35]
v_mfma_f32_16x16x32_bf16 v[32:35], v[104:107], v[64:67], v[32:35]
v_mfma_f32_16x16x32_bf16 v[36:39], v[80:83], v[64:67], v[36:39]
v_mfma_f32_16x16x32_bf16 v[36:39], v[104:107], v[84:87], v[36:39]
v_mfma_f32_16x16x32_bf16 v[40:43], v[80:83], v[84:87], v[40:43]
ds_read_b128 v[120:123], v3 offset:17920
s_waitcnt lgkmcnt(7)
v_mfma_f32_16x16x32_bf16 v[40:43], v[104:107], v[96:99], v[40:43]
v_mfma_f32_16x16x32_bf16 v[44:47], v[80:83], v[96:99], v[44:47]
s_waitcnt lgkmcnt(6)
v_mfma_f32_16x16x32_bf16 v[44:47], v[104:107], v[72:75], v[44:47]
s_waitcnt lgkmcnt(4)
v_mfma_f32_16x16x32_bf16 v[16:19], v[48:51], v[68:71], v[16:19]
ds_read_b128 v[68:71], v10 offset:12800
s_waitcnt lgkmcnt(3)
v_mfma_f32_16x16x32_bf16 v[16:19], v[112:115], v[92:95], v[16:19]
v_mfma_f32_16x16x32_bf16 v[20:23], v[48:51], v[60:63], v[20:23]
s_barrier
ds_read_b64_tr_b16 v[60:61], v12 offset:16384
v_mfma_f32_16x16x32_bf16 v[20:23], v[112:115], v[88:91], v[20:23]
ds_read_b64_tr_b16 v[62:63], v12 offset:16896
v_mfma_f32_16x16x32_bf16 v[24:27], v[48:51], v[52:55], v[24:27]
ds_read_b64_tr_b16 v[52:53], v12 offset:20480
v_mfma_f32_16x16x32_bf16 v[24:27], v[112:115], v[100:103], v[24:27]
ds_read_b64_tr_b16 v[54:55], v12 offset:20992
v_mfma_f32_16x16x32_bf16 v[28:31], v[48:51], v[64:67], v[28:31]
v_mfma_f32_16x16x32_bf16 v[28:31], v[112:115], v[56:59], v[28:31]
v_mfma_f32_16x16x32_bf16 v[32:35], v[48:51], v[84:87], v[32:35]
v_mfma_f32_16x16x32_bf16 v[32:35], v[112:115], v[108:111], v[32:35]
v_mfma_f32_16x16x32_bf16 v[36:39], v[48:51], v[96:99], v[36:39]
v_mfma_f32_16x16x32_bf16 v[36:39], v[112:115], v[76:79], v[36:39]
v_mfma_f32_16x16x32_bf16 v[40:43], v[48:51], v[72:75], v[40:43]
s_waitcnt lgkmcnt(6)
v_mfma_f32_16x16x32_bf16 v[40:43], v[112:115], v[116:119], v[40:43]
s_waitcnt lgkmcnt(4)
v_mfma_f32_16x16x32_bf16 v[44:47], v[48:51], v[68:71], v[44:47]
v_mfma_f32_16x16x32_bf16 v[44:47], v[112:115], v[120:123], v[44:47]
ds_read_b128 v[48:51], v5 offset:0
s_waitcnt lgkmcnt(3)
v_mfma_f32_16x16x32_bf16 v[16:19], v[60:63], v[88:91], v[16:19]
s_waitcnt lgkmcnt(1)
v_mfma_f32_16x16x32_bf16 v[16:19], v[52:55], v[100:103], v[16:19]
ds_read_b128 v[64:67], v5 offset:2560
v_mfma_f32_16x16x32_bf16 v[20:23], v[60:63], v[100:103], v[20:23]
ds_read_b64_tr_b16 v[68:69], v12 offset:24576
v_mfma_f32_16x16x32_bf16 v[20:23], v[52:55], v[56:59], v[20:23]
ds_read_b64_tr_b16 v[70:71], v12 offset:25088
v_mfma_f32_16x16x32_bf16 v[24:27], v[60:63], v[56:59], v[24:27]
ds_read_b64_tr_b16 v[72:73], v12 offset:28672
v_mfma_f32_16x16x32_bf16 v[24:27], v[52:55], v[108:111], v[24:27]
ds_read_b64_tr_b16 v[74:75], v12 offset:29184
v_mfma_f32_16x16x32_bf16 v[28:31], v[60:63], v[108:111], v[28:31]
v_mfma_f32_16x16x32_bf16 v[28:31], v[52:55], v[76:79], v[28:31]
v_mfma_f32_16x16x32_bf16 v[32:35], v[60:63], v[76:79], v[32:35]
v_mfma_f32_16x16x32_bf16 v[32:35], v[52:55], v[116:119], v[32:35]
v_mfma_f32_16x16x32_bf16 v[36:39], v[60:63], v[116:119], v[36:39]
v_mfma_f32_16x16x32_bf16 v[36:39], v[52:55], v[120:123], v[36:39]
v_mfma_f32_16x16x32_bf16 v[40:43], v[60:63], v[120:123], v[40:43]
s_waitcnt lgkmcnt(5)
v_mfma_f32_16x16x32_bf16 v[40:43], v[52:55], v[48:51], v[40:43]
v_mfma_f32_16x16x32_bf16 v[44:47], v[60:63], v[48:51], v[44:47]
s_waitcnt lgkmcnt(4)
v_mfma_f32_16x16x32_bf16 v[44:47], v[52:55], v[64:67], v[44:47]
ds_read_b128 v[52:55], v5 offset:5120
s_waitcnt lgkmcnt(3)
v_mfma_f32_16x16x32_bf16 v[16:19], v[68:71], v[56:59], v[16:19]
s_waitcnt lgkmcnt(1)
v_mfma_f32_16x16x32_bf16 v[16:19], v[72:75], v[108:111], v[16:19]
ds_read_b128 v[56:59], v5 offset:7680
v_mfma_f32_16x16x32_bf16 v[20:23], v[68:71], v[108:111], v[20:23]
s_barrier
ds_read_b64_tr_b16 v[60:61], v12 offset:32768
v_mfma_f32_16x16x32_bf16 v[20:23], v[72:75], v[76:79], v[20:23]
ds_read_b64_tr_b16 v[62:63], v12 offset:33280
v_mfma_f32_16x16x32_bf16 v[24:27], v[68:71], v[76:79], v[24:27]
ds_read_b64_tr_b16 v[80:81], v12 offset:36864
v_mfma_f32_16x16x32_bf16 v[24:27], v[72:75], v[116:119], v[24:27]
ds_read_b64_tr_b16 v[82:83], v12 offset:37376
v_mfma_f32_16x16x32_bf16 v[28:31], v[68:71], v[116:119], v[28:31]
v_mfma_f32_16x16x32_bf16 v[28:31], v[72:75], v[120:123], v[28:31]
v_mfma_f32_16x16x32_bf16 v[32:35], v[68:71], v[120:123], v[32:35]
v_mfma_f32_16x16x32_bf16 v[32:35], v[72:75], v[48:51], v[32:35]
v_mfma_f32_16x16x32_bf16 v[36:39], v[68:71], v[48:51], v[36:39]
v_mfma_f32_16x16x32_bf16 v[36:39], v[72:75], v[64:67], v[36:39]
v_mfma_f32_16x16x32_bf16 v[40:43], v[68:71], v[64:67], v[40:43]
s_waitcnt lgkmcnt(5)
v_mfma_f32_16x16x32_bf16 v[40:43], v[72:75], v[52:55], v[40:43]
v_mfma_f32_16x16x32_bf16 v[44:47], v[68:71], v[52:55], v[44:47]
s_waitcnt lgkmcnt(4)
v_mfma_f32_16x16x32_bf16 v[44:47], v[72:75], v[56:59], v[44:47]
ds_read_b128 v[68:71], v5 offset:10240
s_waitcnt lgkmcnt(3)
v_mfma_f32_16x16x32_bf16 v[16:19], v[60:63], v[76:79], v[16:19]
s_waitcnt lgkmcnt(1)
v_mfma_f32_16x16x32_bf16 v[16:19], v[80:83], v[116:119], v[16:19]
ds_read_b128 v[72:75], v5 offset:12800
v_mfma_f32_16x16x32_bf16 v[20:23], v[60:63], v[116:119], v[20:23]
ds_read_b64_tr_b16 v[76:77], v12 offset:40960
v_mfma_f32_16x16x32_bf16 v[20:23], v[80:83], v[120:123], v[20:23]
ds_read_b64_tr_b16 v[78:79], v12 offset:41472
v_mfma_f32_16x16x32_bf16 v[24:27], v[60:63], v[120:123], v[24:27]
ds_read_b64_tr_b16 v[84:85], v12 offset:45056
v_mfma_f32_16x16x32_bf16 v[24:27], v[80:83], v[48:51], v[24:27]
ds_read_b64_tr_b16 v[86:87], v12 offset:45568
v_mfma_f32_16x16x32_bf16 v[28:31], v[60:63], v[48:51], v[28:31]
v_mfma_f32_16x16x32_bf16 v[28:31], v[80:83], v[64:67], v[28:31]
v_mfma_f32_16x16x32_bf16 v[32:35], v[60:63], v[64:67], v[32:35]
v_mfma_f32_16x16x32_bf16 v[32:35], v[80:83], v[52:55], v[32:35]
v_mfma_f32_16x16x32_bf16 v[36:39], v[60:63], v[52:55], v[36:39]
v_mfma_f32_16x16x32_bf16 v[36:39], v[80:83], v[56:59], v[36:39]
v_mfma_f32_16x16x32_bf16 v[40:43], v[60:63], v[56:59], v[40:43]
s_waitcnt lgkmcnt(5)
v_mfma_f32_16x16x32_bf16 v[40:43], v[80:83], v[68:71], v[40:43]
v_mfma_f32_16x16x32_bf16 v[44:47], v[60:63], v[68:71], v[44:47]
s_waitcnt lgkmcnt(4)
v_mfma_f32_16x16x32_bf16 v[44:47], v[80:83], v[72:75], v[44:47]
ds_read_b128 v[60:63], v5 offset:15360
s_waitcnt lgkmcnt(3)
v_mfma_f32_16x16x32_bf16 v[16:19], v[76:79], v[120:123], v[16:19]
s_waitcnt lgkmcnt(1)
v_mfma_f32_16x16x32_bf16 v[16:19], v[84:87], v[48:51], v[16:19]
ds_read_b128 v[80:83], v5 offset:17920
v_mfma_f32_16x16x32_bf16 v[20:23], v[76:79], v[48:51], v[20:23]
s_barrier
ds_read_b64_tr_b16 v[48:49], v12 offset:49152
v_mfma_f32_16x16x32_bf16 v[20:23], v[84:87], v[64:67], v[20:23]
ds_read_b64_tr_b16 v[50:51], v12 offset:49664
v_mfma_f32_16x16x32_bf16 v[24:27], v[76:79], v[64:67], v[24:27]
ds_read_b64_tr_b16 v[88:89], v12 offset:53248
v_mfma_f32_16x16x32_bf16 v[24:27], v[84:87], v[52:55], v[24:27]
ds_read_b64_tr_b16 v[90:91], v12 offset:53760
v_mfma_f32_16x16x32_bf16 v[28:31], v[76:79], v[52:55], v[28:31]
v_mfma_f32_16x16x32_bf16 v[28:31], v[84:87], v[56:59], v[28:31]
v_mfma_f32_16x16x32_bf16 v[32:35], v[76:79], v[56:59], v[32:35]
v_mfma_f32_16x16x32_bf16 v[32:35], v[84:87], v[68:71], v[32:35]
v_mfma_f32_16x16x32_bf16 v[36:39], v[76:79], v[68:71], v[36:39]
v_mfma_f32_16x16x32_bf16 v[36:39], v[84:87], v[72:75], v[36:39]
v_mfma_f32_16x16x32_bf16 v[40:43], v[76:79], v[72:75], v[40:43]
s_waitcnt lgkmcnt(5)
v_mfma_f32_16x16x32_bf16 v[40:43], v[84:87], v[60:63], v[40:43]
v_mfma_f32_16x16x32_bf16 v[44:47], v[76:79], v[60:63], v[44:47]
s_waitcnt lgkmcnt(4)
v_mfma_f32_16x16x32_bf16 v[44:47], v[84:87], v[80:83], v[44:47]
ds_read_b128 v[76:79], v7 offset:0
s_waitcnt lgkmcnt(3)
v_mfma_f32_16x16x32_bf16 v[16:19], v[48:51], v[64:67], v[16:19]
s_waitcnt lgkmcnt(1)
v_mfma_f32_16x16x32_bf16 v[16:19], v[88:91], v[52:55], v[16:19]
ds_read_b128 v[64:67], v7 offset:2560
v_mfma_f32_16x16x32_bf16 v[20:23], v[48:51], v[52:55], v[20:23]
ds_read_b64_tr_b16 v[52:53], v12 offset:57344
v_mfma_f32_16x16x32_bf16 v[20:23], v[88:91], v[56:59], v[20:23]
ds_read_b64_tr_b16 v[54:55], v12 offset:57856
v_mfma_f32_16x16x32_bf16 v[24:27], v[48:51], v[56:59], v[24:27]
ds_read_b64_tr_b16 v[84:85], v12 offset:61440
v_mfma_f32_16x16x32_bf16 v[24:27], v[88:91], v[68:71], v[24:27]
ds_read_b64_tr_b16 v[86:87], v12 offset:61952
v_mfma_f32_16x16x32_bf16 v[28:31], v[48:51], v[68:71], v[28:31]
L_pgc_0:
s_cbranch_scc1 L_ret
v_mfma_f32_16x16x32_bf16 v[28:31], v[88:91], v[72:75], v[28:31]
v_mfma_f32_16x16x32_bf16 v[32:35], v[48:51], v[72:75], v[32:35]
v_mfma_f32_16x16x32_bf16 v[32:35], v[88:91], v[60:63], v[32:35]
v_mfma_f32_16x16x32_bf16 v[36:39], v[48:51], v[60:63], v[36:39]
v_mfma_f32_16x16x32_bf16 v[36:39], v[88:91], v[80:83], v[36:39]
v_mfma_f32_16x16x32_bf16 v[40:43], v[48:51], v[80:83], v[40:43]
s_waitcnt lgkmcnt(5)
v_mfma_f32_16x16x32_bf16 v[40:43], v[88:91], v[76:79], v[40:43]
v_mfma_f32_16x16x32_bf16 v[44:47], v[48:51], v[76:79], v[44:47]
s_waitcnt lgkmcnt(4)
v_mfma_f32_16x16x32_bf16 v[44:47], v[88:91], v[64:67], v[44:47]
ds_read_b128 v[48:51], v7 offset:5120
s_waitcnt lgkmcnt(3)
v_mfma_f32_16x16x32_bf16 v[16:19], v[52:55], v[56:59], v[16:19]
s_waitcnt lgkmcnt(1)
v_mfma_f32_16x16x32_bf16 v[16:19], v[84:87], v[68:71], v[16:19]
ds_read_b128 v[56:59], v7 offset:7680
v_mfma_f32_16x16x32_bf16 v[20:23], v[52:55], v[68:71], v[20:23]
s_barrier
ds_read_b64_tr_b16 v[68:69], v13 offset:0
v_mfma_f32_16x16x32_bf16 v[20:23], v[84:87], v[72:75], v[20:23]
ds_read_b64_tr_b16 v[70:71], v13 offset:512
v_mfma_f32_16x16x32_bf16 v[24:27], v[52:55], v[72:75], v[24:27]
ds_read_b64_tr_b16 v[88:89], v13 offset:4096
v_mfma_f32_16x16x32_bf16 v[24:27], v[84:87], v[60:63], v[24:27]
ds_read_b64_tr_b16 v[90:91], v13 offset:4608
v_mfma_f32_16x16x32_bf16 v[28:31], v[52:55], v[60:63], v[28:31]
v_mfma_f32_16x16x32_bf16 v[28:31], v[84:87], v[80:83], v[28:31]
v_mfma_f32_16x16x32_bf16 v[32:35], v[52:55], v[80:83], v[32:35]
v_mfma_f32_16x16x32_bf16 v[32:35], v[84:87], v[76:79], v[32:35]
v_mfma_f32_16x16x32_bf16 v[36:39], v[52:55], v[76:79], v[36:39]
v_mfma_f32_16x16x32_bf16 v[36:39], v[84:87], v[64:67], v[36:39]
v_mfma_f32_16x16x32_bf16 v[40:43], v[52:55], v[64:67], v[40:43]
s_waitcnt lgkmcnt(5)
v_mfma_f32_16x16x32_bf16 v[40:43], v[84:87], v[48:51], v[40:43]
v_mfma_f32_16x16x32_bf16 v[44:47], v[52:55], v[48:51], v[44:47]
s_waitcnt lgkmcnt(4)
v_mfma_f32_16x16x32_bf16 v[44:47], v[84:87], v[56:59], v[44:47]
ds_read_b128 v[52:55], v7 offset:10240
s_waitcnt lgkmcnt(3)
v_mfma_f32_16x16x32_bf16 v[16:19], v[68:71], v[72:75], v[16:19]
s_waitcnt lgkmcnt(1)
v_mfma_f32_16x16x32_bf16 v[16:19], v[88:91], v[60:63], v[16:19]
ds_read_b128 v[72:75], v7 offset:12800
v_mfma_f32_16x16x32_bf16 v[20:23], v[68:71], v[60:63], v[20:23]
ds_read_b64_tr_b16 v[60:61], v13 offset:8192
v_mfma_f32_16x16x32_bf16 v[20:23], v[88:91], v[80:83], v[20:23]
ds_read_b64_tr_b16 v[62:63], v13 offset:8704
v_mfma_f32_16x16x32_bf16 v[24:27], v[68:71], v[80:83], v[24:27]
ds_read_b64_tr_b16 v[84:85], v13 offset:12288
v_mfma_f32_16x16x32_bf16 v[24:27], v[88:91], v[76:79], v[24:27]
ds_read_b64_tr_b16 v[86:87], v13 offset:12800
v_mfma_f32_16x16x32_bf16 v[28:31], v[68:71], v[76:79], v[28:31]
v_mfma_f32_16x16x32_bf16 v[28:31], v[88:91], v[64:67], v[28:31]
v_mfma_f32_16x16x32_bf16 v[32:35], v[68:71], v[64:67], v[32:35]
v_mfma_f32_16x16x32_bf16 v[32:35], v[88:91], v[48:51], v[32:35]
v_mfma_f32_16x16x32_bf16 v[36:39], v[68:71], v[48:51], v[36:39]
v_mfma_f32_16x16x32_bf16 v[36:39], v[88:91], v[56:59], v[36:39]
v_mfma_f32_16x16x32_bf16 v[40:43], v[68:71], v[56:59], v[40:43]
s_waitcnt lgkmcnt(5)
v_mfma_f32_16x16x32_bf16 v[40:43], v[88:91], v[52:55], v[40:43]
v_mfma_f32_16x16x32_bf16 v[44:47], v[68:71], v[52:55], v[44:47]
s_waitcnt lgkmcnt(4)
v_mfma_f32_16x16x32_bf16 v[44:47], v[88:91], v[72:75], v[44:47]
ds_read_b128 v[68:71], v7 offset:15360
s_waitcnt lgkmcnt(3)
v_mfma_f32_16x16x32_bf16 v[16:19], v[60:63], v[80:83], v[16:19]
s_waitcnt lgkmcnt(1)
v_mfma_f32_16x16x32_bf16 v[16:19], v[84:87], v[76:79], v[16:19]
ds_read_b128 v[80:83], v7 offset:17920
v_mfma_f32_16x16x32_bf16 v[20:23], v[60:63], v[76:79], v[20:23]
s_barrier
ds_read_b64_tr_b16 v[76:77], v13 offset:16384
v_mfma_f32_16x16x32_bf16 v[20:23], v[84:87], v[64:67], v[20:23]
ds_read_b64_tr_b16 v[78:79], v13 offset:16896
v_mfma_f32_16x16x32_bf16 v[24:27], v[60:63], v[64:67], v[24:27]
ds_read_b64_tr_b16 v[88:89], v13 offset:20480
v_mfma_f32_16x16x32_bf16 v[24:27], v[84:87], v[48:51], v[24:27]
ds_read_b64_tr_b16 v[90:91], v13 offset:20992
v_mfma_f32_16x16x32_bf16 v[28:31], v[60:63], v[48:51], v[28:31]
v_mfma_f32_16x16x32_bf16 v[28:31], v[84:87], v[56:59], v[28:31]
v_mfma_f32_16x16x32_bf16 v[32:35], v[60:63], v[56:59], v[32:35]
v_mfma_f32_16x16x32_bf16 v[32:35], v[84:87], v[52:55], v[32:35]
v_mfma_f32_16x16x32_bf16 v[36:39], v[60:63], v[52:55], v[36:39]
v_mfma_f32_16x16x32_bf16 v[36:39], v[84:87], v[72:75], v[36:39]
v_mfma_f32_16x16x32_bf16 v[40:43], v[60:63], v[72:75], v[40:43]
s_waitcnt lgkmcnt(5)
v_mfma_f32_16x16x32_bf16 v[40:43], v[84:87], v[68:71], v[40:43]
v_mfma_f32_16x16x32_bf16 v[44:47], v[60:63], v[68:71], v[44:47]
s_waitcnt lgkmcnt(4)
v_mfma_f32_16x16x32_bf16 v[44:47], v[84:87], v[80:83], v[44:47]
ds_read_b128 v[60:63], v9 offset:0
s_waitcnt lgkmcnt(3)
v_mfma_f32_16x16x32_bf16 v[16:19], v[76:79], v[64:67], v[16:19]
s_waitcnt lgkmcnt(1)
v_mfma_f32_16x16x32_bf16 v[16:19], v[88:91], v[48:51], v[16:19]
ds_read_b128 v[64:67], v9 offset:2560
v_mfma_f32_16x16x32_bf16 v[20:23], v[76:79], v[48:51], v[20:23]
ds_read_b64_tr_b16 v[48:49], v13 offset:24576
v_mfma_f32_16x16x32_bf16 v[20:23], v[88:91], v[56:59], v[20:23]
ds_read_b64_tr_b16 v[50:51], v13 offset:25088
v_mfma_f32_16x16x32_bf16 v[24:27], v[76:79], v[56:59], v[24:27]
ds_read_b64_tr_b16 v[84:85], v13 offset:28672
v_mfma_f32_16x16x32_bf16 v[24:27], v[88:91], v[52:55], v[24:27]
ds_read_b64_tr_b16 v[86:87], v13 offset:29184
v_mfma_f32_16x16x32_bf16 v[28:31], v[76:79], v[52:55], v[28:31]
v_mfma_f32_16x16x32_bf16 v[28:31], v[88:91], v[72:75], v[28:31]
v_mfma_f32_16x16x32_bf16 v[32:35], v[76:79], v[72:75], v[32:35]
v_mfma_f32_16x16x32_bf16 v[32:35], v[88:91], v[68:71], v[32:35]
v_mfma_f32_16x16x32_bf16 v[36:39], v[76:79], v[68:71], v[36:39]
v_mfma_f32_16x16x32_bf16 v[36:39], v[88:91], v[80:83], v[36:39]
v_mfma_f32_16x16x32_bf16 v[40:43], v[76:79], v[80:83], v[40:43]
s_waitcnt lgkmcnt(5)
v_mfma_f32_16x16x32_bf16 v[40:43], v[88:91], v[60:63], v[40:43]
v_mfma_f32_16x16x32_bf16 v[44:47], v[76:79], v[60:63], v[44:47]
s_waitcnt lgkmcnt(4)
v_mfma_f32_16x16x32_bf16 v[44:47], v[88:91], v[64:67], v[44:47]
ds_read_b128 v[76:79], v9 offset:5120
s_waitcnt lgkmcnt(3)
v_mfma_f32_16x16x32_bf16 v[16:19], v[48:51], v[56:59], v[16:19]
s_waitcnt lgkmcnt(1)
v_mfma_f32_16x16x32_bf16 v[16:19], v[84:87], v[52:55], v[16:19]
ds_read_b128 v[56:59], v9 offset:7680
v_mfma_f32_16x16x32_bf16 v[20:23], v[48:51], v[52:55], v[20:23]
s_barrier
ds_read_b64_tr_b16 v[52:53], v13 offset:32768
v_mfma_f32_16x16x32_bf16 v[20:23], v[84:87], v[72:75], v[20:23]
ds_read_b64_tr_b16 v[54:55], v13 offset:33280
v_mfma_f32_16x16x32_bf16 v[24:27], v[48:51], v[72:75], v[24:27]
ds_read_b64_tr_b16 v[88:89], v13 offset:36864
v_mfma_f32_16x16x32_bf16 v[24:27], v[84:87], v[68:71], v[24:27]
ds_read_b64_tr_b16 v[90:91], v13 offset:37376
v_mfma_f32_16x16x32_bf16 v[28:31], v[48:51], v[68:71], v[28:31]
v_mfma_f32_16x16x32_bf16 v[28:31], v[84:87], v[80:83], v[28:31]
v_mfma_f32_16x16x32_bf16 v[32:35], v[48:51], v[80:83], v[32:35]
v_mfma_f32_16x16x32_bf16 v[32:35], v[84:87], v[60:63], v[32:35]
v_mfma_f32_16x16x32_bf16 v[36:39], v[48:51], v[60:63], v[36:39]
v_mfma_f32_16x16x32_bf16 v[36:39], v[84:87], v[64:67], v[36:39]
v_mfma_f32_16x16x32_bf16 v[40:43], v[48:51], v[64:67], v[40:43]
s_waitcnt lgkmcnt(5)
v_mfma_f32_16x16x32_bf16 v[40:43], v[84:87], v[76:79], v[40:43]
v_mfma_f32_16x16x32_bf16 v[44:47], v[48:51], v[76:79], v[44:47]
s_waitcnt lgkmcnt(4)
v_mfma_f32_16x16x32_bf16 v[44:47], v[84:87], v[56:59], v[44:47]
ds_read_b128 v[48:51], v9 offset:10240
s_waitcnt lgkmcnt(3)
v_mfma_f32_16x16x32_bf16 v[16:19], v[52:55], v[72:75], v[16:19]
ds_read_b64_tr_b16 v[72:73], v13 offset:40960
s_waitcnt lgkmcnt(2)
v_mfma_f32_16x16x32_bf16 v[16:19], v[88:91], v[68:71], v[16:19]
ds_read_b64_tr_b16 v[74:75], v13 offset:41472
v_mfma_f32_16x16x32_bf16 v[20:23], v[52:55], v[68:71], v[20:23]
ds_read_b128 v[68:71], v9 offset:12800
v_mfma_f32_16x16x32_bf16 v[20:23], v[88:91], v[80:83], v[20:23]
ds_read_b64_tr_b16 v[84:85], v13 offset:45056
v_mfma_f32_16x16x32_bf16 v[24:27], v[52:55], v[80:83], v[24:27]
ds_read_b64_tr_b16 v[86:87], v13 offset:45568
v_mfma_f32_16x16x32_bf16 v[24:27], v[88:91], v[60:63], v[24:27]
ds_read_b64_tr_b16 v[92:93], v12 offset:0
v_mfma_f32_16x16x32_bf16 v[28:31], v[52:55], v[60:63], v[28:31]
ds_read_b64_tr_b16 v[94:95], v12 offset:512
v_mfma_f32_16x16x32_bf16 v[28:31], v[88:91], v[64:67], v[28:31]
v_mfma_f32_16x16x32_bf16 v[32:35], v[52:55], v[64:67], v[32:35]
v_mfma_f32_16x16x32_bf16 v[32:35], v[88:91], v[76:79], v[32:35]
v_mfma_f32_16x16x32_bf16 v[36:39], v[52:55], v[76:79], v[36:39]
v_mfma_f32_16x16x32_bf16 v[36:39], v[88:91], v[56:59], v[36:39]
ds_read_b64_tr_b16 v[96:97], v12 offset:4096
v_mfma_f32_16x16x32_bf16 v[40:43], v[52:55], v[56:59], v[40:43]
ds_read_b64_tr_b16 v[98:99], v12 offset:4608
s_waitcnt lgkmcnt(9)
v_mfma_f32_16x16x32_bf16 v[40:43], v[88:91], v[48:51], v[40:43]
v_mfma_f32_16x16x32_bf16 v[44:47], v[52:55], v[48:51], v[44:47]
s_waitcnt lgkmcnt(6)
v_mfma_f32_16x16x32_bf16 v[44:47], v[88:91], v[68:71], v[44:47]
ds_read_b128 v[52:55], v9 offset:15360
s_waitcnt lgkmcnt(5)
v_mfma_f32_16x16x32_bf16 v[16:19], v[84:87], v[80:83], v[16:19]
s_waitcnt lgkmcnt(3)
v_mfma_f32_16x16x32_bf16 v[16:19], v[92:95], v[60:63], v[16:19]
ds_read_b128 v[80:83], v9 offset:17920
v_mfma_f32_16x16x32_bf16 v[20:23], v[84:87], v[60:63], v[20:23]
s_barrier
ds_read_b64_tr_b16 v[60:61], v12 offset:8192
v_mfma_f32_16x16x32_bf16 v[20:23], v[92:95], v[64:67], v[20:23]
ds_read_b64_tr_b16 v[62:63], v12 offset:8704
v_mfma_f32_16x16x32_bf16 v[24:27], v[84:87], v[64:67], v[24:27]
ds_read_b64_tr_b16 v[88:89], v12 offset:12288
v_mfma_f32_16x16x32_bf16 v[24:27], v[92:95], v[76:79], v[24:27]
ds_read_b64_tr_b16 v[90:91], v12 offset:12800
v_mfma_f32_16x16x32_bf16 v[28:31], v[84:87], v[76:79], v[28:31]
ds_read_b64_tr_b16 v[100:101], v12 offset:16384
v_mfma_f32_16x16x32_bf16 v[28:31], v[92:95], v[56:59], v[28:31]
ds_read_b64_tr_b16 v[102:103], v12 offset:16896
v_mfma_f32_16x16x32_bf16 v[32:35], v[84:87], v[56:59], v[32:35]
v_mfma_f32_16x16x32_bf16 v[32:35], v[92:95], v[48:51], v[32:35]
v_mfma_f32_16x16x32_bf16 v[36:39], v[84:87], v[48:51], v[36:39]
ds_read_b128 v[104:107], v2 offset:20480
v_mfma_f32_16x16x32_bf16 v[36:39], v[92:95], v[68:71], v[36:39]
v_mfma_f32_16x16x32_bf16 v[40:43], v[84:87], v[68:71], v[40:43]
s_waitcnt lgkmcnt(8)
v_mfma_f32_16x16x32_bf16 v[40:43], v[92:95], v[52:55], v[40:43]
v_mfma_f32_16x16x32_bf16 v[44:47], v[84:87], v[52:55], v[44:47]
s_waitcnt lgkmcnt(7)
v_mfma_f32_16x16x32_bf16 v[44:47], v[92:95], v[80:83], v[44:47]
ds_read_b128 v[84:87], v11 offset:0
s_waitcnt lgkmcnt(6)
v_mfma_f32_16x16x32_bf16 v[16:19], v[60:63], v[64:67], v[16:19]
ds_read_b128 v[64:67], v2 offset:23040
s_waitcnt lgkmcnt(5)
v_mfma_f32_16x16x32_bf16 v[16:19], v[88:91], v[76:79], v[16:19]
ds_read_b64_tr_b16 v[92:93], v12 offset:20480
v_mfma_f32_16x16x32_bf16 v[20:23], v[60:63], v[76:79], v[20:23]
ds_read_b64_tr_b16 v[94:95], v12 offset:20992
v_mfma_f32_16x16x32_bf16 v[20:23], v[88:91], v[56:59], v[20:23]
ds_read_b128 v[76:79], v11 offset:2560
v_mfma_f32_16x16x32_bf16 v[24:27], v[60:63], v[56:59], v[24:27]
ds_read_b64_tr_b16 v[108:109], v12 offset:24576
v_mfma_f32_16x16x32_bf16 v[24:27], v[88:91], v[48:51], v[24:27]
ds_read_b64_tr_b16 v[110:111], v12 offset:25088
ds_read_b64_tr_b16 v[112:113], v12 offset:28672
v_mfma_f32_16x16x32_bf16 v[28:31], v[60:63], v[48:51], v[28:31]
ds_read_b64_tr_b16 v[114:115], v12 offset:29184
v_mfma_f32_16x16x32_bf16 v[28:31], v[88:91], v[68:71], v[28:31]
ds_read_b128 v[116:119], v2 offset:25600
v_mfma_f32_16x16x32_bf16 v[32:35], v[60:63], v[68:71], v[32:35]
v_mfma_f32_16x16x32_bf16 v[32:35], v[88:91], v[52:55], v[32:35]
v_mfma_f32_16x16x32_bf16 v[36:39], v[60:63], v[52:55], v[36:39]
v_mfma_f32_16x16x32_bf16 v[36:39], v[88:91], v[80:83], v[36:39]
v_mfma_f32_16x16x32_bf16 v[40:43], v[60:63], v[80:83], v[40:43]
ds_read_b64_tr_b16 v[120:121], v12 offset:32768
s_waitcnt lgkmcnt(10)
v_mfma_f32_16x16x32_bf16 v[40:43], v[88:91], v[84:87], v[40:43]
ds_read_b64_tr_b16 v[122:123], v12 offset:33280
v_mfma_f32_16x16x32_bf16 v[44:47], v[60:63], v[84:87], v[44:47]
ds_read_b128 v[60:63], v2 offset:28160
s_waitcnt lgkmcnt(8)
v_mfma_f32_16x16x32_bf16 v[44:47], v[88:91], v[76:79], v[44:47]
ds_read_b128 v[88:91], v11 offset:5120
s_waitcnt lgkmcnt(7)
v_mfma_f32_16x16x32_bf16 v[16:19], v[108:111], v[56:59], v[16:19]
s_waitcnt lgkmcnt(5)
v_mfma_f32_16x16x32_bf16 v[16:19], v[112:115], v[48:51], v[16:19]
ds_read_b128 v[56:59], v11 offset:7680
v_mfma_f32_16x16x32_bf16 v[20:23], v[108:111], v[48:51], v[20:23]
s_barrier
ds_read_b64_tr_b16 v[48:49], v12 offset:36864
v_mfma_f32_16x16x32_bf16 v[20:23], v[112:115], v[68:71], v[20:23]
ds_read_b64_tr_b16 v[50:51], v12 offset:37376
v_mfma_f32_16x16x32_bf16 v[24:27], v[108:111], v[68:71], v[24:27]
ds_read_b64_tr_b16 v[124:125], v12 offset:40960
v_mfma_f32_16x16x32_bf16 v[24:27], v[112:115], v[52:55], v[24:27]
ds_read_b64_tr_b16 v[126:127], v12 offset:41472
v_mfma_f32_16x16x32_bf16 v[28:31], v[108:111], v[52:55], v[28:31]
ds_read_b128 v[128:131], v2 offset:30720
v_mfma_f32_16x16x32_bf16 v[28:31], v[112:115], v[80:83], v[28:31]
v_mfma_f32_16x16x32_bf16 v[32:35], v[108:111], v[80:83], v[32:35]
ds_read_b64_tr_b16 v[132:133], v12 offset:45056
v_mfma_f32_16x16x32_bf16 v[32:35], v[112:115], v[84:87], v[32:35]
ds_read_b64_tr_b16 v[134:135], v12 offset:45568
v_mfma_f32_16x16x32_bf16 v[36:39], v[108:111], v[84:87], v[36:39]
v_mfma_f32_16x16x32_bf16 v[36:39], v[112:115], v[76:79], v[36:39]
v_mfma_f32_16x16x32_bf16 v[40:43], v[108:111], v[76:79], v[40:43]
ds_read_b128 v[136:139], v2 offset:33280
s_waitcnt lgkmcnt(9)
v_mfma_f32_16x16x32_bf16 v[40:43], v[112:115], v[88:91], v[40:43]
v_mfma_f32_16x16x32_bf16 v[44:47], v[108:111], v[88:91], v[44:47]
s_waitcnt lgkmcnt(8)
v_mfma_f32_16x16x32_bf16 v[44:47], v[112:115], v[56:59], v[44:47]
ds_read_b128 v[108:111], v11 offset:10240
s_waitcnt lgkmcnt(7)
v_mfma_f32_16x16x32_bf16 v[16:19], v[48:51], v[68:71], v[16:19]
s_waitcnt lgkmcnt(5)
v_mfma_f32_16x16x32_bf16 v[16:19], v[124:127], v[52:55], v[16:19]
ds_read_b128 v[68:71], v11 offset:12800
v_mfma_f32_16x16x32_bf16 v[20:23], v[48:51], v[52:55], v[20:23]
ds_read_b64_tr_b16 v[52:53], v12 offset:49152
v_mfma_f32_16x16x32_bf16 v[20:23], v[124:127], v[80:83], v[20:23]
ds_read_b64_tr_b16 v[54:55], v12 offset:49664
v_mfma_f32_16x16x32_bf16 v[24:27], v[48:51], v[80:83], v[24:27]
ds_read_b64_tr_b16 v[80:81], v12 offset:53248
v_mfma_f32_16x16x32_bf16 v[24:27], v[124:127], v[84:87], v[24:27]
ds_read_b64_tr_b16 v[82:83], v12 offset:53760
v_mfma_f32_16x16x32_bf16 v[28:31], v[48:51], v[84:87], v[28:31]
ds_read_b64_tr_b16 v[84:85], v12 offset:57344
ds_read_b64_tr_b16 v[86:87], v12 offset:57856
v_mfma_f32_16x16x32_bf16 v[28:31], v[124:127], v[76:79], v[28:31]
ds_read_b128 v[112:115], v2 offset:35840
v_mfma_f32_16x16x32_bf16 v[32:35], v[48:51], v[76:79], v[32:35]
v_mfma_f32_16x16x32_bf16 v[32:35], v[124:127], v[88:91], v[32:35]
v_mfma_f32_16x16x32_bf16 v[36:39], v[48:51], v[88:91], v[36:39]
ds_read_b128 v[76:79], v2 offset:38400
v_mfma_f32_16x16x32_bf16 v[36:39], v[124:127], v[56:59], v[36:39]
v_mfma_f32_16x16x32_bf16 v[40:43], v[48:51], v[56:59], v[40:43]
s_waitcnt lgkmcnt(9)
v_mfma_f32_16x16x32_bf16 v[40:43], v[124:127], v[108:111], v[40:43]
v_mfma_f32_16x16x32_bf16 v[44:47], v[48:51], v[108:111], v[44:47]
ds_read_b64_tr_b16 v[48:49], v12 offset:61440
s_waitcnt lgkmcnt(9)
v_mfma_f32_16x16x32_bf16 v[44:47], v[124:127], v[68:71], v[44:47]
ds_read_b64_tr_b16 v[50:51], v12 offset:61952
s_waitcnt lgkmcnt(8)
v_mfma_f32_16x16x32_bf16 v[16:19], v[52:55], v[104:107], v[16:19]
s_waitcnt lgkmcnt(6)
v_mfma_f32_16x16x32_bf16 v[16:19], v[80:83], v[64:67], v[16:19]
ds_read_b128 v[56:59], v4 offset:20480
v_mfma_f32_16x16x32_bf16 v[20:23], v[52:55], v[64:67], v[20:23]
s_waitcnt lgkmcnt(5)
s_barrier
ds_read_b64_tr_b16 v[64:65], v13 offset:0
v_mfma_f32_16x16x32_bf16 v[20:23], v[80:83], v[116:119], v[20:23]
ds_read_b64_tr_b16 v[66:67], v13 offset:512
v_mfma_f32_16x16x32_bf16 v[24:27], v[52:55], v[116:119], v[24:27]
ds_read_b64_tr_b16 v[68:69], v13 offset:4096
v_mfma_f32_16x16x32_bf16 v[24:27], v[80:83], v[60:63], v[24:27]
ds_read_b64_tr_b16 v[70:71], v13 offset:4608
v_mfma_f32_16x16x32_bf16 v[28:31], v[52:55], v[60:63], v[28:31]
v_mfma_f32_16x16x32_bf16 v[28:31], v[80:83], v[128:131], v[28:31]
v_mfma_f32_16x16x32_bf16 v[32:35], v[52:55], v[128:131], v[32:35]
v_mfma_f32_16x16x32_bf16 v[32:35], v[80:83], v[136:139], v[32:35]
ds_read_b64_tr_b16 v[88:89], v13 offset:8192
v_mfma_f32_16x16x32_bf16 v[36:39], v[52:55], v[136:139], v[36:39]
ds_read_b64_tr_b16 v[90:91], v13 offset:8704
s_waitcnt lgkmcnt(10)
v_mfma_f32_16x16x32_bf16 v[36:39], v[80:83], v[112:115], v[36:39]
v_mfma_f32_16x16x32_bf16 v[40:43], v[52:55], v[112:115], v[40:43]
s_waitcnt lgkmcnt(9)
v_mfma_f32_16x16x32_bf16 v[40:43], v[80:83], v[76:79], v[40:43]
v_mfma_f32_16x16x32_bf16 v[44:47], v[52:55], v[76:79], v[44:47]
s_waitcnt lgkmcnt(6)
v_mfma_f32_16x16x32_bf16 v[44:47], v[80:83], v[56:59], v[44:47]
ds_read_b128 v[52:55], v4 offset:23040
s_waitcnt lgkmcnt(5)
v_mfma_f32_16x16x32_bf16 v[16:19], v[64:67], v[116:119], v[16:19]
s_waitcnt lgkmcnt(3)
v_mfma_f32_16x16x32_bf16 v[16:19], v[68:71], v[60:63], v[16:19]
ds_read_b128 v[80:83], v4 offset:25600
v_mfma_f32_16x16x32_bf16 v[20:23], v[64:67], v[60:63], v[20:23]
ds_read_b64_tr_b16 v[60:61], v13 offset:12288
v_mfma_f32_16x16x32_bf16 v[20:23], v[68:71], v[128:131], v[20:23]
ds_read_b64_tr_b16 v[62:63], v13 offset:12800
v_mfma_f32_16x16x32_bf16 v[24:27], v[64:67], v[128:131], v[24:27]
ds_read_b64_tr_b16 v[104:105], v13 offset:16384
v_mfma_f32_16x16x32_bf16 v[24:27], v[68:71], v[136:139], v[24:27]
ds_read_b64_tr_b16 v[106:107], v13 offset:16896
v_mfma_f32_16x16x32_bf16 v[28:31], v[64:67], v[136:139], v[28:31]
ds_read_b64_tr_b16 v[108:109], v13 offset:20480
v_mfma_f32_16x16x32_bf16 v[28:31], v[68:71], v[112:115], v[28:31]
ds_read_b64_tr_b16 v[110:111], v13 offset:20992
v_mfma_f32_16x16x32_bf16 v[32:35], v[64:67], v[112:115], v[32:35]
v_mfma_f32_16x16x32_bf16 v[32:35], v[68:71], v[76:79], v[32:35]
v_mfma_f32_16x16x32_bf16 v[36:39], v[64:67], v[76:79], v[36:39]
v_mfma_f32_16x16x32_bf16 v[36:39], v[68:71], v[56:59], v[36:39]
v_mfma_f32_16x16x32_bf16 v[40:43], v[64:67], v[56:59], v[40:43]
s_waitcnt lgkmcnt(7)
v_mfma_f32_16x16x32_bf16 v[40:43], v[68:71], v[52:55], v[40:43]
v_mfma_f32_16x16x32_bf16 v[44:47], v[64:67], v[52:55], v[44:47]
s_waitcnt lgkmcnt(6)
v_mfma_f32_16x16x32_bf16 v[44:47], v[68:71], v[80:83], v[44:47]
ds_read_b128 v[64:67], v4 offset:28160
s_waitcnt lgkmcnt(5)
v_mfma_f32_16x16x32_bf16 v[16:19], v[60:63], v[128:131], v[16:19]
s_waitcnt lgkmcnt(3)
s_barrier
ds_read_b64_tr_b16 v[68:69], v13 offset:24576
v_mfma_f32_16x16x32_bf16 v[16:19], v[104:107], v[136:139], v[16:19]
ds_read_b64_tr_b16 v[70:71], v13 offset:25088
v_mfma_f32_16x16x32_bf16 v[20:23], v[60:63], v[136:139], v[20:23]
ds_read_b128 v[116:119], v4 offset:30720
v_mfma_f32_16x16x32_bf16 v[20:23], v[104:107], v[112:115], v[20:23]
ds_read_b64_tr_b16 v[124:125], v13 offset:28672
v_mfma_f32_16x16x32_bf16 v[24:27], v[60:63], v[112:115], v[24:27]
ds_read_b64_tr_b16 v[126:127], v13 offset:29184
v_mfma_f32_16x16x32_bf16 v[24:27], v[104:107], v[76:79], v[24:27]
ds_read_b64_tr_b16 v[128:129], v13 offset:32768
v_mfma_f32_16x16x32_bf16 v[28:31], v[60:63], v[76:79], v[28:31]
ds_read_b64_tr_b16 v[130:131], v13 offset:33280
v_mfma_f32_16x16x32_bf16 v[28:31], v[104:107], v[56:59], v[28:31]
v_mfma_f32_16x16x32_bf16 v[32:35], v[60:63], v[56:59], v[32:35]
v_mfma_f32_16x16x32_bf16 v[32:35], v[104:107], v[52:55], v[32:35]
v_mfma_f32_16x16x32_bf16 v[36:39], v[60:63], v[52:55], v[36:39]
v_mfma_f32_16x16x32_bf16 v[36:39], v[104:107], v[80:83], v[36:39]
ds_read_b64_tr_b16 v[136:137], v13 offset:36864
v_mfma_f32_16x16x32_bf16 v[40:43], v[60:63], v[80:83], v[40:43]
ds_read_b64_tr_b16 v[138:139], v13 offset:37376
s_waitcnt lgkmcnt(9)
v_mfma_f32_16x16x32_bf16 v[40:43], v[104:107], v[64:67], v[40:43]
v_mfma_f32_16x16x32_bf16 v[44:47], v[60:63], v[64:67], v[44:47]
s_waitcnt lgkmcnt(6)
v_mfma_f32_16x16x32_bf16 v[44:47], v[104:107], v[116:119], v[44:47]
ds_read_b128 v[60:63], v4 offset:33280
s_waitcnt lgkmcnt(5)
v_mfma_f32_16x16x32_bf16 v[16:19], v[124:127], v[112:115], v[16:19]
s_waitcnt lgkmcnt(3)
v_mfma_f32_16x16x32_bf16 v[16:19], v[128:131], v[76:79], v[16:19]
ds_read_b128 v[104:107], v4 offset:35840
v_mfma_f32_16x16x32_bf16 v[20:23], v[124:127], v[76:79], v[20:23]
ds_read_b64_tr_b16 v[76:77], v13 offset:40960
v_mfma_f32_16x16x32_bf16 v[20:23], v[128:131], v[56:59], v[20:23]
ds_read_b64_tr_b16 v[78:79], v13 offset:41472
v_mfma_f32_16x16x32_bf16 v[24:27], v[124:127], v[56:59], v[24:27]
ds_read_b64_tr_b16 v[112:113], v13 offset:45056
v_mfma_f32_16x16x32_bf16 v[24:27], v[128:131], v[52:55], v[24:27]
ds_read_b64_tr_b16 v[114:115], v13 offset:45568
v_mfma_f32_16x16x32_bf16 v[28:31], v[124:127], v[52:55], v[28:31]
ds_read_b64_tr_b16 v[140:141], v12 offset:0
v_mfma_f32_16x16x32_bf16 v[28:31], v[128:131], v[80:83], v[28:31]
ds_read_b64_tr_b16 v[142:143], v12 offset:512
v_mfma_f32_16x16x32_bf16 v[32:35], v[124:127], v[80:83], v[32:35]
v_mfma_f32_16x16x32_bf16 v[32:35], v[128:131], v[64:67], v[32:35]
v_mfma_f32_16x16x32_bf16 v[36:39], v[124:127], v[64:67], v[36:39]
v_mfma_f32_16x16x32_bf16 v[36:39], v[128:131], v[116:119], v[36:39]
v_mfma_f32_16x16x32_bf16 v[40:43], v[124:127], v[116:119], v[40:43]
s_waitcnt lgkmcnt(7)
v_mfma_f32_16x16x32_bf16 v[40:43], v[128:131], v[60:63], v[40:43]
v_mfma_f32_16x16x32_bf16 v[44:47], v[124:127], v[60:63], v[44:47]
s_waitcnt lgkmcnt(6)
v_mfma_f32_16x16x32_bf16 v[44:47], v[128:131], v[104:107], v[44:47]
ds_read_b128 v[124:127], v4 offset:38400
s_waitcnt lgkmcnt(5)
v_mfma_f32_16x16x32_bf16 v[16:19], v[76:79], v[56:59], v[16:19]
s_waitcnt lgkmcnt(3)
v_mfma_f32_16x16x32_bf16 v[16:19], v[112:115], v[52:55], v[16:19]
s_waitcnt lgkmcnt(1)
s_barrier
ds_read_b64_tr_b16 v[56:57], v12 offset:4096
v_mfma_f32_16x16x32_bf16 v[20:23], v[76:79], v[52:55], v[20:23]
ds_read_b64_tr_b16 v[58:59], v12 offset:4608
v_mfma_f32_16x16x32_bf16 v[20:23], v[112:115], v[80:83], v[20:23]
ds_read_b128 v[52:55], v6 offset:20480
v_mfma_f32_16x16x32_bf16 v[24:27], v[76:79], v[80:83], v[24:27]
ds_read_b64_tr_b16 v[128:129], v12 offset:8192
v_mfma_f32_16x16x32_bf16 v[24:27], v[112:115], v[64:67], v[24:27]
ds_read_b64_tr_b16 v[130:131], v12 offset:8704
ds_read_b64_tr_b16 v[144:145], v12 offset:12288
v_mfma_f32_16x16x32_bf16 v[28:31], v[76:79], v[64:67], v[28:31]
ds_read_b64_tr_b16 v[146:147], v12 offset:12800
v_mfma_f32_16x16x32_bf16 v[28:31], v[112:115], v[116:119], v[28:31]
v_mfma_f32_16x16x32_bf16 v[32:35], v[76:79], v[116:119], v[32:35]
v_mfma_f32_16x16x32_bf16 v[32:35], v[112:115], v[60:63], v[32:35]
v_mfma_f32_16x16x32_bf16 v[36:39], v[76:79], v[60:63], v[36:39]
v_mfma_f32_16x16x32_bf16 v[36:39], v[112:115], v[104:107], v[36:39]
v_mfma_f32_16x16x32_bf16 v[40:43], v[76:79], v[104:107], v[40:43]
ds_read_b64_tr_b16 v[148:149], v12 offset:16384
s_waitcnt lgkmcnt(8)
v_mfma_f32_16x16x32_bf16 v[40:43], v[112:115], v[124:127], v[40:43]
ds_read_b64_tr_b16 v[150:151], v12 offset:16896
v_mfma_f32_16x16x32_bf16 v[44:47], v[76:79], v[124:127], v[44:47]
s_waitcnt lgkmcnt(6)
v_mfma_f32_16x16x32_bf16 v[44:47], v[112:115], v[52:55], v[44:47]
ds_read_b128 v[76:79], v6 offset:23040
s_waitcnt lgkmcnt(5)
v_mfma_f32_16x16x32_bf16 v[16:19], v[128:131], v[80:83], v[16:19]
s_waitcnt lgkmcnt(3)
v_mfma_f32_16x16x32_bf16 v[16:19], v[144:147], v[64:67], v[16:19]
ds_read_b128 v[80:83], v6 offset:25600
v_mfma_f32_16x16x32_bf16 v[20:23], v[128:131], v[64:67], v[20:23]
ds_read_b64_tr_b16 v[64:65], v12 offset:20480
v_mfma_f32_16x16x32_bf16 v[20:23], v[144:147], v[116:119], v[20:23]
ds_read_b64_tr_b16 v[66:67], v12 offset:20992
v_mfma_f32_16x16x32_bf16 v[24:27], v[128:131], v[116:119], v[24:27]
ds_read_b64_tr_b16 v[112:113], v12 offset:24576
v_mfma_f32_16x16x32_bf16 v[24:27], v[144:147], v[60:63], v[24:27]
ds_read_b64_tr_b16 v[114:115], v12 offset:25088
v_mfma_f32_16x16x32_bf16 v[28:31], v[128:131], v[60:63], v[28:31]
v_mfma_f32_16x16x32_bf16 v[28:31], v[144:147], v[104:107], v[28:31]
v_mfma_f32_16x16x32_bf16 v[32:35], v[128:131], v[104:107], v[32:35]
ds_read_b64_tr_b16 v[152:153], v12 offset:28672
v_mfma_f32_16x16x32_bf16 v[32:35], v[144:147], v[124:127], v[32:35]
ds_read_b64_tr_b16 v[154:155], v12 offset:29184
v_mfma_f32_16x16x32_bf16 v[36:39], v[128:131], v[124:127], v[36:39]
v_mfma_f32_16x16x32_bf16 v[36:39], v[144:147], v[52:55], v[36:39]
v_mfma_f32_16x16x32_bf16 v[40:43], v[128:131], v[52:55], v[40:43]
s_waitcnt lgkmcnt(7)
v_mfma_f32_16x16x32_bf16 v[40:43], v[144:147], v[76:79], v[40:43]
v_mfma_f32_16x16x32_bf16 v[44:47], v[128:131], v[76:79], v[44:47]
s_waitcnt lgkmcnt(6)
v_mfma_f32_16x16x32_bf16 v[44:47], v[144:147], v[80:83], v[44:47]
ds_read_b128 v[128:131], v6 offset:28160
s_waitcnt lgkmcnt(5)
v_mfma_f32_16x16x32_bf16 v[16:19], v[64:67], v[116:119], v[16:19]
s_waitcnt lgkmcnt(3)
v_mfma_f32_16x16x32_bf16 v[16:19], v[112:115], v[60:63], v[16:19]
ds_read_b128 v[116:119], v6 offset:30720
v_mfma_f32_16x16x32_bf16 v[20:23], v[64:67], v[60:63], v[20:23]
s_barrier
ds_read_b64_tr_b16 v[60:61], v12 offset:32768
v_mfma_f32_16x16x32_bf16 v[20:23], v[112:115], v[104:107], v[20:23]
ds_read_b64_tr_b16 v[62:63], v12 offset:33280
v_mfma_f32_16x16x32_bf16 v[24:27], v[64:67], v[104:107], v[24:27]
ds_read_b64_tr_b16 v[144:145], v12 offset:36864
v_mfma_f32_16x16x32_bf16 v[24:27], v[112:115], v[124:127], v[24:27]
ds_read_b64_tr_b16 v[146:147], v12 offset:37376
v_mfma_f32_16x16x32_bf16 v[28:31], v[64:67], v[124:127], v[28:31]
ds_read_b64_tr_b16 v[156:157], v12 offset:40960
ds_read_b64_tr_b16 v[158:159], v12 offset:41472
v_mfma_f32_16x16x32_bf16 v[28:31], v[112:115], v[52:55], v[28:31]
v_mfma_f32_16x16x32_bf16 v[32:35], v[64:67], v[52:55], v[32:35]
v_mfma_f32_16x16x32_bf16 v[32:35], v[112:115], v[76:79], v[32:35]
v_mfma_f32_16x16x32_bf16 v[36:39], v[64:67], v[76:79], v[36:39]
v_mfma_f32_16x16x32_bf16 v[36:39], v[112:115], v[80:83], v[36:39]
v_mfma_f32_16x16x32_bf16 v[40:43], v[64:67], v[80:83], v[40:43]
s_waitcnt lgkmcnt(7)
v_mfma_f32_16x16x32_bf16 v[40:43], v[112:115], v[128:131], v[40:43]
v_mfma_f32_16x16x32_bf16 v[44:47], v[64:67], v[128:131], v[44:47]
ds_read_b64_tr_b16 v[64:65], v12 offset:45056
s_waitcnt lgkmcnt(7)
v_mfma_f32_16x16x32_bf16 v[44:47], v[112:115], v[116:119], v[44:47]
ds_read_b64_tr_b16 v[66:67], v12 offset:45568
s_waitcnt lgkmcnt(6)
v_mfma_f32_16x16x32_bf16 v[16:19], v[60:63], v[104:107], v[16:19]
ds_read_b128 v[104:107], v6 offset:33280
s_waitcnt lgkmcnt(5)
v_mfma_f32_16x16x32_bf16 v[16:19], v[144:147], v[124:127], v[16:19]
ds_read_b128 v[112:115], v6 offset:35840
v_mfma_f32_16x16x32_bf16 v[20:23], v[60:63], v[124:127], v[20:23]
ds_read_b64_tr_b16 v[124:125], v12 offset:49152
v_mfma_f32_16x16x32_bf16 v[20:23], v[144:147], v[52:55], v[20:23]
ds_read_b64_tr_b16 v[126:127], v12 offset:49664
v_mfma_f32_16x16x32_bf16 v[24:27], v[60:63], v[52:55], v[24:27]
ds_read_b64_tr_b16 v[160:161], v12 offset:53248
v_mfma_f32_16x16x32_bf16 v[24:27], v[144:147], v[76:79], v[24:27]
ds_read_b64_tr_b16 v[162:163], v12 offset:53760
v_mfma_f32_16x16x32_bf16 v[28:31], v[60:63], v[76:79], v[28:31]
v_mfma_f32_16x16x32_bf16 v[28:31], v[144:147], v[80:83], v[28:31]
v_mfma_f32_16x16x32_bf16 v[32:35], v[60:63], v[80:83], v[32:35]
v_mfma_f32_16x16x32_bf16 v[32:35], v[144:147], v[128:131], v[32:35]
ds_read_b64_tr_b16 v[164:165], v12 offset:57344
v_mfma_f32_16x16x32_bf16 v[36:39], v[60:63], v[128:131], v[36:39]
ds_read_b64_tr_b16 v[166:167], v12 offset:57856
v_mfma_f32_16x16x32_bf16 v[36:39], v[144:147], v[116:119], v[36:39]
v_mfma_f32_16x16x32_bf16 v[40:43], v[60:63], v[116:119], v[40:43]
s_waitcnt lgkmcnt(7)
v_mfma_f32_16x16x32_bf16 v[40:43], v[144:147], v[104:107], v[40:43]
v_mfma_f32_16x16x32_bf16 v[44:47], v[60:63], v[104:107], v[44:47]
s_waitcnt lgkmcnt(6)
v_mfma_f32_16x16x32_bf16 v[44:47], v[144:147], v[112:115], v[44:47]
ds_read_b128 v[60:63], v6 offset:38400
s_waitcnt lgkmcnt(5)
v_mfma_f32_16x16x32_bf16 v[16:19], v[124:127], v[52:55], v[16:19]
s_waitcnt lgkmcnt(3)
v_mfma_f32_16x16x32_bf16 v[16:19], v[160:163], v[76:79], v[16:19]
ds_read_b128 v[52:55], v8 offset:20480
v_mfma_f32_16x16x32_bf16 v[20:23], v[124:127], v[76:79], v[20:23]
s_barrier
ds_read_b64_tr_b16 v[76:77], v12 offset:61440
v_mfma_f32_16x16x32_bf16 v[20:23], v[160:163], v[80:83], v[20:23]
ds_read_b64_tr_b16 v[78:79], v12 offset:61952
v_mfma_f32_16x16x32_bf16 v[24:27], v[124:127], v[80:83], v[24:27]
ds_read_b64_tr_b16 v[144:145], v13 offset:0
v_mfma_f32_16x16x32_bf16 v[24:27], v[160:163], v[128:131], v[24:27]
ds_read_b64_tr_b16 v[146:147], v13 offset:512
v_mfma_f32_16x16x32_bf16 v[28:31], v[124:127], v[128:131], v[28:31]
ds_read_b64_tr_b16 v[168:169], v13 offset:4096
v_mfma_f32_16x16x32_bf16 v[28:31], v[160:163], v[116:119], v[28:31]
ds_read_b64_tr_b16 v[170:171], v13 offset:4608
v_mfma_f32_16x16x32_bf16 v[32:35], v[124:127], v[116:119], v[32:35]
L_pgc_1:
s_cbranch_scc1 L_ret
v_mfma_f32_16x16x32_bf16 v[32:35], v[160:163], v[104:107], v[32:35]
v_mfma_f32_16x16x32_bf16 v[36:39], v[124:127], v[104:107], v[36:39]
v_mfma_f32_16x16x32_bf16 v[36:39], v[160:163], v[112:115], v[36:39]
v_mfma_f32_16x16x32_bf16 v[40:43], v[124:127], v[112:115], v[40:43]
s_waitcnt lgkmcnt(7)
v_mfma_f32_16x16x32_bf16 v[40:43], v[160:163], v[60:63], v[40:43]
v_mfma_f32_16x16x32_bf16 v[44:47], v[124:127], v[60:63], v[44:47]
s_waitcnt lgkmcnt(6)
v_mfma_f32_16x16x32_bf16 v[44:47], v[160:163], v[52:55], v[44:47]
ds_read_b128 v[124:127], v8 offset:23040
s_waitcnt lgkmcnt(5)
v_mfma_f32_16x16x32_bf16 v[16:19], v[76:79], v[80:83], v[16:19]
ds_read_b64_tr_b16 v[80:81], v13 offset:8192
s_waitcnt lgkmcnt(4)
v_mfma_f32_16x16x32_bf16 v[16:19], v[144:147], v[128:131], v[16:19]
ds_read_b64_tr_b16 v[82:83], v13 offset:8704
v_mfma_f32_16x16x32_bf16 v[20:23], v[76:79], v[128:131], v[20:23]
ds_read_b128 v[128:131], v8 offset:25600
v_mfma_f32_16x16x32_bf16 v[20:23], v[144:147], v[116:119], v[20:23]
ds_read_b64_tr_b16 v[160:161], v13 offset:12288
v_mfma_f32_16x16x32_bf16 v[24:27], v[76:79], v[116:119], v[24:27]
ds_read_b64_tr_b16 v[162:163], v13 offset:12800
v_mfma_f32_16x16x32_bf16 v[24:27], v[144:147], v[104:107], v[24:27]
ds_read_b64_tr_b16 v[172:173], v13 offset:16384
v_mfma_f32_16x16x32_bf16 v[28:31], v[76:79], v[104:107], v[28:31]
ds_read_b64_tr_b16 v[174:175], v13 offset:16896
v_mfma_f32_16x16x32_bf16 v[28:31], v[144:147], v[112:115], v[28:31]
v_mfma_f32_16x16x32_bf16 v[32:35], v[76:79], v[112:115], v[32:35]
v_mfma_f32_16x16x32_bf16 v[32:35], v[144:147], v[60:63], v[32:35]
v_mfma_f32_16x16x32_bf16 v[36:39], v[76:79], v[60:63], v[36:39]
v_mfma_f32_16x16x32_bf16 v[36:39], v[144:147], v[52:55], v[36:39]
ds_read_b64_tr_b16 v[176:177], v13 offset:20480
s_cmp_eq_u32 s37, 1
s_cbranch_scc1 L_fin1
s_cmp_eq_u32 s37, 2
s_cbranch_scc1 L_fin2
s_cmp_eq_u32 s37, 3
s_cbranch_scc1 L_fin3
L_fin0:
v_mfma_f32_16x16x32_bf16 v[40:43], v[76:79], v[52:55], v[40:43]
ds_read_b64_tr_b16 v[178:179], v13 offset:20992
s_waitcnt lgkmcnt(9)
v_mfma_f32_16x16x32_bf16 v[40:43], v[144:147], v[124:127], v[40:43]
ds_read_b128 v[180:183], v8 offset:28160
v_mfma_f32_16x16x32_bf16 v[44:47], v[76:79], v[124:127], v[44:47]
ds_read_b128 v[76:79], v8 offset:30720
s_waitcnt lgkmcnt(8)
v_mfma_f32_16x16x32_bf16 v[44:47], v[144:147], v[128:131], v[44:47]
ds_read_b64_tr_b16 v[144:145], v13 offset:24576
s_waitcnt lgkmcnt(7)
v_mfma_f32_16x16x32_bf16 v[24:27], v[160:163], v[112:115], v[24:27]
ds_read_b64_tr_b16 v[146:147], v13 offset:25088
s_waitcnt lgkmcnt(6)
v_mfma_f32_16x16x32_bf16 v[24:27], v[172:175], v[60:63], v[24:27]
ds_read_b64_tr_b16 v[116:117], v13 offset:28672
v_mfma_f32_16x16x32_bf16 v[28:31], v[160:163], v[60:63], v[28:31]
ds_read_b64_tr_b16 v[118:119], v13 offset:29184
v_mfma_f32_16x16x32_bf16 v[28:31], v[172:175], v[52:55], v[28:31]
v_mfma_f32_16x16x32_bf16 v[32:35], v[160:163], v[52:55], v[32:35]
v_mfma_f32_16x16x32_bf16 v[32:35], v[172:175], v[124:127], v[32:35]
v_mfma_f32_16x16x32_bf16 v[36:39], v[160:163], v[124:127], v[36:39]
s_waitcnt lgkmcnt(6)
s_barrier
ds_read_b64_tr_b16 v[104:105], v13 offset:32768
v_mfma_f32_16x16x32_bf16 v[36:39], v[172:175], v[128:131], v[36:39]
ds_read_b64_tr_b16 v[106:107], v13 offset:33280
v_mfma_f32_16x16x32_bf16 v[40:43], v[160:163], v[128:131], v[40:43]
ds_read_b128 v[184:187], v8 offset:33280
s_waitcnt lgkmcnt(8)
v_mfma_f32_16x16x32_bf16 v[40:43], v[172:175], v[180:183], v[40:43]
ds_read_b128 v[188:191], v8 offset:35840
v_mfma_f32_16x16x32_bf16 v[44:47], v[160:163], v[180:183], v[44:47]
ds_read_b64_tr_b16 v[192:193], v13 offset:36864
s_waitcnt lgkmcnt(9)
v_mfma_f32_16x16x32_bf16 v[44:47], v[172:175], v[76:79], v[44:47]
ds_read_b64_tr_b16 v[194:195], v13 offset:37376
s_waitcnt lgkmcnt(8)
v_mfma_f32_16x16x32_bf16 v[24:27], v[144:147], v[52:55], v[24:27]
ds_read_b64_tr_b16 v[112:113], v13 offset:40960
s_waitcnt lgkmcnt(7)
v_mfma_f32_16x16x32_bf16 v[24:27], v[116:119], v[124:127], v[24:27]
ds_read_b64_tr_b16 v[114:115], v13 offset:41472
v_mfma_f32_16x16x32_bf16 v[28:31], v[144:147], v[124:127], v[28:31]
v_mfma_f32_16x16x32_bf16 v[28:31], v[116:119], v[128:131], v[28:31]
v_mfma_f32_16x16x32_bf16 v[32:35], v[144:147], v[128:131], v[32:35]
v_mfma_f32_16x16x32_bf16 v[32:35], v[116:119], v[180:183], v[32:35]
ds_read_b64_tr_b16 v[60:61], v13 offset:45056
v_mfma_f32_16x16x32_bf16 v[36:39], v[144:147], v[180:183], v[36:39]
ds_read_b64_tr_b16 v[62:63], v13 offset:45568
v_mfma_f32_16x16x32_bf16 v[36:39], v[116:119], v[76:79], v[36:39]
ds_read_b128 v[196:199], v8 offset:38400
v_mfma_f32_16x16x32_bf16 v[40:43], v[144:147], v[76:79], v[40:43]
s_waitcnt lgkmcnt(8)
v_mfma_f32_16x16x32_bf16 v[40:43], v[116:119], v[184:187], v[40:43]
ds_read_b128 v[200:203], v10 offset:20480
v_mfma_f32_16x16x32_bf16 v[44:47], v[144:147], v[184:187], v[44:47]
ds_read_b64_tr_b16 v[204:205], v12 offset:0
s_waitcnt lgkmcnt(9)
v_mfma_f32_16x16x32_bf16 v[44:47], v[116:119], v[188:191], v[44:47]
ds_read_b64_tr_b16 v[206:207], v12 offset:512
s_waitcnt lgkmcnt(8)
v_mfma_f32_16x16x32_bf16 v[24:27], v[192:195], v[128:131], v[24:27]
ds_read_b64_tr_b16 v[52:53], v12 offset:4096
s_waitcnt lgkmcnt(7)
v_mfma_f32_16x16x32_bf16 v[24:27], v[112:115], v[180:183], v[24:27]
ds_read_b64_tr_b16 v[54:55], v12 offset:4608
v_mfma_f32_16x16x32_bf16 v[28:31], v[192:195], v[180:183], v[28:31]
v_mfma_f32_16x16x32_bf16 v[28:31], v[112:115], v[76:79], v[28:31]
v_mfma_f32_16x16x32_bf16 v[32:35], v[192:195], v[76:79], v[32:35]
ds_read_b64_tr_b16 v[124:125], v12 offset:8192
v_mfma_f32_16x16x32_bf16 v[32:35], v[112:115], v[184:187], v[32:35]
ds_read_b64_tr_b16 v[126:127], v12 offset:8704
v_mfma_f32_16x16x32_bf16 v[36:39], v[192:195], v[184:187], v[36:39]
v_mfma_f32_16x16x32_bf16 v[36:39], v[112:115], v[188:191], v[36:39]
ds_read_b128 v[208:211], v10 offset:23040
v_mfma_f32_16x16x32_bf16 v[40:43], v[192:195], v[188:191], v[40:43]
s_waitcnt lgkmcnt(8)
v_mfma_f32_16x16x32_bf16 v[40:43], v[112:115], v[196:199], v[40:43]
ds_read_b128 v[212:215], v10 offset:25600
v_mfma_f32_16x16x32_bf16 v[44:47], v[192:195], v[196:199], v[44:47]
ds_read_b64_tr_b16 v[216:217], v12 offset:12288
s_waitcnt lgkmcnt(9)
v_mfma_f32_16x16x32_bf16 v[44:47], v[112:115], v[200:203], v[44:47]
ds_read_b64_tr_b16 v[218:219], v12 offset:12800
s_waitcnt lgkmcnt(8)
v_mfma_f32_16x16x32_bf16 v[24:27], v[204:207], v[76:79], v[24:27]
ds_read_b64_tr_b16 v[76:77], v12 offset:16384
s_waitcnt lgkmcnt(7)
v_mfma_f32_16x16x32_bf16 v[24:27], v[52:55], v[184:187], v[24:27]
ds_read_b64_tr_b16 v[78:79], v12 offset:16896
v_mfma_f32_16x16x32_bf16 v[28:31], v[204:207], v[184:187], v[28:31]
v_mfma_f32_16x16x32_bf16 v[28:31], v[52:55], v[188:191], v[28:31]
v_mfma_f32_16x16x32_bf16 v[32:35], v[204:207], v[188:191], v[32:35]
s_waitcnt lgkmcnt(6)
s_barrier
ds_read_b64_tr_b16 v[128:129], v12 offset:20480
v_mfma_f32_16x16x32_bf16 v[32:35], v[52:55], v[196:199], v[32:35]
ds_read_b64_tr_b16 v[130:131], v12 offset:20992
v_mfma_f32_16x16x32_bf16 v[36:39], v[204:207], v[196:199], v[36:39]
v_mfma_f32_16x16x32_bf16 v[36:39], v[52:55], v[200:203], v[36:39]
ds_read_b128 v[180:183], v10 offset:28160
v_mfma_f32_16x16x32_bf16 v[40:43], v[204:207], v[200:203], v[40:43]
s_waitcnt lgkmcnt(8)
v_mfma_f32_16x16x32_bf16 v[40:43], v[52:55], v[208:211], v[40:43]
ds_read_b128 v[184:187], v10 offset:30720
v_mfma_f32_16x16x32_bf16 v[44:47], v[204:207], v[208:211], v[44:47]
ds_read_b64_tr_b16 v[220:221], v12 offset:24576
s_waitcnt lgkmcnt(9)
v_mfma_f32_16x16x32_bf16 v[44:47], v[52:55], v[212:215], v[44:47]
ds_read_b64_tr_b16 v[222:223], v12 offset:25088
s_waitcnt lgkmcnt(8)
v_mfma_f32_16x16x32_bf16 v[24:27], v[216:219], v[188:191], v[24:27]
s_waitcnt lgkmcnt(6)
v_mfma_f32_16x16x32_bf16 v[24:27], v[76:79], v[196:199], v[24:27]
v_mfma_f32_16x16x32_bf16 v[28:31], v[216:219], v[196:199], v[28:31]
v_mfma_f32_16x16x32_bf16 v[28:31], v[76:79], v[200:203], v[28:31]
ds_read_b64_tr_b16 v[188:189], v12 offset:28672
v_mfma_f32_16x16x32_bf16 v[32:35], v[216:219], v[200:203], v[32:35]
ds_read_b64_tr_b16 v[190:191], v12 offset:29184
v_mfma_f32_16x16x32_bf16 v[32:35], v[76:79], v[208:211], v[32:35]
ds_read_b128 v[196:199], v10 offset:33280
v_mfma_f32_16x16x32_bf16 v[36:39], v[216:219], v[208:211], v[36:39]
ds_read_b128 v[224:227], v3 offset:30720
v_mfma_f32_16x16x32_bf16 v[36:39], v[76:79], v[212:215], v[36:39]
ds_read_b128 v[228:231], v3 offset:33280
v_mfma_f32_16x16x32_bf16 v[40:43], v[216:219], v[212:215], v[40:43]
ds_read_b128 v[232:235], v3 offset:35840
s_waitcnt lgkmcnt(9)
v_mfma_f32_16x16x32_bf16 v[40:43], v[76:79], v[180:183], v[40:43]
ds_read_b128 v[236:239], v3 offset:38400
v_mfma_f32_16x16x32_bf16 v[44:47], v[216:219], v[180:183], v[44:47]
s_waitcnt lgkmcnt(9)
v_mfma_f32_16x16x32_bf16 v[44:47], v[76:79], v[184:187], v[44:47]
ds_read_b128 v[240:243], v5 offset:20480
s_waitcnt lgkmcnt(8)
v_mfma_f32_16x16x32_bf16 v[24:27], v[220:223], v[200:203], v[24:27]
v_mfma_f32_16x16x32_bf16 v[28:31], v[220:223], v[208:211], v[28:31]
ds_read_b128 v[200:203], v5 offset:23040
v_mfma_f32_16x16x32_bf16 v[32:35], v[220:223], v[212:215], v[32:35]
ds_read_b64_tr_b16 v[208:209], v12 offset:32768
v_mfma_f32_16x16x32_bf16 v[36:39], v[220:223], v[180:183], v[36:39]
ds_read_b64_tr_b16 v[210:211], v12 offset:33280
v_mfma_f32_16x16x32_bf16 v[40:43], v[220:223], v[184:187], v[40:43]
ds_read_b128 v[180:183], v5 offset:25600
s_waitcnt lgkmcnt(9)
v_mfma_f32_16x16x32_bf16 v[44:47], v[220:223], v[196:199], v[44:47]
ds_read_b128 v[184:187], v5 offset:28160
s_waitcnt lgkmcnt(9)
v_mfma_f32_16x16x32_bf16 v[32:35], v[72:75], v[224:227], v[32:35]
s_waitcnt lgkmcnt(8)
v_mfma_f32_16x16x32_bf16 v[32:35], v[96:99], v[228:231], v[32:35]
ds_read_b128 v[196:199], v5 offset:30720
v_mfma_f32_16x16x32_bf16 v[36:39], v[72:75], v[228:231], v[36:39]
s_waitcnt lgkmcnt(8)
v_mfma_f32_16x16x32_bf16 v[36:39], v[96:99], v[232:235], v[36:39]
ds_read_b128 v[212:215], v5 offset:33280
v_mfma_f32_16x16x32_bf16 v[32:35], v[100:103], v[232:235], v[32:35]
s_waitcnt lgkmcnt(8)
v_mfma_f32_16x16x32_bf16 v[32:35], v[92:95], v[236:239], v[32:35]
ds_read_b128 v[224:227], v5 offset:35840
v_mfma_f32_16x16x32_bf16 v[36:39], v[100:103], v[236:239], v[36:39]
s_waitcnt lgkmcnt(8)
v_mfma_f32_16x16x32_bf16 v[36:39], v[92:95], v[240:243], v[36:39]
s_waitcnt lgkmcnt(5)
s_barrier
ds_read_b64_tr_b16 v[228:229], v12 offset:36864
v_mfma_f32_16x16x32_bf16 v[32:35], v[120:123], v[240:243], v[32:35]
ds_read_b64_tr_b16 v[230:231], v12 offset:37376
v_mfma_f32_16x16x32_bf16 v[32:35], v[132:135], v[200:203], v[32:35]
ds_read_b128 v[232:235], v5 offset:38400
v_mfma_f32_16x16x32_bf16 v[36:39], v[120:123], v[200:203], v[36:39]
ds_read_b128 v[200:203], v7 offset:20480
s_waitcnt lgkmcnt(8)
v_mfma_f32_16x16x32_bf16 v[36:39], v[132:135], v[180:183], v[36:39]
ds_read_b128 v[236:239], v7 offset:23040
v_mfma_f32_16x16x32_bf16 v[32:35], v[84:87], v[180:183], v[32:35]
s_waitcnt lgkmcnt(8)
v_mfma_f32_16x16x32_bf16 v[32:35], v[48:51], v[184:187], v[32:35]
ds_read_b128 v[180:183], v7 offset:25600
v_mfma_f32_16x16x32_bf16 v[36:39], v[84:87], v[184:187], v[36:39]
s_waitcnt lgkmcnt(8)
v_mfma_f32_16x16x32_bf16 v[36:39], v[48:51], v[196:199], v[36:39]
ds_read_b128 v[184:187], v7 offset:28160
v_mfma_f32_16x16x32_bf16 v[32:35], v[88:91], v[196:199], v[32:35]
s_waitcnt lgkmcnt(8)
v_mfma_f32_16x16x32_bf16 v[32:35], v[108:111], v[212:215], v[32:35]
ds_read_b128 v[196:199], v7 offset:30720
v_mfma_f32_16x16x32_bf16 v[36:39], v[88:91], v[212:215], v[36:39]
ds_read_b64_tr_b16 v[212:213], v12 offset:40960
s_waitcnt lgkmcnt(9)
v_mfma_f32_16x16x32_bf16 v[36:39], v[108:111], v[224:227], v[36:39]
ds_read_b64_tr_b16 v[214:215], v12 offset:41472
v_mfma_f32_16x16x32_bf16 v[32:35], v[68:71], v[224:227], v[32:35]
ds_read_b128 v[224:227], v7 offset:33280
s_waitcnt lgkmcnt(8)
v_mfma_f32_16x16x32_bf16 v[32:35], v[136:139], v[232:235], v[32:35]
ds_read_b128 v[240:243], v7 offset:35840
v_mfma_f32_16x16x32_bf16 v[36:39], v[68:71], v[232:235], v[36:39]
s_waitcnt lgkmcnt(8)
v_mfma_f32_16x16x32_bf16 v[36:39], v[136:139], v[200:203], v[36:39]
ds_read_b128 v[232:235], v7 offset:38400
v_mfma_f32_16x16x32_bf16 v[32:35], v[140:143], v[200:203], v[32:35]
s_waitcnt lgkmcnt(8)
v_mfma_f32_16x16x32_bf16 v[32:35], v[56:59], v[236:239], v[32:35]
ds_read_b128 v[200:203], v9 offset:20480
v_mfma_f32_16x16x32_bf16 v[36:39], v[140:143], v[236:239], v[36:39]
s_waitcnt lgkmcnt(8)
v_mfma_f32_16x16x32_bf16 v[36:39], v[56:59], v[180:183], v[36:39]
ds_read_b128 v[236:239], v9 offset:23040
v_mfma_f32_16x16x32_bf16 v[32:35], v[148:151], v[180:183], v[32:35]
s_waitcnt lgkmcnt(8)
v_mfma_f32_16x16x32_bf16 v[32:35], v[152:155], v[184:187], v[32:35]
ds_read_b128 v[180:183], v9 offset:25600
v_mfma_f32_16x16x32_bf16 v[36:39], v[148:151], v[184:187], v[36:39]
ds_read_b64_tr_b16 v[184:185], v12 offset:45056
s_waitcnt lgkmcnt(9)
v_mfma_f32_16x16x32_bf16 v[36:39], v[152:155], v[196:199], v[36:39]
ds_read_b64_tr_b16 v[186:187], v12 offset:45568
v_mfma_f32_16x16x32_bf16 v[32:35], v[156:159], v[196:199], v[32:35]
ds_read_b128 v[196:199], v9 offset:28160
s_waitcnt lgkmcnt(8)
v_mfma_f32_16x16x32_bf16 v[32:35], v[64:67], v[224:227], v[32:35]
ds_read_b128 v[244:247], v9 offset:30720
v_mfma_f32_16x16x32_bf16 v[36:39], v[156:159], v[224:227], v[36:39]
s_waitcnt lgkmcnt(8)
v_mfma_f32_16x16x32_bf16 v[36:39], v[64:67], v[240:243], v[36:39]
ds_read_b128 v[224:227], v9 offset:33280
v_mfma_f32_16x16x32_bf16 v[32:35], v[164:167], v[240:243], v[32:35]
s_waitcnt lgkmcnt(8)
v_mfma_f32_16x16x32_bf16 v[32:35], v[168:171], v[232:235], v[32:35]
ds_read_b128 v[240:243], v9 offset:35840
v_mfma_f32_16x16x32_bf16 v[36:39], v[164:167], v[232:235], v[36:39]
s_waitcnt lgkmcnt(8)
v_mfma_f32_16x16x32_bf16 v[36:39], v[168:171], v[200:203], v[36:39]
ds_read_b128 v[232:235], v9 offset:38400
v_mfma_f32_16x16x32_bf16 v[32:35], v[80:83], v[200:203], v[32:35]
s_waitcnt lgkmcnt(8)
v_mfma_f32_16x16x32_bf16 v[32:35], v[176:179], v[236:239], v[32:35]
ds_read_b128 v[200:203], v11 offset:20480
v_mfma_f32_16x16x32_bf16 v[36:39], v[80:83], v[236:239], v[36:39]
s_waitcnt lgkmcnt(8)
v_mfma_f32_16x16x32_bf16 v[36:39], v[176:179], v[180:183], v[36:39]
ds_read_b128 v[236:239], v11 offset:23040
v_mfma_f32_16x16x32_bf16 v[32:35], v[104:107], v[180:183], v[32:35]
s_waitcnt lgkmcnt(6)
v_mfma_f32_16x16x32_bf16 v[32:35], v[60:63], v[196:199], v[32:35]
ds_read_b128 v[180:183], v11 offset:25600
v_mfma_f32_16x16x32_bf16 v[36:39], v[104:107], v[196:199], v[36:39]
s_waitcnt lgkmcnt(6)
v_mfma_f32_16x16x32_bf16 v[36:39], v[60:63], v[244:247], v[36:39]
ds_read_b128 v[196:199], v11 offset:28160
v_mfma_f32_16x16x32_bf16 v[32:35], v[124:127], v[244:247], v[32:35]
ds_read_b128 v[244:247], v3 offset:35840
s_waitcnt lgkmcnt(7)
v_mfma_f32_16x16x32_bf16 v[32:35], v[128:131], v[224:227], v[32:35]
ds_read_b128 v[248:251], v3 offset:38400
v_mfma_f32_16x16x32_bf16 v[36:39], v[124:127], v[224:227], v[36:39]
s_waitcnt lgkmcnt(7)
v_mfma_f32_16x16x32_bf16 v[36:39], v[128:131], v[240:243], v[36:39]
ds_read_b128 v[224:227], v5 offset:20480
v_mfma_f32_16x16x32_bf16 v[32:35], v[188:191], v[240:243], v[32:35]
s_waitcnt lgkmcnt(7)
v_mfma_f32_16x16x32_bf16 v[32:35], v[208:211], v[232:235], v[32:35]
ds_read_b128 v[240:243], v5 offset:23040
v_mfma_f32_16x16x32_bf16 v[36:39], v[188:191], v[232:235], v[36:39]
s_waitcnt lgkmcnt(7)
v_mfma_f32_16x16x32_bf16 v[36:39], v[208:211], v[200:203], v[36:39]
ds_read_b128 v[232:235], v5 offset:25600
v_mfma_f32_16x16x32_bf16 v[32:35], v[228:231], v[200:203], v[32:35]
s_waitcnt lgkmcnt(7)
v_mfma_f32_16x16x32_bf16 v[32:35], v[212:215], v[236:239], v[32:35]
ds_read_b128 v[200:203], v5 offset:28160
v_mfma_f32_16x16x32_bf16 v[36:39], v[228:231], v[236:239], v[36:39]
s_waitcnt lgkmcnt(7)
v_mfma_f32_16x16x32_bf16 v[36:39], v[212:215], v[180:183], v[36:39]
ds_read_b128 v[236:239], v5 offset:30720
v_mfma_f32_16x16x32_bf16 v[32:35], v[184:187], v[180:183], v[32:35]
s_waitcnt lgkmcnt(7)
v_mfma_f32_16x16x32_bf16 v[36:39], v[184:187], v[196:199], v[36:39]
ds_read_b128 v[180:183], v5 offset:33280
s_waitcnt lgkmcnt(7)
v_mfma_f32_16x16x32_bf16 v[40:43], v[72:75], v[244:247], v[40:43]
s_waitcnt lgkmcnt(6)
v_mfma_f32_16x16x32_bf16 v[40:43], v[96:99], v[248:251], v[40:43]
ds_read_b128 v[196:199], v5 offset:35840
v_mfma_f32_16x16x32_bf16 v[44:47], v[72:75], v[248:251], v[44:47]
s_waitcnt lgkmcnt(6)
v_mfma_f32_16x16x32_bf16 v[44:47], v[96:99], v[224:227], v[44:47]
ds_read_b128 v[244:247], v5 offset:38400
v_mfma_f32_16x16x32_bf16 v[40:43], v[100:103], v[224:227], v[40:43]
s_add_u32 s40, s44, 24576
s_waitcnt lgkmcnt(6)
v_mfma_f32_16x16x32_bf16 v[40:43], v[92:95], v[240:243], v[40:43]
ds_read_b128 v[224:227], v7 offset:20480
v_cvt_pk_bf16_f32 v32, v32, v33
v_mfma_f32_16x16x32_bf16 v[44:47], v[100:103], v[240:243], v[44:47]
v_cvt_pk_bf16_f32 v33, v34, v35
v_cvt_pk_bf16_f32 v34, v36, v37
s_waitcnt lgkmcnt(6)
v_mfma_f32_16x16x32_bf16 v[44:47], v[92:95], v[232:235], v[44:47]
v_cvt_pk_bf16_f32 v35, v38, v39
v_min_u32 v32, 0xfffffffe, v32
v_mfma_f32_16x16x32_bf16 v[40:43], v[120:123], v[232:235], v[40:43]
v_min_u32 v33, 0xfffffffe, v33
v_min_u32 v34, 0xfffffffe, v34
s_waitcnt lgkmcnt(5)
v_mfma_f32_16x16x32_bf16 v[40:43], v[132:135], v[200:203], v[40:43]
v_min_u32 v35, 0xfffffffe, v35
buffer_store_dwordx4 v[32:35], v14, s[28:31], s40 offen sc1
v_mfma_f32_16x16x32_bf16 v[44:47], v[120:123], v[200:203], v[44:47]
ds_read_b128 v[200:203], v7 offset:23040
ds_read_b128 v[232:235], v7 offset:25600
s_waitcnt lgkmcnt(6)
v_mfma_f32_16x16x32_bf16 v[44:47], v[132:135], v[236:239], v[44:47]
ds_read_b128 v[240:243], v7 offset:28160
v_mfma_f32_16x16x32_bf16 v[40:43], v[84:87], v[236:239], v[40:43]
s_waitcnt lgkmcnt(6)
v_mfma_f32_16x16x32_bf16 v[40:43], v[48:51], v[180:183], v[40:43]
ds_read_b128 v[236:239], v7 offset:30720
v_mfma_f32_16x16x32_bf16 v[44:47], v[84:87], v[180:183], v[44:47]
s_waitcnt lgkmcnt(6)
v_mfma_f32_16x16x32_bf16 v[44:47], v[48:51], v[196:199], v[44:47]
ds_read_b128 v[180:183], v7 offset:33280
v_mfma_f32_16x16x32_bf16 v[40:43], v[88:91], v[196:199], v[40:43]
s_waitcnt lgkmcnt(6)
v_mfma_f32_16x16x32_bf16 v[40:43], v[108:111], v[244:247], v[40:43]
ds_read_b128 v[196:199], v7 offset:35840
v_mfma_f32_16x16x32_bf16 v[44:47], v[88:91], v[244:247], v[44:47]
s_waitcnt lgkmcnt(6)
v_mfma_f32_16x16x32_bf16 v[44:47], v[108:111], v[224:227], v[44:47]
ds_read_b128 v[244:247], v7 offset:38400
v_mfma_f32_16x16x32_bf16 v[40:43], v[68:71], v[224:227], v[40:43]
s_waitcnt lgkmcnt(6)
v_mfma_f32_16x16x32_bf16 v[40:43], v[136:139], v[200:203], v[40:43]
ds_read_b128 v[224:227], v9 offset:20480
v_mfma_f32_16x16x32_bf16 v[44:47], v[68:71], v[200:203], v[44:47]
s_waitcnt lgkmcnt(6)
v_mfma_f32_16x16x32_bf16 v[44:47], v[136:139], v[232:235], v[44:47]
ds_read_b128 v[200:203], v9 offset:23040
v_mfma_f32_16x16x32_bf16 v[40:43], v[140:143], v[232:235], v[40:43]
s_waitcnt lgkmcnt(6)
v_mfma_f32_16x16x32_bf16 v[40:43], v[56:59], v[240:243], v[40:43]
ds_read_b128 v[232:235], v9 offset:25600
v_mfma_f32_16x16x32_bf16 v[44:47], v[140:143], v[240:243], v[44:47]
s_waitcnt lgkmcnt(6)
v_mfma_f32_16x16x32_bf16 v[44:47], v[56:59], v[236:239], v[44:47]
ds_read_b128 v[240:243], v9 offset:28160
v_mfma_f32_16x16x32_bf16 v[40:43], v[148:151], v[236:239], v[40:43]
s_waitcnt lgkmcnt(6)
v_mfma_f32_16x16x32_bf16 v[40:43], v[152:155], v[180:183], v[40:43]
ds_read_b128 v[236:239], v9 offset:30720
v_mfma_f32_16x16x32_bf16 v[44:47], v[148:151], v[180:183], v[44:47]
s_waitcnt lgkmcnt(6)
v_mfma_f32_16x16x32_bf16 v[44:47], v[152:155], v[196:199], v[44:47]
ds_read_b128 v[180:183], v9 offset:33280
v_mfma_f32_16x16x32_bf16 v[40:43], v[156:159], v[196:199], v[40:43]
s_waitcnt lgkmcnt(6)
v_mfma_f32_16x16x32_bf16 v[40:43], v[64:67], v[244:247], v[40:43]
ds_read_b128 v[196:199], v9 offset:35840
v_mfma_f32_16x16x32_bf16 v[44:47], v[156:159], v[244:247], v[44:47]
s_waitcnt lgkmcnt(6)
v_mfma_f32_16x16x32_bf16 v[44:47], v[64:67], v[224:227], v[44:47]
ds_read_b128 v[244:247], v9 offset:38400
v_mfma_f32_16x16x32_bf16 v[40:43], v[164:167], v[224:227], v[40:43]
s_waitcnt lgkmcnt(6)
v_mfma_f32_16x16x32_bf16 v[40:43], v[168:171], v[200:203], v[40:43]
ds_read_b128 v[224:227], v11 offset:20480
v_mfma_f32_16x16x32_bf16 v[44:47], v[164:167], v[200:203], v[44:47]
s_waitcnt lgkmcnt(6)
v_mfma_f32_16x16x32_bf16 v[44:47], v[168:171], v[232:235], v[44:47]
ds_read_b128 v[200:203], v11 offset:23040
v_mfma_f32_16x16x32_bf16 v[40:43], v[80:83], v[232:235], v[40:43]
s_barrier
s_waitcnt lgkmcnt(6)
v_mfma_f32_16x16x32_bf16 v[40:43], v[176:179], v[240:243], v[40:43]
ds_read_b128 v[232:235], v11 offset:25600
v_mfma_f32_16x16x32_bf16 v[44:47], v[80:83], v[240:243], v[44:47]
s_waitcnt lgkmcnt(6)
v_mfma_f32_16x16x32_bf16 v[44:47], v[176:179], v[236:239], v[44:47]
ds_read_b128 v[240:243], v11 offset:28160
v_mfma_f32_16x16x32_bf16 v[40:43], v[104:107], v[236:239], v[40:43]
s_waitcnt lgkmcnt(6)
v_mfma_f32_16x16x32_bf16 v[40:43], v[60:63], v[180:183], v[40:43]
ds_read_b128 v[236:239], v11 offset:30720
v_mfma_f32_16x16x32_bf16 v[44:47], v[104:107], v[180:183], v[44:47]
s_waitcnt lgkmcnt(6)
v_mfma_f32_16x16x32_bf16 v[44:47], v[60:63], v[196:199], v[44:47]
ds_read_b128 v[180:183], v11 offset:33280
v_mfma_f32_16x16x32_bf16 v[40:43], v[124:127], v[196:199], v[40:43]
ds_read_b128 v[196:199], v3 offset:25600
s_waitcnt lgkmcnt(7)
v_mfma_f32_16x16x32_bf16 v[40:43], v[128:131], v[244:247], v[40:43]
ds_read_b128 v[248:251], v3 offset:28160
v_mfma_f32_16x16x32_bf16 v[44:47], v[124:127], v[244:247], v[44:47]
s_waitcnt lgkmcnt(7)
v_mfma_f32_16x16x32_bf16 v[44:47], v[128:131], v[224:227], v[44:47]
ds_read_b128 v[244:247], v3 offset:30720
v_mfma_f32_16x16x32_bf16 v[40:43], v[188:191], v[224:227], v[40:43]
s_waitcnt lgkmcnt(7)
v_mfma_f32_16x16x32_bf16 v[40:43], v[208:211], v[200:203], v[40:43]
ds_read_b128 v[224:227], v3 offset:33280
v_mfma_f32_16x16x32_bf16 v[44:47], v[188:191], v[200:203], v[44:47]
s_waitcnt lgkmcnt(7)
v_mfma_f32_16x16x32_bf16 v[44:47], v[208:211], v[232:235], v[44:47]
ds_read_b128 v[200:203], v3 offset:35840
v_mfma_f32_16x16x32_bf16 v[40:43], v[228:231], v[232:235], v[40:43]
s_waitcnt lgkmcnt(7)
v_mfma_f32_16x16x32_bf16 v[40:43], v[212:215], v[240:243], v[40:43]
ds_read_b128 v[232:235], v3 offset:38400
v_mfma_f32_16x16x32_bf16 v[44:47], v[228:231], v[240:243], v[44:47]
s_waitcnt lgkmcnt(7)
v_mfma_f32_16x16x32_bf16 v[44:47], v[212:215], v[236:239], v[44:47]
ds_read_b128 v[240:243], v5 offset:20480
v_mfma_f32_16x16x32_bf16 v[40:43], v[184:187], v[236:239], v[40:43]
s_waitcnt lgkmcnt(7)
v_mfma_f32_16x16x32_bf16 v[44:47], v[184:187], v[180:183], v[44:47]
ds_read_b128 v[180:183], v5 offset:23040
s_waitcnt lgkmcnt(7)
v_mfma_f32_16x16x32_bf16 v[24:27], v[72:75], v[196:199], v[24:27]
s_waitcnt lgkmcnt(6)
v_mfma_f32_16x16x32_bf16 v[24:27], v[96:99], v[248:251], v[24:27]
ds_read_b128 v[196:199], v5 offset:25600
v_mfma_f32_16x16x32_bf16 v[28:31], v[72:75], v[248:251], v[28:31]
s_waitcnt lgkmcnt(6)
v_mfma_f32_16x16x32_bf16 v[28:31], v[96:99], v[244:247], v[28:31]
ds_read_b128 v[236:239], v5 offset:28160
v_mfma_f32_16x16x32_bf16 v[24:27], v[100:103], v[244:247], v[24:27]
s_add_u32 s40, s44, 40960
s_waitcnt lgkmcnt(6)
v_mfma_f32_16x16x32_bf16 v[24:27], v[92:95], v[224:227], v[24:27]
ds_read_b128 v[244:247], v5 offset:30720
v_cvt_pk_bf16_f32 v40, v40, v41
v_mfma_f32_16x16x32_bf16 v[28:31], v[100:103], v[224:227], v[28:31]
v_cvt_pk_bf16_f32 v41, v42, v43
v_cvt_pk_bf16_f32 v42, v44, v45
s_waitcnt lgkmcnt(6)
v_mfma_f32_16x16x32_bf16 v[28:31], v[92:95], v[200:203], v[28:31]
v_cvt_pk_bf16_f32 v43, v46, v47
v_min_u32 v40, 0xfffffffe, v40
v_mfma_f32_16x16x32_bf16 v[24:27], v[120:123], v[200:203], v[24:27]
v_min_u32 v41, 0xfffffffe, v41
v_min_u32 v42, 0xfffffffe, v42
s_waitcnt lgkmcnt(5)
v_mfma_f32_16x16x32_bf16 v[24:27], v[132:135], v[232:235], v[24:27]
v_min_u32 v43, 0xfffffffe, v43
buffer_store_dwordx4 v[40:43], v14, s[28:31], s40 offen sc1
v_mfma_f32_16x16x32_bf16 v[28:31], v[120:123], v[232:235], v[28:31]
ds_read_b128 v[200:203], v5 offset:33280
ds_read_b128 v[224:227], v5 offset:35840
s_waitcnt lgkmcnt(6)
v_mfma_f32_16x16x32_bf16 v[28:31], v[132:135], v[240:243], v[28:31]
ds_read_b128 v[232:235], v5 offset:38400
v_mfma_f32_16x16x32_bf16 v[24:27], v[84:87], v[240:243], v[24:27]
s_waitcnt lgkmcnt(6)
v_mfma_f32_16x16x32_bf16 v[24:27], v[48:51], v[180:183], v[24:27]
ds_read_b128 v[240:243], v7 offset:20480
v_mfma_f32_16x16x32_bf16 v[28:31], v[84:87], v[180:183], v[28:31]
s_waitcnt lgkmcnt(6)
v_mfma_f32_16x16x32_bf16 v[28:31], v[48:51], v[196:199], v[28:31]
ds_read_b128 v[180:183], v7 offset:23040
v_mfma_f32_16x16x32_bf16 v[24:27], v[88:91], v[196:199], v[24:27]
s_waitcnt lgkmcnt(6)
v_mfma_f32_16x16x32_bf16 v[24:27], v[108:111], v[236:239], v[24:27]
ds_read_b128 v[196:199], v7 offset:25600
v_mfma_f32_16x16x32_bf16 v[28:31], v[88:91], v[236:239], v[28:31]
s_waitcnt lgkmcnt(6)
v_mfma_f32_16x16x32_bf16 v[28:31], v[108:111], v[244:247], v[28:31]
ds_read_b128 v[236:239], v7 offset:28160
v_mfma_f32_16x16x32_bf16 v[24:27], v[68:71], v[244:247], v[24:27]
s_waitcnt lgkmcnt(6)
v_mfma_f32_16x16x32_bf16 v[24:27], v[136:139], v[200:203], v[24:27]
ds_read_b128 v[244:247], v7 offset:30720
v_mfma_f32_16x16x32_bf16 v[28:31], v[68:71], v[200:203], v[28:31]
s_waitcnt lgkmcnt(6)
v_mfma_f32_16x16x32_bf16 v[28:31], v[136:139], v[224:227], v[28:31]
ds_read_b128 v[200:203], v7 offset:33280
v_mfma_f32_16x16x32_bf16 v[24:27], v[140:143], v[224:227], v[24:27]
s_waitcnt lgkmcnt(6)
v_mfma_f32_16x16x32_bf16 v[24:27], v[56:59], v[232:235], v[24:27]
ds_read_b128 v[224:227], v7 offset:35840
v_mfma_f32_16x16x32_bf16 v[28:31], v[140:143], v[232:235], v[28:31]
s_waitcnt lgkmcnt(6)
v_mfma_f32_16x16x32_bf16 v[28:31], v[56:59], v[240:243], v[28:31]
ds_read_b128 v[232:235], v7 offset:38400
v_mfma_f32_16x16x32_bf16 v[24:27], v[148:151], v[240:243], v[24:27]
s_waitcnt lgkmcnt(6)
v_mfma_f32_16x16x32_bf16 v[24:27], v[152:155], v[180:183], v[24:27]
ds_read_b128 v[240:243], v9 offset:20480
v_mfma_f32_16x16x32_bf16 v[28:31], v[148:151], v[180:183], v[28:31]
s_waitcnt lgkmcnt(6)
v_mfma_f32_16x16x32_bf16 v[28:31], v[152:155], v[196:199], v[28:31]
ds_read_b128 v[180:183], v9 offset:23040
v_mfma_f32_16x16x32_bf16 v[24:27], v[156:159], v[196:199], v[24:27]
s_waitcnt lgkmcnt(6)
v_mfma_f32_16x16x32_bf16 v[24:27], v[64:67], v[236:239], v[24:27]
ds_read_b128 v[196:199], v9 offset:25600
v_mfma_f32_16x16x32_bf16 v[28:31], v[156:159], v[236:239], v[28:31]
s_waitcnt lgkmcnt(6)
v_mfma_f32_16x16x32_bf16 v[28:31], v[64:67], v[244:247], v[28:31]
ds_read_b128 v[236:239], v9 offset:28160
v_mfma_f32_16x16x32_bf16 v[24:27], v[164:167], v[244:247], v[24:27]
s_barrier
s_waitcnt lgkmcnt(6)
v_mfma_f32_16x16x32_bf16 v[24:27], v[168:171], v[200:203], v[24:27]
ds_read_b128 v[244:247], v9 offset:30720
v_mfma_f32_16x16x32_bf16 v[28:31], v[164:167], v[200:203], v[28:31]
s_waitcnt lgkmcnt(6)
v_mfma_f32_16x16x32_bf16 v[28:31], v[168:171], v[224:227], v[28:31]
ds_read_b128 v[200:203], v9 offset:33280
v_mfma_f32_16x16x32_bf16 v[24:27], v[80:83], v[224:227], v[24:27]
s_waitcnt lgkmcnt(6)
v_mfma_f32_16x16x32_bf16 v[24:27], v[176:179], v[232:235], v[24:27]
ds_read_b128 v[224:227], v9 offset:35840
v_mfma_f32_16x16x32_bf16 v[28:31], v[80:83], v[232:235], v[28:31]
s_waitcnt lgkmcnt(6)
v_mfma_f32_16x16x32_bf16 v[28:31], v[176:179], v[240:243], v[28:31]
ds_read_b128 v[232:235], v9 offset:38400
v_mfma_f32_16x16x32_bf16 v[24:27], v[104:107], v[240:243], v[24:27]
s_waitcnt lgkmcnt(6)
v_mfma_f32_16x16x32_bf16 v[24:27], v[60:63], v[180:183], v[24:27]
ds_read_b128 v[240:243], v11 offset:20480
v_mfma_f32_16x16x32_bf16 v[28:31], v[104:107], v[180:183], v[28:31]
s_waitcnt lgkmcnt(6)
v_mfma_f32_16x16x32_bf16 v[28:31], v[60:63], v[196:199], v[28:31]
ds_read_b128 v[180:183], v11 offset:23040
v_mfma_f32_16x16x32_bf16 v[24:27], v[124:127], v[196:199], v[24:27]
ds_read_b128 v[196:199], v6 offset:30720
s_waitcnt lgkmcnt(7)
v_mfma_f32_16x16x32_bf16 v[24:27], v[128:131], v[236:239], v[24:27]
ds_read_b128 v[248:251], v6 offset:33280
v_mfma_f32_16x16x32_bf16 v[28:31], v[124:127], v[236:239], v[28:31]
s_waitcnt lgkmcnt(7)
v_mfma_f32_16x16x32_bf16 v[28:31], v[128:131], v[244:247], v[28:31]
ds_read_b128 v[236:239], v6 offset:35840
v_mfma_f32_16x16x32_bf16 v[24:27], v[188:191], v[244:247], v[24:27]
s_waitcnt lgkmcnt(7)
v_mfma_f32_16x16x32_bf16 v[24:27], v[208:211], v[200:203], v[24:27]
ds_read_b128 v[244:247], v6 offset:38400
v_mfma_f32_16x16x32_bf16 v[28:31], v[188:191], v[200:203], v[28:31]
s_waitcnt lgkmcnt(7)
v_mfma_f32_16x16x32_bf16 v[28:31], v[208:211], v[224:227], v[28:31]
ds_read_b128 v[200:203], v8 offset:20480
v_mfma_f32_16x16x32_bf16 v[24:27], v[228:231], v[224:227], v[24:27]
s_waitcnt lgkmcnt(7)
L_pg0_0:
s_cbranch_scc1 L_ret
v_mfma_f32_16x16x32_bf16 v[24:27], v[212:215], v[232:235], v[24:27]
ds_read_b128 v[224:227], v8 offset:23040
v_mfma_f32_16x16x32_bf16 v[28:31], v[228:231], v[232:235], v[28:31]
s_waitcnt lgkmcnt(7)
v_mfma_f32_16x16x32_bf16 v[28:31], v[212:215], v[240:243], v[28:31]
ds_read_b128 v[232:235], v8 offset:25600
v_mfma_f32_16x16x32_bf16 v[24:27], v[184:187], v[240:243], v[24:27]
s_waitcnt lgkmcnt(7)
v_mfma_f32_16x16x32_bf16 v[28:31], v[184:187], v[180:183], v[28:31]
ds_read_b128 v[180:183], v8 offset:28160
s_waitcnt lgkmcnt(7)
v_mfma_f32_16x16x32_bf16 v[16:19], v[160:163], v[196:199], v[16:19]
s_add_u32 s41, s44, 8192
s_waitcnt lgkmcnt(6)
v_mfma_f32_16x16x32_bf16 v[16:19], v[172:175], v[248:251], v[16:19]
ds_read_b128 v[196:199], v8 offset:30720
v_mfma_f32_16x16x32_bf16 v[20:23], v[160:163], v[248:251], v[20:23]
s_waitcnt lgkmcnt(6)
v_mfma_f32_16x16x32_bf16 v[20:23], v[172:175], v[236:239], v[20:23]
ds_read_b128 v[160:163], v8 offset:33280
v_mfma_f32_16x16x32_bf16 v[16:19], v[144:147], v[236:239], v[16:19]
s_add_u32 s40, s44, 20480
s_waitcnt lgkmcnt(6)
v_mfma_f32_16x16x32_bf16 v[16:19], v[116:119], v[244:247], v[16:19]
ds_read_b128 v[172:175], v8 offset:35840
v_cvt_pk_bf16_f32 v24, v24, v25
v_mfma_f32_16x16x32_bf16 v[20:23], v[144:147], v[244:247], v[20:23]
v_cvt_pk_bf16_f32 v25, v26, v27
v_cvt_pk_bf16_f32 v26, v28, v29
s_waitcnt lgkmcnt(6)
v_mfma_f32_16x16x32_bf16 v[20:23], v[116:119], v[200:203], v[20:23]
v_cvt_pk_bf16_f32 v27, v30, v31
v_min_u32 v24, 0xfffffffe, v24
v_mfma_f32_16x16x32_bf16 v[16:19], v[192:195], v[200:203], v[16:19]
v_min_u32 v25, 0xfffffffe, v25
v_min_u32 v26, 0xfffffffe, v26
s_waitcnt lgkmcnt(5)
v_mfma_f32_16x16x32_bf16 v[16:19], v[112:115], v[224:227], v[16:19]
v_min_u32 v27, 0xfffffffe, v27
buffer_store_dwordx4 v[24:27], v14, s[28:31], s40 offen sc1
v_mfma_f32_16x16x32_bf16 v[20:23], v[192:195], v[224:227], v[20:23]
ds_read_b128 v[116:119], v8 offset:38400
ds_read_b128 v[144:147], v3 offset:20480
s_waitcnt lgkmcnt(6)
v_mfma_f32_16x16x32_bf16 v[20:23], v[112:115], v[232:235], v[20:23]
ds_read_b128 v[112:115], v3 offset:23040
v_mfma_f32_16x16x32_bf16 v[16:19], v[204:207], v[232:235], v[16:19]
ds_read_b128 v[192:195], v3 offset:25600
s_waitcnt lgkmcnt(7)
v_mfma_f32_16x16x32_bf16 v[16:19], v[52:55], v[180:183], v[16:19]
ds_read_b128 v[200:203], v3 offset:28160
v_mfma_f32_16x16x32_bf16 v[20:23], v[204:207], v[180:183], v[20:23]
s_waitcnt lgkmcnt(7)
v_mfma_f32_16x16x32_bf16 v[20:23], v[52:55], v[196:199], v[20:23]
ds_read_b128 v[52:55], v3 offset:30720
v_mfma_f32_16x16x32_bf16 v[16:19], v[216:219], v[196:199], v[16:19]
s_waitcnt lgkmcnt(7)
v_mfma_f32_16x16x32_bf16 v[16:19], v[76:79], v[160:163], v[16:19]
ds_read_b128 v[180:183], v3 offset:33280
v_mfma_f32_16x16x32_bf16 v[20:23], v[216:219], v[160:163], v[20:23]
s_waitcnt lgkmcnt(7)
v_mfma_f32_16x16x32_bf16 v[20:23], v[76:79], v[172:175], v[20:23]
ds_read_b128 v[76:79], v3 offset:35840
v_mfma_f32_16x16x32_bf16 v[16:19], v[220:223], v[172:175], v[16:19]
s_waitcnt lgkmcnt(7)
v_mfma_f32_16x16x32_bf16 v[20:23], v[220:223], v[116:119], v[20:23]
ds_read_b128 v[116:119], v3 offset:38400
s_waitcnt lgkmcnt(7)
v_mfma_f32_16x16x32_bf16 v[16:19], v[72:75], v[144:147], v[16:19]
s_waitcnt lgkmcnt(6)
v_mfma_f32_16x16x32_bf16 v[16:19], v[96:99], v[112:115], v[16:19]
ds_read_b128 v[144:147], v5 offset:20480
v_mfma_f32_16x16x32_bf16 v[20:23], v[72:75], v[112:115], v[20:23]
s_waitcnt lgkmcnt(6)
v_mfma_f32_16x16x32_bf16 v[20:23], v[96:99], v[192:195], v[20:23]
ds_read_b128 v[72:75], v5 offset:23040
v_mfma_f32_16x16x32_bf16 v[16:19], v[100:103], v[192:195], v[16:19]
s_waitcnt lgkmcnt(6)
v_mfma_f32_16x16x32_bf16 v[16:19], v[92:95], v[200:203], v[16:19]
ds_read_b128 v[96:99], v5 offset:25600
v_mfma_f32_16x16x32_bf16 v[20:23], v[100:103], v[200:203], v[20:23]
s_waitcnt lgkmcnt(6)
v_mfma_f32_16x16x32_bf16 v[20:23], v[92:95], v[52:55], v[20:23]
ds_read_b128 v[92:95], v5 offset:28160
v_mfma_f32_16x16x32_bf16 v[16:19], v[120:123], v[52:55], v[16:19]
s_waitcnt lgkmcnt(6)
v_mfma_f32_16x16x32_bf16 v[16:19], v[132:135], v[180:183], v[16:19]
ds_read_b128 v[52:55], v5 offset:30720
v_mfma_f32_16x16x32_bf16 v[20:23], v[120:123], v[180:183], v[20:23]
s_waitcnt lgkmcnt(6)
v_mfma_f32_16x16x32_bf16 v[20:23], v[132:135], v[76:79], v[20:23]
ds_read_b128 v[100:103], v5 offset:33280
v_mfma_f32_16x16x32_bf16 v[16:19], v[84:87], v[76:79], v[16:19]
s_waitcnt lgkmcnt(6)
v_mfma_f32_16x16x32_bf16 v[16:19], v[48:51], v[116:119], v[16:19]
ds_read_b128 v[76:79], v5 offset:35840
v_mfma_f32_16x16x32_bf16 v[20:23], v[84:87], v[116:119], v[20:23]
s_waitcnt lgkmcnt(6)
v_mfma_f32_16x16x32_bf16 v[20:23], v[48:51], v[144:147], v[20:23]
ds_read_b128 v[48:51], v5 offset:38400
v_mfma_f32_16x16x32_bf16 v[16:19], v[88:91], v[144:147], v[16:19]
s_waitcnt lgkmcnt(6)
v_mfma_f32_16x16x32_bf16 v[16:19], v[108:111], v[72:75], v[16:19]
ds_read_b128 v[84:87], v7 offset:20480
v_mfma_f32_16x16x32_bf16 v[20:23], v[88:91], v[72:75], v[20:23]
s_waitcnt lgkmcnt(6)
v_mfma_f32_16x16x32_bf16 v[20:23], v[108:111], v[96:99], v[20:23]
ds_read_b128 v[72:75], v7 offset:23040
v_mfma_f32_16x16x32_bf16 v[16:19], v[68:71], v[96:99], v[16:19]
s_waitcnt lgkmcnt(6)
v_mfma_f32_16x16x32_bf16 v[16:19], v[136:139], v[92:95], v[16:19]
ds_read_b128 v[88:91], v7 offset:25600
v_mfma_f32_16x16x32_bf16 v[20:23], v[68:71], v[92:95], v[20:23]
buffer_load_dwordx4 v[68:71], v14, s[28:31], s41 offen offset:0 sc1
s_waitcnt lgkmcnt(6)
v_mfma_f32_16x16x32_bf16 v[20:23], v[136:139], v[52:55], v[20:23]
ds_read_b128 v[92:95], v7 offset:28160
v_mfma_f32_16x16x32_bf16 v[16:19], v[140:143], v[52:55], v[16:19]
s_waitcnt lgkmcnt(6)
v_mfma_f32_16x16x32_bf16 v[16:19], v[56:59], v[100:103], v[16:19]
ds_read_b128 v[52:55], v7 offset:30720
v_mfma_f32_16x16x32_bf16 v[20:23], v[140:143], v[100:103], v[20:23]
s_waitcnt lgkmcnt(6)
v_mfma_f32_16x16x32_bf16 v[20:23], v[56:59], v[76:79], v[20:23]
ds_read_b128 v[56:59], v7 offset:33280
v_mfma_f32_16x16x32_bf16 v[16:19], v[148:151], v[76:79], v[16:19]
s_waitcnt lgkmcnt(6)
v_mfma_f32_16x16x32_bf16 v[16:19], v[152:155], v[48:51], v[16:19]
ds_read_b128 v[76:79], v7 offset:35840
v_mfma_f32_16x16x32_bf16 v[20:23], v[148:151], v[48:51], v[20:23]
s_waitcnt lgkmcnt(6)
v_mfma_f32_16x16x32_bf16 v[20:23], v[152:155], v[84:87], v[20:23]
ds_read_b128 v[48:51], v7 offset:38400
v_mfma_f32_16x16x32_bf16 v[16:19], v[156:159], v[84:87], v[16:19]
s_waitcnt lgkmcnt(6)
v_mfma_f32_16x16x32_bf16 v[16:19], v[64:67], v[72:75], v[16:19]
ds_read_b128 v[84:87], v9 offset:20480
v_mfma_f32_16x16x32_bf16 v[20:23], v[156:159], v[72:75], v[20:23]
s_waitcnt lgkmcnt(6)
v_mfma_f32_16x16x32_bf16 v[20:23], v[64:67], v[88:91], v[20:23]
ds_read_b128 v[64:67], v9 offset:23040
v_mfma_f32_16x16x32_bf16 v[16:19], v[164:167], v[88:91], v[16:19]
buffer_load_dwordx4 v[72:75], v14, s[28:31], s41 offen offset:0 sc1
s_waitcnt lgkmcnt(6)
v_mfma_f32_16x16x32_bf16 v[16:19], v[168:171], v[92:95], v[16:19]
ds_read_b128 v[88:91], v9 offset:25600
v_mfma_f32_16x16x32_bf16 v[20:23], v[164:167], v[92:95], v[20:23]
s_waitcnt lgkmcnt(6)
v_mfma_f32_16x16x32_bf16 v[20:23], v[168:171], v[52:55], v[20:23]
ds_read_b128 v[92:95], v9 offset:28160
v_mfma_f32_16x16x32_bf16 v[16:19], v[80:83], v[52:55], v[16:19]
s_waitcnt lgkmcnt(6)
v_mfma_f32_16x16x32_bf16 v[16:19], v[176:179], v[56:59], v[16:19]
ds_read_b128 v[52:55], v9 offset:30720
v_mfma_f32_16x16x32_bf16 v[20:23], v[80:83], v[56:59], v[20:23]
s_waitcnt lgkmcnt(6)
v_mfma_f32_16x16x32_bf16 v[20:23], v[176:179], v[76:79], v[20:23]
ds_read_b128 v[56:59], v9 offset:33280
v_mfma_f32_16x16x32_bf16 v[16:19], v[104:107], v[76:79], v[16:19]
s_waitcnt lgkmcnt(6)
v_mfma_f32_16x16x32_bf16 v[16:19], v[60:63], v[48:51], v[16:19]
ds_read_b128 v[76:79], v9 offset:35840
v_mfma_f32_16x16x32_bf16 v[20:23], v[104:107], v[48:51], v[20:23]
s_waitcnt lgkmcnt(6)
v_mfma_f32_16x16x32_bf16 v[20:23], v[60:63], v[84:87], v[20:23]
ds_read_b128 v[48:51], v9 offset:38400
v_mfma_f32_16x16x32_bf16 v[16:19], v[124:127], v[84:87], v[16:19]
s_waitcnt lgkmcnt(6)
v_mfma_f32_16x16x32_bf16 v[16:19], v[128:131], v[64:67], v[16:19]
v_mfma_f32_16x16x32_bf16 v[20:23], v[124:127], v[64:67], v[20:23]
s_waitcnt lgkmcnt(5)
v_mfma_f32_16x16x32_bf16 v[20:23], v[128:131], v[88:91], v[20:23]
v_mfma_f32_16x16x32_bf16 v[16:19], v[188:191], v[88:91], v[16:19]
s_waitcnt lgkmcnt(4)
v_mfma_f32_16x16x32_bf16 v[16:19], v[208:211], v[92:95], v[16:19]
v_mfma_f32_16x16x32_bf16 v[20:23], v[188:191], v[92:95], v[20:23]
s_waitcnt lgkmcnt(3)
v_mfma_f32_16x16x32_bf16 v[20:23], v[208:211], v[52:55], v[20:23]
v_mfma_f32_16x16x32_bf16 v[16:19], v[228:231], v[52:55], v[16:19]
s_waitcnt lgkmcnt(2)
v_mfma_f32_16x16x32_bf16 v[16:19], v[212:215], v[56:59], v[16:19]
v_mfma_f32_16x16x32_bf16 v[20:23], v[228:231], v[56:59], v[20:23]
s_waitcnt lgkmcnt(1)
v_mfma_f32_16x16x32_bf16 v[20:23], v[212:215], v[76:79], v[20:23]
v_mfma_f32_16x16x32_bf16 v[16:19], v[184:187], v[76:79], v[16:19]
s_waitcnt lgkmcnt(0)
v_mfma_f32_16x16x32_bf16 v[20:23], v[184:187], v[48:51], v[20:23]
L_pl0:
s_waitcnt vmcnt(1)
v_max3_u32 v56, v68, v69, v70
v_max_u32 v56, v56, v71
v_cmp_eq_u32 vcc, -1, v56
s_cbranch_vccz L_got0_0
buffer_load_dwordx4 v[68:71], v14, s[28:31], s41 offen offset:0 sc1
s_waitcnt vmcnt(1)
v_max3_u32 v56, v72, v73, v74
v_max_u32 v56, v56, v75
v_cmp_eq_u32 vcc, -1, v56
s_cbranch_vccz L_got0_1
buffer_load_dwordx4 v[72:75], v14, s[28:31], s41 offen offset:0 sc1
s_branch L_pl0
L_got0_1:
v_lshlrev_b32 v48, 16, v72
v_and_b32 v49, 0xffff0000, v72
v_lshlrev_b32 v50, 16, v73
v_and_b32 v51, 0xffff0000, v73
v_lshlrev_b32 v52, 16, v74
v_and_b32 v53, 0xffff0000, v74
v_lshlrev_b32 v54, 16, v75
v_and_b32 v55, 0xffff0000, v75
s_branch L_ok0
L_got0_0:
v_lshlrev_b32 v48, 16, v68
v_and_b32 v49, 0xffff0000, v68
v_lshlrev_b32 v50, 16, v69
v_and_b32 v51, 0xffff0000, v69
v_lshlrev_b32 v52, 16, v70
v_and_b32 v53, 0xffff0000, v70
v_lshlrev_b32 v54, 16, v71
v_and_b32 v55, 0xffff0000, v71
L_ok0:
v_add_f32 v48, v16, v48
v_add_f32 v49, v17, v49
v_add_f32 v50, v18, v50
v_add_f32 v51, v19, v51
v_add_f32 v52, v20, v52
v_add_f32 v53, v21, v53
v_add_f32 v54, v22, v54
v_add_f32 v55, v23, v55
v_mul_f32 v48, s45, v48
v_mul_f32 v49, s45, v49
v_mul_f32 v50, s45, v50
v_mul_f32 v51, s45, v51
v_mul_f32 v52, s45, v52
v_mul_f32 v53, s45, v53
v_mul_f32 v54, s45, v54
v_mul_f32 v55, s45, v55
s_barrier
ds_read_b128 v[60:63], v1 offset:0
ds_read_b128 v[64:67], v1 offset:1024
v_exp_f32 v48, v48
v_exp_f32 v49, v49
v_exp_f32 v50, v50
v_exp_f32 v51, v51
v_exp_f32 v52, v52
v_exp_f32 v53, v53
v_exp_f32 v54, v54
v_exp_f32 v55, v55
v_fma_f32 v48, v48, 0.5, 0.5
v_fma_f32 v49, v49, 0.5, 0.5
v_fma_f32 v50, v50, 0.5, 0.5
v_fma_f32 v51, v51, 0.5, 0.5
v_fma_f32 v52, v52, 0.5, 0.5
v_fma_f32 v53, v53, 0.5, 0.5
v_fma_f32 v54, v54, 0.5, 0.5
v_fma_f32 v55, v55, 0.5, 0.5
v_rcp_f32 v48, v48
v_rcp_f32 v49, v49
v_rcp_f32 v50, v50
v_rcp_f32 v51, v51
v_rcp_f32 v52, v52
v_rcp_f32 v53, v53
v_rcp_f32 v54, v54
v_rcp_f32 v55, v55
s_waitcnt lgkmcnt(0)
v_fma_f32 v48, -v48, v60, v60
v_fma_f32 v49, -v49, v61, v61
v_fma_f32 v50, -v50, v62, v62
v_fma_f32 v51, -v51, v63, v63
v_cvt_pk_bf16_f32 v16, v48, v49
v_cvt_pk_bf16_f32 v17, v50, v51
buffer_store_dwordx2 v[16:17], v15, s[24:27], 0 offen offset:0
v_fma_f32 v52, -v52, v64, v64
v_fma_f32 v53, -v53, v65, v65
v_fma_f32 v54, -v54, v66, v66
v_fma_f32 v55, -v55, v67, v67
v_cvt_pk_bf16_f32 v18, v52, v53
v_cvt_pk_bf16_f32 v19, v54, v55
buffer_store_dwordx2 v[18:19], v15, s[24:27], 0 offen offset:1024
s_endpgm
.p2align 6
L_warm1:
s_setpc_b64 s[50:51]
L_fin1:
s_cmp_eq_u32 0, 1
v_mfma_f32_16x16x32_bf16 v[40:43], v[76:79], v[52:55], v[40:43]
ds_read_b64_tr_b16 v[178:179], v13 offset:20992
s_waitcnt lgkmcnt(9)
v_mfma_f32_16x16x32_bf16 v[40:43], v[144:147], v[124:127], v[40:43]
ds_read_b128 v[180:183], v8 offset:28160
v_mfma_f32_16x16x32_bf16 v[44:47], v[76:79], v[124:127], v[44:47]
ds_read_b128 v[76:79], v8 offset:30720
s_waitcnt lgkmcnt(8)
v_mfma_f32_16x16x32_bf16 v[44:47], v[144:147], v[128:131], v[44:47]
ds_read_b64_tr_b16 v[144:145], v13 offset:24576
s_waitcnt lgkmcnt(7)
v_mfma_f32_16x16x32_bf16 v[16:19], v[160:163], v[116:119], v[16:19]
ds_read_b64_tr_b16 v[146:147], v13 offset:25088
s_waitcnt lgkmcnt(6)
v_mfma_f32_16x16x32_bf16 v[16:19], v[172:175], v[104:107], v[16:19]
ds_read_b64_tr_b16 v[116:117], v13 offset:28672
v_mfma_f32_16x16x32_bf16 v[20:23], v[160:163], v[104:107], v[20:23]
ds_read_b64_tr_b16 v[118:119], v13 offset:29184
v_mfma_f32_16x16x32_bf16 v[20:23], v[172:175], v[112:115], v[20:23]
v_mfma_f32_16x16x32_bf16 v[32:35], v[160:163], v[52:55], v[32:35]
v_mfma_f32_16x16x32_bf16 v[32:35], v[172:175], v[124:127], v[32:35]
v_mfma_f32_16x16x32_bf16 v[36:39], v[160:163], v[124:127], v[36:39]
s_waitcnt lgkmcnt(6)
s_barrier
ds_read_b64_tr_b16 v[104:105], v13 offset:32768
v_mfma_f32_16x16x32_bf16 v[36:39], v[172:175], v[128:131], v[36:39]
ds_read_b64_tr_b16 v[106:107], v13 offset:33280
v_mfma_f32_16x16x32_bf16 v[40:43], v[160:163], v[128:131], v[40:43]
ds_read_b128 v[184:187], v8 offset:33280
s_waitcnt lgkmcnt(8)
v_mfma_f32_16x16x32_bf16 v[40:43], v[172:175], v[180:183], v[40:43]
ds_read_b128 v[188:191], v8 offset:35840
v_mfma_f32_16x16x32_bf16 v[44:47], v[160:163], v[180:183], v[44:47]
ds_read_b64_tr_b16 v[192:193], v13 offset:36864
s_waitcnt lgkmcnt(9)
v_mfma_f32_16x16x32_bf16 v[44:47], v[172:175], v[76:79], v[44:47]
ds_read_b64_tr_b16 v[194:195], v13 offset:37376
s_waitcnt lgkmcnt(8)
v_mfma_f32_16x16x32_bf16 v[16:19], v[144:147], v[112:115], v[16:19]
ds_read_b64_tr_b16 v[112:113], v13 offset:40960
s_waitcnt lgkmcnt(7)
v_mfma_f32_16x16x32_bf16 v[16:19], v[116:119], v[60:63], v[16:19]
ds_read_b64_tr_b16 v[114:115], v13 offset:41472
v_mfma_f32_16x16x32_bf16 v[20:23], v[144:147], v[60:63], v[20:23]
v_mfma_f32_16x16x32_bf16 v[20:23], v[116:119], v[52:55], v[20:23]
v_mfma_f32_16x16x32_bf16 v[32:35], v[144:147], v[128:131], v[32:35]
v_mfma_f32_16x16x32_bf16 v[32:35], v[116:119], v[180:183], v[32:35]
ds_read_b64_tr_b16 v[60:61], v13 offset:45056
v_mfma_f32_16x16x32_bf16 v[36:39], v[144:147], v[180:183], v[36:39]
ds_read_b64_tr_b16 v[62:63], v13 offset:45568
v_mfma_f32_16x16x32_bf16 v[36:39], v[116:119], v[76:79], v[36:39]
ds_read_b128 v[196:199], v8 offset:38400
v_mfma_f32_16x16x32_bf16 v[40:43], v[144:147], v[76:79], v[40:43]
s_waitcnt lgkmcnt(8)
v_mfma_f32_16x16x32_bf16 v[40:43], v[116:119], v[184:187], v[40:43]
ds_read_b128 v[200:203], v10 offset:20480
v_mfma_f32_16x16x32_bf16 v[44:47], v[144:147], v[184:187], v[44:47]
ds_read_b64_tr_b16 v[204:205], v12 offset:0
s_waitcnt lgkmcnt(9)
v_mfma_f32_16x16x32_bf16 v[44:47], v[116:119], v[188:191], v[44:47]
ds_read_b64_tr_b16 v[206:207], v12 offset:512
s_waitcnt lgkmcnt(8)
v_mfma_f32_16x16x32_bf16 v[16:19], v[192:195], v[52:55], v[16:19]
ds_read_b64_tr_b16 v[52:53], v12 offset:4096
s_waitcnt lgkmcnt(7)
v_mfma_f32_16x16x32_bf16 v[16:19], v[112:115], v[124:127], v[16:19]
ds_read_b64_tr_b16 v[54:55], v12 offset:4608
v_mfma_f32_16x16x32_bf16 v[20:23], v[192:195], v[124:127], v[20:23]
v_mfma_f32_16x16x32_bf16 v[20:23], v[112:115], v[128:131], v[20:23]
v_mfma_f32_16x16x32_bf16 v[32:35], v[192:195], v[76:79], v[32:35]
ds_read_b64_tr_b16 v[124:125], v12 offset:8192
v_mfma_f32_16x16x32_bf16 v[32:35], v[112:115], v[184:187], v[32:35]
ds_read_b64_tr_b16 v[126:127], v12 offset:8704
v_mfma_f32_16x16x32_bf16 v[36:39], v[192:195], v[184:187], v[36:39]
v_mfma_f32_16x16x32_bf16 v[36:39], v[112:115], v[188:191], v[36:39]
ds_read_b128 v[208:211], v10 offset:23040
v_mfma_f32_16x16x32_bf16 v[40:43], v[192:195], v[188:191], v[40:43]
s_waitcnt lgkmcnt(8)
v_mfma_f32_16x16x32_bf16 v[40:43], v[112:115], v[196:199], v[40:43]
ds_read_b128 v[212:215], v10 offset:25600
v_mfma_f32_16x16x32_bf16 v[44:47], v[192:195], v[196:199], v[44:47]
ds_read_b64_tr_b16 v[216:217], v12 offset:12288
s_waitcnt lgkmcnt(9)
v_mfma_f32_16x16x32_bf16 v[44:47], v[112:115], v[200:203], v[44:47]
ds_read_b64_tr_b16 v[218:219], v12 offset:12800
s_waitcnt lgkmcnt(8)
v_mfma_f32_16x16x32_bf16 v[16:19], v[204:207], v[128:131], v[16:19]
ds_read_b64_tr_b16 v[128:129], v12 offset:16384
s_waitcnt lgkmcnt(7)
v_mfma_f32_16x16x32_bf16 v[16:19], v[52:55], v[180:183], v[16:19]
ds_read_b64_tr_b16 v[130:131], v12 offset:16896
v_mfma_f32_16x16x32_bf16 v[20:23], v[204:207], v[180:183], v[20:23]
v_mfma_f32_16x16x32_bf16 v[20:23], v[52:55], v[76:79], v[20:23]
v_mfma_f32_16x16x32_bf16 v[32:35], v[204:207], v[188:191], v[32:35]
s_waitcnt lgkmcnt(6)
s_barrier
ds_read_b64_tr_b16 v[180:181], v12 offset:20480
v_mfma_f32_16x16x32_bf16 v[32:35], v[52:55], v[196:199], v[32:35]
ds_read_b64_tr_b16 v[182:183], v12 offset:20992
v_mfma_f32_16x16x32_bf16 v[36:39], v[204:207], v[196:199], v[36:39]
v_mfma_f32_16x16x32_bf16 v[36:39], v[52:55], v[200:203], v[36:39]
ds_read_b128 v[220:223], v10 offset:28160
v_mfma_f32_16x16x32_bf16 v[40:43], v[204:207], v[200:203], v[40:43]
s_waitcnt lgkmcnt(8)
v_mfma_f32_16x16x32_bf16 v[40:43], v[52:55], v[208:211], v[40:43]
ds_read_b128 v[224:227], v10 offset:30720
v_mfma_f32_16x16x32_bf16 v[44:47], v[204:207], v[208:211], v[44:47]
ds_read_b64_tr_b16 v[228:229], v12 offset:24576
s_waitcnt lgkmcnt(9)
v_mfma_f32_16x16x32_bf16 v[44:47], v[52:55], v[212:215], v[44:47]
ds_read_b64_tr_b16 v[230:231], v12 offset:25088
s_waitcnt lgkmcnt(8)
v_mfma_f32_16x16x32_bf16 v[16:19], v[216:219], v[76:79], v[16:19]
s_waitcnt lgkmcnt(6)
v_mfma_f32_16x16x32_bf16 v[16:19], v[128:131], v[184:187], v[16:19]
v_mfma_f32_16x16x32_bf16 v[20:23], v[216:219], v[184:187], v[20:23]
v_mfma_f32_16x16x32_bf16 v[20:23], v[128:131], v[188:191], v[20:23]
ds_read_b64_tr_b16 v[76:77], v12 offset:28672
v_mfma_f32_16x16x32_bf16 v[32:35], v[216:219], v[200:203], v[32:35]
ds_read_b64_tr_b16 v[78:79], v12 offset:29184
v_mfma_f32_16x16x32_bf16 v[32:35], v[128:131], v[208:211], v[32:35]
ds_read_b128 v[184:187], v10 offset:33280
v_mfma_f32_16x16x32_bf16 v[36:39], v[216:219], v[208:211], v[36:39]
ds_read_b128 v[200:203], v3 offset:35840
v_mfma_f32_16x16x32_bf16 v[36:39], v[128:131], v[212:215], v[36:39]
ds_read_b128 v[208:211], v3 offset:38400
v_mfma_f32_16x16x32_bf16 v[40:43], v[216:219], v[212:215], v[40:43]
ds_read_b128 v[232:235], v5 offset:20480
s_waitcnt lgkmcnt(9)
v_mfma_f32_16x16x32_bf16 v[40:43], v[128:131], v[220:223], v[40:43]
ds_read_b128 v[236:239], v5 offset:23040
v_mfma_f32_16x16x32_bf16 v[44:47], v[216:219], v[220:223], v[44:47]
s_waitcnt lgkmcnt(9)
v_mfma_f32_16x16x32_bf16 v[44:47], v[128:131], v[224:227], v[44:47]
ds_read_b128 v[240:243], v5 offset:25600
s_waitcnt lgkmcnt(8)
v_mfma_f32_16x16x32_bf16 v[16:19], v[228:231], v[188:191], v[16:19]
v_mfma_f32_16x16x32_bf16 v[20:23], v[228:231], v[196:199], v[20:23]
ds_read_b128 v[188:191], v5 offset:28160
v_mfma_f32_16x16x32_bf16 v[32:35], v[228:231], v[212:215], v[32:35]
ds_read_b64_tr_b16 v[196:197], v12 offset:32768
v_mfma_f32_16x16x32_bf16 v[36:39], v[228:231], v[220:223], v[36:39]
ds_read_b64_tr_b16 v[198:199], v12 offset:33280
v_mfma_f32_16x16x32_bf16 v[40:43], v[228:231], v[224:227], v[40:43]
ds_read_b128 v[212:215], v5 offset:30720
s_waitcnt lgkmcnt(9)
v_mfma_f32_16x16x32_bf16 v[44:47], v[228:231], v[184:187], v[44:47]
ds_read_b128 v[184:187], v5 offset:33280
s_waitcnt lgkmcnt(9)
v_mfma_f32_16x16x32_bf16 v[40:43], v[72:75], v[200:203], v[40:43]
s_waitcnt lgkmcnt(8)
v_mfma_f32_16x16x32_bf16 v[40:43], v[96:99], v[208:211], v[40:43]
ds_read_b128 v[200:203], v5 offset:35840
v_mfma_f32_16x16x32_bf16 v[44:47], v[72:75], v[208:211], v[44:47]
s_waitcnt lgkmcnt(8)
v_mfma_f32_16x16x32_bf16 v[44:47], v[96:99], v[232:235], v[44:47]
ds_read_b128 v[208:211], v5 offset:38400
v_mfma_f32_16x16x32_bf16 v[40:43], v[100:103], v[232:235], v[40:43]
s_waitcnt lgkmcnt(8)
v_mfma_f32_16x16x32_bf16 v[40:43], v[92:95], v[236:239], v[40:43]
ds_read_b128 v[220:223], v7 offset:20480
v_mfma_f32_16x16x32_bf16 v[44:47], v[100:103], v[236:239], v[44:47]
s_waitcnt lgkmcnt(8)
v_mfma_f32_16x16x32_bf16 v[44:47], v[92:95], v[240:243], v[44:47]
s_waitcnt lgkmcnt(5)
s_barrier
ds_read_b64_tr_b16 v[224:225], v12 offset:36864
v_mfma_f32_16x16x32_bf16 v[40:43], v[120:123], v[240:243], v[40:43]
ds_read_b64_tr_b16 v[226:227], v12 offset:37376
v_mfma_f32_16x16x32_bf16 v[40:43], v[132:135], v[188:191], v[40:43]
ds_read_b128 v[232:235], v7 offset:23040
v_mfma_f32_16x16x32_bf16 v[44:47], v[120:123], v[188:191], v[44:47]
ds_read_b128 v[188:191], v7 offset:25600
s_waitcnt lgkmcnt(8)
v_mfma_f32_16x16x32_bf16 v[44:47], v[132:135], v[212:215], v[44:47]
ds_read_b128 v[236:239], v7 offset:28160
v_mfma_f32_16x16x32_bf16 v[40:43], v[84:87], v[212:215], v[40:43]
s_waitcnt lgkmcnt(8)
v_mfma_f32_16x16x32_bf16 v[40:43], v[48:51], v[184:187], v[40:43]
ds_read_b128 v[212:215], v7 offset:30720
v_mfma_f32_16x16x32_bf16 v[44:47], v[84:87], v[184:187], v[44:47]
s_waitcnt lgkmcnt(8)
v_mfma_f32_16x16x32_bf16 v[44:47], v[48:51], v[200:203], v[44:47]
ds_read_b128 v[184:187], v7 offset:33280
v_mfma_f32_16x16x32_bf16 v[40:43], v[88:91], v[200:203], v[40:43]
s_waitcnt lgkmcnt(8)
v_mfma_f32_16x16x32_bf16 v[40:43], v[108:111], v[208:211], v[40:43]
ds_read_b128 v[200:203], v7 offset:35840
v_mfma_f32_16x16x32_bf16 v[44:47], v[88:91], v[208:211], v[44:47]
ds_read_b64_tr_b16 v[208:209], v12 offset:40960
s_waitcnt lgkmcnt(9)
v_mfma_f32_16x16x32_bf16 v[44:47], v[108:111], v[220:223], v[44:47]
ds_read_b64_tr_b16 v[210:211], v12 offset:41472
v_mfma_f32_16x16x32_bf16 v[40:43], v[68:71], v[220:223], v[40:43]
ds_read_b128 v[220:223], v7 offset:38400
s_waitcnt lgkmcnt(8)
v_mfma_f32_16x16x32_bf16 v[40:43], v[136:139], v[232:235], v[40:43]
ds_read_b128 v[240:243], v9 offset:20480
v_mfma_f32_16x16x32_bf16 v[44:47], v[68:71], v[232:235], v[44:47]
s_waitcnt lgkmcnt(8)
v_mfma_f32_16x16x32_bf16 v[44:47], v[136:139], v[188:191], v[44:47]
ds_read_b128 v[232:235], v9 offset:23040
v_mfma_f32_16x16x32_bf16 v[40:43], v[140:143], v[188:191], v[40:43]
s_waitcnt lgkmcnt(8)
v_mfma_f32_16x16x32_bf16 v[40:43], v[56:59], v[236:239], v[40:43]
ds_read_b128 v[188:191], v9 offset:25600
v_mfma_f32_16x16x32_bf16 v[44:47], v[140:143], v[236:239], v[44:47]
s_waitcnt lgkmcnt(8)
v_mfma_f32_16x16x32_bf16 v[44:47], v[56:59], v[212:215], v[44:47]
ds_read_b128 v[236:239], v9 offset:28160
v_mfma_f32_16x16x32_bf16 v[40:43], v[148:151], v[212:215], v[40:43]
s_waitcnt lgkmcnt(8)
v_mfma_f32_16x16x32_bf16 v[40:43], v[152:155], v[184:187], v[40:43]
ds_read_b128 v[212:215], v9 offset:30720
v_mfma_f32_16x16x32_bf16 v[44:47], v[148:151], v[184:187], v[44:47]
ds_read_b64_tr_b16 v[184:185], v12 offset:45056
s_waitcnt lgkmcnt(9)
v_mfma_f32_16x16x32_bf16 v[44:47], v[152:155], v[200:203], v[44:47]
ds_read_b64_tr_b16 v[186:187], v12 offset:45568
v_mfma_f32_16x16x32_bf16 v[40:43], v[156:159], v[200:203], v[40:43]
ds_read_b128 v[200:203], v9 offset:33280
s_waitcnt lgkmcnt(8)
v_mfma_f32_16x16x32_bf16 v[40:43], v[64:67], v[220:223], v[40:43]
ds_read_b128 v[244:247], v9 offset:35840
v_mfma_f32_16x16x32_bf16 v[44:47], v[156:159], v[220:223], v[44:47]
s_waitcnt lgkmcnt(8)
v_mfma_f32_16x16x32_bf16 v[44:47], v[64:67], v[240:243], v[44:47]
ds_read_b128 v[220:223], v9 offset:38400
v_mfma_f32_16x16x32_bf16 v[40:43], v[164:167], v[240:243], v[40:43]
s_waitcnt lgkmcnt(8)
v_mfma_f32_16x16x32_bf16 v[40:43], v[168:171], v[232:235], v[40:43]
ds_read_b128 v[240:243], v11 offset:20480
v_mfma_f32_16x16x32_bf16 v[44:47], v[164:167], v[232:235], v[44:47]
s_waitcnt lgkmcnt(8)
v_mfma_f32_16x16x32_bf16 v[44:47], v[168:171], v[188:191], v[44:47]
ds_read_b128 v[232:235], v11 offset:23040
v_mfma_f32_16x16x32_bf16 v[40:43], v[80:83], v[188:191], v[40:43]
s_waitcnt lgkmcnt(8)
v_mfma_f32_16x16x32_bf16 v[40:43], v[176:179], v[236:239], v[40:43]
ds_read_b128 v[188:191], v11 offset:25600
v_mfma_f32_16x16x32_bf16 v[44:47], v[80:83], v[236:239], v[44:47]
s_waitcnt lgkmcnt(8)
v_mfma_f32_16x16x32_bf16 v[44:47], v[176:179], v[212:215], v[44:47]
ds_read_b128 v[236:239], v11 offset:28160
v_mfma_f32_16x16x32_bf16 v[40:43], v[104:107], v[212:215], v[40:43]
s_waitcnt lgkmcnt(6)
v_mfma_f32_16x16x32_bf16 v[40:43], v[60:63], v[200:203], v[40:43]
ds_read_b128 v[212:215], v11 offset:30720
v_mfma_f32_16x16x32_bf16 v[44:47], v[104:107], v[200:203], v[44:47]
s_waitcnt lgkmcnt(6)
v_mfma_f32_16x16x32_bf16 v[44:47], v[60:63], v[244:247], v[44:47]
ds_read_b128 v[200:203], v11 offset:33280
v_mfma_f32_16x16x32_bf16 v[40:43], v[124:127], v[244:247], v[40:43]
ds_read_b128 v[244:247], v3 offset:30720
s_waitcnt lgkmcnt(7)
v_mfma_f32_16x16x32_bf16 v[40:43], v[180:183], v[220:223], v[40:43]
ds_read_b128 v[248:251], v3 offset:33280
v_mfma_f32_16x16x32_bf16 v[44:47], v[124:127], v[220:223], v[44:47]
s_waitcnt lgkmcnt(7)
v_mfma_f32_16x16x32_bf16 v[44:47], v[180:183], v[240:243], v[44:47]
ds_read_b128 v[220:223], v3 offset:35840
v_mfma_f32_16x16x32_bf16 v[40:43], v[76:79], v[240:243], v[40:43]
s_waitcnt lgkmcnt(7)
v_mfma_f32_16x16x32_bf16 v[40:43], v[196:199], v[232:235], v[40:43]
ds_read_b128 v[240:243], v3 offset:38400
v_mfma_f32_16x16x32_bf16 v[44:47], v[76:79], v[232:235], v[44:47]
s_waitcnt lgkmcnt(7)
v_mfma_f32_16x16x32_bf16 v[44:47], v[196:199], v[188:191], v[44:47]
ds_read_b128 v[232:235], v5 offset:20480
v_mfma_f32_16x16x32_bf16 v[40:43], v[224:227], v[188:191], v[40:43]
s_waitcnt lgkmcnt(7)
v_mfma_f32_16x16x32_bf16 v[40:43], v[208:211], v[236:239], v[40:43]
ds_read_b128 v[188:191], v5 offset:23040
v_mfma_f32_16x16x32_bf16 v[44:47], v[224:227], v[236:239], v[44:47]
s_waitcnt lgkmcnt(7)
v_mfma_f32_16x16x32_bf16 v[44:47], v[208:211], v[212:215], v[44:47]
ds_read_b128 v[236:239], v5 offset:25600
v_mfma_f32_16x16x32_bf16 v[40:43], v[184:187], v[212:215], v[40:43]
s_waitcnt lgkmcnt(7)
v_mfma_f32_16x16x32_bf16 v[44:47], v[184:187], v[200:203], v[44:47]
ds_read_b128 v[200:203], v5 offset:28160
s_waitcnt lgkmcnt(7)
v_mfma_f32_16x16x32_bf16 v[32:35], v[72:75], v[244:247], v[32:35]
s_waitcnt lgkmcnt(6)
v_mfma_f32_16x16x32_bf16 v[32:35], v[96:99], v[248:251], v[32:35]
ds_read_b128 v[212:215], v5 offset:30720
v_mfma_f32_16x16x32_bf16 v[36:39], v[72:75], v[248:251], v[36:39]
s_waitcnt lgkmcnt(6)
v_mfma_f32_16x16x32_bf16 v[36:39], v[96:99], v[220:223], v[36:39]
ds_read_b128 v[244:247], v5 offset:33280
v_mfma_f32_16x16x32_bf16 v[32:35], v[100:103], v[220:223], v[32:35]
s_add_u32 s40, s44, 36864
s_waitcnt lgkmcnt(6)
v_mfma_f32_16x16x32_bf16 v[32:35], v[92:95], v[240:243], v[32:35]
ds_read_b128 v[220:223], v5 offset:35840
v_cvt_pk_bf16_f32 v40, v40, v41
v_mfma_f32_16x16x32_bf16 v[36:39], v[100:103], v[240:243], v[36:39]
v_cvt_pk_bf16_f32 v41, v42, v43
v_cvt_pk_bf16_f32 v42, v44, v45
s_waitcnt lgkmcnt(6)
v_mfma_f32_16x16x32_bf16 v[36:39], v[92:95], v[232:235], v[36:39]
v_cvt_pk_bf16_f32 v43, v46, v47
v_min_u32 v40, 0xfffffffe, v40
v_mfma_f32_16x16x32_bf16 v[32:35], v[120:123], v[232:235], v[32:35]
v_min_u32 v41, 0xfffffffe, v41
v_min_u32 v42, 0xfffffffe, v42
s_waitcnt lgkmcnt(5)
v_mfma_f32_16x16x32_bf16 v[32:35], v[132:135], v[188:191], v[32:35]
v_min_u32 v43, 0xfffffffe, v43
buffer_store_dwordx4 v[40:43], v14, s[28:31], s40 offen sc1
v_mfma_f32_16x16x32_bf16 v[36:39], v[120:123], v[188:191], v[36:39]
ds_read_b128 v[188:191], v5 offset:38400
ds_read_b128 v[232:235], v7 offset:20480
s_waitcnt lgkmcnt(6)
v_mfma_f32_16x16x32_bf16 v[36:39], v[132:135], v[236:239], v[36:39]
ds_read_b128 v[240:243], v7 offset:23040
L_pg1_0:
s_cbranch_scc1 L_ret
v_mfma_f32_16x16x32_bf16 v[32:35], v[84:87], v[236:239], v[32:35]
s_waitcnt lgkmcnt(6)
v_mfma_f32_16x16x32_bf16 v[32:35], v[48:51], v[200:203], v[32:35]
ds_read_b128 v[236:239], v7 offset:25600
v_mfma_f32_16x16x32_bf16 v[36:39], v[84:87], v[200:203], v[36:39]
s_waitcnt lgkmcnt(6)
v_mfma_f32_16x16x32_bf16 v[36:39], v[48:51], v[212:215], v[36:39]
ds_read_b128 v[200:203], v7 offset:28160
v_mfma_f32_16x16x32_bf16 v[32:35], v[88:91], v[212:215], v[32:35]
s_waitcnt lgkmcnt(6)
v_mfma_f32_16x16x32_bf16 v[32:35], v[108:111], v[244:247], v[32:35]
ds_read_b128 v[212:215], v7 offset:30720
v_mfma_f32_16x16x32_bf16 v[36:39], v[88:91], v[244:247], v[36:39]
s_waitcnt lgkmcnt(6)
v_mfma_f32_16x16x32_bf16 v[36:39], v[108:111], v[220:223], v[36:39]
ds_read_b128 v[244:247], v7 offset:33280
v_mfma_f32_16x16x32_bf16 v[32:35], v[68:71], v[220:223], v[32:35]
s_waitcnt lgkmcnt(6)
v_mfma_f32_16x16x32_bf16 v[32:35], v[136:139], v[188:191], v[32:35]
ds_read_b128 v[220:223], v7 offset:35840
v_mfma_f32_16x16x32_bf16 v[36:39], v[68:71], v[188:191], v[36:39]
s_waitcnt lgkmcnt(6)
v_mfma_f32_16x16x32_bf16 v[36:39], v[136:139], v[232:235], v[36:39]
ds_read_b128 v[188:191], v7 offset:38400
v_mfma_f32_16x16x32_bf16 v[32:35], v[140:143], v[232:235], v[32:35]
s_waitcnt lgkmcnt(6)
v_mfma_f32_16x16x32_bf16 v[32:35], v[56:59], v[240:243], v[32:35]
ds_read_b128 v[232:235], v9 offset:20480
v_mfma_f32_16x16x32_bf16 v[36:39], v[140:143], v[240:243], v[36:39]
s_waitcnt lgkmcnt(6)
v_mfma_f32_16x16x32_bf16 v[36:39], v[56:59], v[236:239], v[36:39]
ds_read_b128 v[240:243], v9 offset:23040
v_mfma_f32_16x16x32_bf16 v[32:35], v[148:151], v[236:239], v[32:35]
s_waitcnt lgkmcnt(6)
v_mfma_f32_16x16x32_bf16 v[32:35], v[152:155], v[200:203], v[32:35]
ds_read_b128 v[236:239], v9 offset:25600
v_mfma_f32_16x16x32_bf16 v[36:39], v[148:151], v[200:203], v[36:39]
s_waitcnt lgkmcnt(6)
v_mfma_f32_16x16x32_bf16 v[36:39], v[152:155], v[212:215], v[36:39]
ds_read_b128 v[200:203], v9 offset:28160
v_mfma_f32_16x16x32_bf16 v[32:35], v[156:159], v[212:215], v[32:35]
s_waitcnt lgkmcnt(6)
v_mfma_f32_16x16x32_bf16 v[32:35], v[64:67], v[244:247], v[32:35]
ds_read_b128 v[212:215], v9 offset:30720
v_mfma_f32_16x16x32_bf16 v[36:39], v[156:159], v[244:247], v[36:39]
s_waitcnt lgkmcnt(6)
v_mfma_f32_16x16x32_bf16 v[36:39], v[64:67], v[220:223], v[36:39]
ds_read_b128 v[244:247], v9 offset:33280
v_mfma_f32_16x16x32_bf16 v[32:35], v[164:167], v[220:223], v[32:35]
s_waitcnt lgkmcnt(6)
v_mfma_f32_16x16x32_bf16 v[32:35], v[168:171], v[188:191], v[32:35]
ds_read_b128 v[220:223], v9 offset:35840
v_mfma_f32_16x16x32_bf16 v[36:39], v[164:167], v[188:191], v[36:39]
s_waitcnt lgkmcnt(6)
v_mfma_f32_16x16x32_bf16 v[36:39], v[168:171], v[232:235], v[36:39]
ds_read_b128 v[188:191], v9 offset:38400
v_mfma_f32_16x16x32_bf16 v[32:35], v[80:83], v[232:235], v[32:35]
s_barrier
s_waitcnt lgkmcnt(6)
v_mfma_f32_16x16x32_bf16 v[32:35], v[176:179], v[240:243], v[32:35]
ds_read_b128 v[232:235], v11 offset:20480
v_mfma_f32_16x16x32_bf16 v[36:39], v[80:83], v[240:243], v[36:39]
s_waitcnt lgkmcnt(6)
v_mfma_f32_16x16x32_bf16 v[36:39], v[176:179], v[236:239], v[36:39]
ds_read_b128 v[240:243], v11 offset:23040
v_mfma_f32_16x16x32_bf16 v[32:35], v[104:107], v[236:239], v[32:35]
s_waitcnt lgkmcnt(6)
v_mfma_f32_16x16x32_bf16 v[32:35], v[60:63], v[200:203], v[32:35]
ds_read_b128 v[236:239], v11 offset:25600
v_mfma_f32_16x16x32_bf16 v[36:39], v[104:107], v[200:203], v[36:39]
s_waitcnt lgkmcnt(6)
v_mfma_f32_16x16x32_bf16 v[36:39], v[60:63], v[212:215], v[36:39]
ds_read_b128 v[200:203], v11 offset:28160
v_mfma_f32_16x16x32_bf16 v[32:35], v[124:127], v[212:215], v[32:35]
ds_read_b128 v[212:215], v3 offset:20480
s_waitcnt lgkmcnt(7)
v_mfma_f32_16x16x32_bf16 v[32:35], v[180:183], v[244:247], v[32:35]
ds_read_b128 v[248:251], v3 offset:23040
v_mfma_f32_16x16x32_bf16 v[36:39], v[124:127], v[244:247], v[36:39]
s_waitcnt lgkmcnt(7)
v_mfma_f32_16x16x32_bf16 v[36:39], v[180:183], v[220:223], v[36:39]
ds_read_b128 v[244:247], v3 offset:25600
v_mfma_f32_16x16x32_bf16 v[32:35], v[76:79], v[220:223], v[32:35]
s_waitcnt lgkmcnt(7)
v_mfma_f32_16x16x32_bf16 v[32:35], v[196:199], v[188:191], v[32:35]
ds_read_b128 v[220:223], v3 offset:28160
v_mfma_f32_16x16x32_bf16 v[36:39], v[76:79], v[188:191], v[36:39]
s_waitcnt lgkmcnt(7)
v_mfma_f32_16x16x32_bf16 v[36:39], v[196:199], v[232:235], v[36:39]
ds_read_b128 v[188:191], v3 offset:30720
v_mfma_f32_16x16x32_bf16 v[32:35], v[224:227], v[232:235], v[32:35]
s_waitcnt lgkmcnt(7)
v_mfma_f32_16x16x32_bf16 v[32:35], v[208:211], v[240:243], v[32:35]
ds_read_b128 v[232:235], v3 offset:33280
v_mfma_f32_16x16x32_bf16 v[36:39], v[224:227], v[240:243], v[36:39]
s_waitcnt lgkmcnt(7)
v_mfma_f32_16x16x32_bf16 v[36:39], v[208:211], v[236:239], v[36:39]
ds_read_b128 v[240:243], v3 offset:35840
v_mfma_f32_16x16x32_bf16 v[32:35], v[184:187], v[236:239], v[32:35]
s_waitcnt lgkmcnt(7)
v_mfma_f32_16x16x32_bf16 v[36:39], v[184:187], v[200:203], v[36:39]
ds_read_b128 v[200:203], v3 offset:38400
s_waitcnt lgkmcnt(7)
v_mfma_f32_16x16x32_bf16 v[16:19], v[72:75], v[212:215], v[16:19]
s_waitcnt lgkmcnt(6)
v_mfma_f32_16x16x32_bf16 v[16:19], v[96:99], v[248:251], v[16:19]
ds_read_b128 v[212:215], v5 offset:20480
v_mfma_f32_16x16x32_bf16 v[20:23], v[72:75], v[248:251], v[20:23]
s_waitcnt lgkmcnt(6)
v_mfma_f32_16x16x32_bf16 v[20:23], v[96:99], v[244:247], v[20:23]
ds_read_b128 v[236:239], v5 offset:23040
v_mfma_f32_16x16x32_bf16 v[16:19], v[100:103], v[244:247], v[16:19]
s_add_u32 s40, s44, 28672
s_waitcnt lgkmcnt(6)
v_mfma_f32_16x16x32_bf16 v[16:19], v[92:95], v[220:223], v[16:19]
ds_read_b128 v[244:247], v5 offset:25600
v_cvt_pk_bf16_f32 v32, v32, v33
v_mfma_f32_16x16x32_bf16 v[20:23], v[100:103], v[220:223], v[20:23]
v_cvt_pk_bf16_f32 v33, v34, v35
v_cvt_pk_bf16_f32 v34, v36, v37
s_waitcnt lgkmcnt(6)
v_mfma_f32_16x16x32_bf16 v[20:23], v[92:95], v[188:191], v[20:23]
v_cvt_pk_bf16_f32 v35, v38, v39
v_min_u32 v32, 0xfffffffe, v32
v_mfma_f32_16x16x32_bf16 v[16:19], v[120:123], v[188:191], v[16:19]
v_min_u32 v33, 0xfffffffe, v33
v_min_u32 v34, 0xfffffffe, v34
s_waitcnt lgkmcnt(5)
v_mfma_f32_16x16x32_bf16 v[16:19], v[132:135], v[232:235], v[16:19]
v_min_u32 v35, 0xfffffffe, v35
buffer_store_dwordx4 v[32:35], v14, s[28:31], s40 offen sc1
v_mfma_f32_16x16x32_bf16 v[20:23], v[120:123], v[232:235], v[20:23]
ds_read_b128 v[188:191], v5 offset:28160
ds_read_b128 v[220:223], v5 offset:30720
s_waitcnt lgkmcnt(6)
v_mfma_f32_16x16x32_bf16 v[20:23], v[132:135], v[240:243], v[20:23]
ds_read_b128 v[232:235], v5 offset:33280
v_mfma_f32_16x16x32_bf16 v[16:19], v[84:87], v[240:243], v[16:19]
s_waitcnt lgkmcnt(6)
v_mfma_f32_16x16x32_bf16 v[16:19], v[48:51], v[200:203], v[16:19]
ds_read_b128 v[240:243], v5 offset:35840
v_mfma_f32_16x16x32_bf16 v[20:23], v[84:87], v[200:203], v[20:23]
s_waitcnt lgkmcnt(6)
v_mfma_f32_16x16x32_bf16 v[20:23], v[48:51], v[212:215], v[20:23]
ds_read_b128 v[200:203], v5 offset:38400
v_mfma_f32_16x16x32_bf16 v[16:19], v[88:91], v[212:215], v[16:19]
s_waitcnt lgkmcnt(6)
v_mfma_f32_16x16x32_bf16 v[16:19], v[108:111], v[236:239], v[16:19]
ds_read_b128 v[212:215], v7 offset:20480
v_mfma_f32_16x16x32_bf16 v[20:23], v[88:91], v[236:239], v[20:23]
s_waitcnt lgkmcnt(6)
v_mfma_f32_16x16x32_bf16 v[20:23], v[108:111], v[244:247], v[20:23]
ds_read_b128 v[236:239], v7 offset:23040
v_mfma_f32_16x16x32_bf16 v[16:19], v[68:71], v[244:247], v[16:19]
s_waitcnt lgkmcnt(6)
v_mfma_f32_16x16x32_bf16 v[16:19], v[136:139], v[188:191], v[16:19]
ds_read_b128 v[244:247], v7 offset:25600
v_mfma_f32_16x16x32_bf16 v[20:23], v[68:71], v[188:191], v[20:23]
s_waitcnt lgkmcnt(6)
v_mfma_f32_16x16x32_bf16 v[20:23], v[136:139], v[220:223], v[20:23]
ds_read_b128 v[188:191], v7 offset:28160
v_mfma_f32_16x16x32_bf16 v[16:19], v[140:143], v[220:223], v[16:19]
s_waitcnt lgkmcnt(6)
v_mfma_f32_16x16x32_bf16 v[16:19], v[56:59], v[232:235], v[16:19]
ds_read_b128 v[220:223], v7 offset:30720
v_mfma_f32_16x16x32_bf16 v[20:23], v[140:143], v[232:235], v[20:23]
s_waitcnt lgkmcnt(6)
v_mfma_f32_16x16x32_bf16 v[20:23], v[56:59], v[240:243], v[20:23]
ds_read_b128 v[232:235], v7 offset:33280
v_mfma_f32_16x16x32_bf16 v[16:19], v[148:151], v[240:243], v[16:19]
s_waitcnt lgkmcnt(6)
v_mfma_f32_16x16x32_bf16 v[16:19], v[152:155], v[200:203], v[16:19]
ds_read_b128 v[240:243], v7 offset:35840
v_mfma_f32_16x16x32_bf16 v[20:23], v[148:151], v[200:203], v[20:23]
s_waitcnt lgkmcnt(6)
v_mfma_f32_16x16x32_bf16 v[20:23], v[152:155], v[212:215], v[20:23]
ds_read_b128 v[200:203], v7 offset:38400
v_mfma_f32_16x16x32_bf16 v[16:19], v[156:159], v[212:215], v[16:19]
s_waitcnt lgkmcnt(6)
v_mfma_f32_16x16x32_bf16 v[16:19], v[64:67], v[236:239], v[16:19]
ds_read_b128 v[212:215], v9 offset:20480
v_mfma_f32_16x16x32_bf16 v[20:23], v[156:159], v[236:239], v[20:23]
s_waitcnt lgkmcnt(6)
v_mfma_f32_16x16x32_bf16 v[20:23], v[64:67], v[244:247], v[20:23]
ds_read_b128 v[236:239], v9 offset:23040
v_mfma_f32_16x16x32_bf16 v[16:19], v[164:167], v[244:247], v[16:19]
s_barrier
s_waitcnt lgkmcnt(6)
v_mfma_f32_16x16x32_bf16 v[16:19], v[168:171], v[188:191], v[16:19]
ds_read_b128 v[244:247], v9 offset:25600
v_mfma_f32_16x16x32_bf16 v[20:23], v[164:167], v[188:191], v[20:23]
s_waitcnt lgkmcnt(6)
v_mfma_f32_16x16x32_bf16 v[20:23], v[168:171], v[220:223], v[20:23]
ds_read_b128 v[188:191], v9 offset:28160
v_mfma_f32_16x16x32_bf16 v[16:19], v[80:83], v[220:223], v[16:19]
s_waitcnt lgkmcnt(6)
v_mfma_f32_16x16x32_bf16 v[16:19], v[176:179], v[232:235], v[16:19]
ds_read_b128 v[220:223], v9 offset:30720
v_mfma_f32_16x16x32_bf16 v[20:23], v[80:83], v[232:235], v[20:23]
s_waitcnt lgkmcnt(6)
v_mfma_f32_16x16x32_bf16 v[20:23], v[176:179], v[240:243], v[20:23]
ds_read_b128 v[232:235], v9 offset:33280
v_mfma_f32_16x16x32_bf16 v[16:19], v[104:107], v[240:243], v[16:19]
s_waitcnt lgkmcnt(6)
v_mfma_f32_16x16x32_bf16 v[16:19], v[60:63], v[200:203], v[16:19]
ds_read_b128 v[240:243], v9 offset:35840
v_mfma_f32_16x16x32_bf16 v[20:23], v[104:107], v[200:203], v[20:23]
s_waitcnt lgkmcnt(6)
v_mfma_f32_16x16x32_bf16 v[20:23], v[60:63], v[212:215], v[20:23]
ds_read_b128 v[200:203], v9 offset:38400
v_mfma_f32_16x16x32_bf16 v[16:19], v[124:127], v[212:215], v[16:19]
ds_read_b128 v[212:215], v6 offset:35840
s_waitcnt lgkmcnt(7)
v_mfma_f32_16x16x32_bf16 v[16:19], v[180:183], v[236:239], v[16:19]
ds_read_b128 v[248:251], v6 offset:38400
v_mfma_f32_16x16x32_bf16 v[20:23], v[124:127], v[236:239], v[20:23]
s_waitcnt lgkmcnt(7)
v_mfma_f32_16x16x32_bf16 v[20:23], v[180:183], v[244:247], v[20:23]
ds_read_b128 v[236:239], v8 offset:20480
v_mfma_f32_16x16x32_bf16 v[16:19], v[76:79], v[244:247], v[16:19]
s_waitcnt lgkmcnt(7)
v_mfma_f32_16x16x32_bf16 v[16:19], v[196:199], v[188:191], v[16:19]
ds_read_b128 v[244:247], v8 offset:23040
v_mfma_f32_16x16x32_bf16 v[20:23], v[76:79], v[188:191], v[20:23]
s_waitcnt lgkmcnt(7)
v_mfma_f32_16x16x32_bf16 v[20:23], v[196:199], v[220:223], v[20:23]
ds_read_b128 v[188:191], v8 offset:25600
v_mfma_f32_16x16x32_bf16 v[16:19], v[224:227], v[220:223], v[16:19]
s_waitcnt lgkmcnt(7)
v_mfma_f32_16x16x32_bf16 v[16:19], v[208:211], v[232:235], v[16:19]
ds_read_b128 v[220:223], v8 offset:28160
v_mfma_f32_16x16x32_bf16 v[20:23], v[224:227], v[232:235], v[20:23]
s_waitcnt lgkmcnt(7)
v_mfma_f32_16x16x32_bf16 v[20:23], v[208:211], v[240:243], v[20:23]
ds_read_b128 v[232:235], v8 offset:30720
v_mfma_f32_16x16x32_bf16 v[16:19], v[184:187], v[240:243], v[16:19]
s_waitcnt lgkmcnt(7)
v_mfma_f32_16x16x32_bf16 v[20:23], v[184:187], v[200:203], v[20:23]
ds_read_b128 v[200:203], v8 offset:33280
s_waitcnt lgkmcnt(7)
v_mfma_f32_16x16x32_bf16 v[24:27], v[160:163], v[212:215], v[24:27]
s_add_u32 s41, s44, 20480
s_waitcnt lgkmcnt(6)
v_mfma_f32_16x16x32_bf16 v[24:27], v[172:175], v[248:251], v[24:27]
ds_read_b128 v[212:215], v8 offset:35840
v_mfma_f32_16x16x32_bf16 v[28:31], v[160:163], v[248:251], v[28:31]
s_waitcnt lgkmcnt(6)
v_mfma_f32_16x16x32_bf16 v[28:31], v[172:175], v[236:239], v[28:31]
ds_read_b128 v[160:163], v8 offset:38400
v_mfma_f32_16x16x32_bf16 v[24:27], v[144:147], v[236:239], v[24:27]
s_add_u32 s40, s44, 8192
s_waitcnt lgkmcnt(6)
v_mfma_f32_16x16x32_bf16 v[24:27], v[116:119], v[244:247], v[24:27]
ds_read_b128 v[172:175], v10 offset:20480
v_cvt_pk_bf16_f32 v16, v16, v17
v_mfma_f32_16x16x32_bf16 v[28:31], v[144:147], v[244:247], v[28:31]
v_cvt_pk_bf16_f32 v17, v18, v19
v_cvt_pk_bf16_f32 v18, v20, v21
s_waitcnt lgkmcnt(6)
v_mfma_f32_16x16x32_bf16 v[28:31], v[116:119], v[188:191], v[28:31]
v_cvt_pk_bf16_f32 v19, v22, v23
v_min_u32 v16, 0xfffffffe, v16
v_mfma_f32_16x16x32_bf16 v[24:27], v[192:195], v[188:191], v[24:27]
v_min_u32 v17, 0xfffffffe, v17
v_min_u32 v18, 0xfffffffe, v18
s_waitcnt lgkmcnt(5)
v_mfma_f32_16x16x32_bf16 v[24:27], v[112:115], v[220:223], v[24:27]
v_min_u32 v19, 0xfffffffe, v19
buffer_store_dwordx4 v[16:19], v14, s[28:31], s40 offen sc1
v_mfma_f32_16x16x32_bf16 v[28:31], v[192:195], v[220:223], v[28:31]
ds_read_b128 v[116:119], v10 offset:23040
ds_read_b128 v[144:147], v3 offset:25600
s_waitcnt lgkmcnt(6)
v_mfma_f32_16x16x32_bf16 v[28:31], v[112:115], v[232:235], v[28:31]
ds_read_b128 v[112:115], v3 offset:28160
v_mfma_f32_16x16x32_bf16 v[24:27], v[204:207], v[232:235], v[24:27]
ds_read_b128 v[188:191], v3 offset:30720
s_waitcnt lgkmcnt(7)
v_mfma_f32_16x16x32_bf16 v[24:27], v[52:55], v[200:203], v[24:27]
ds_read_b128 v[192:195], v3 offset:33280
v_mfma_f32_16x16x32_bf16 v[28:31], v[204:207], v[200:203], v[28:31]
s_waitcnt lgkmcnt(7)
v_mfma_f32_16x16x32_bf16 v[28:31], v[52:55], v[212:215], v[28:31]
ds_read_b128 v[52:55], v3 offset:35840
v_mfma_f32_16x16x32_bf16 v[24:27], v[216:219], v[212:215], v[24:27]
s_waitcnt lgkmcnt(7)
v_mfma_f32_16x16x32_bf16 v[24:27], v[128:131], v[160:163], v[24:27]
ds_read_b128 v[200:203], v3 offset:38400
v_mfma_f32_16x16x32_bf16 v[28:31], v[216:219], v[160:163], v[28:31]
s_waitcnt lgkmcnt(7)
v_mfma_f32_16x16x32_bf16 v[28:31], v[128:131], v[172:175], v[28:31]
ds_read_b128 v[128:131], v5 offset:20480
v_mfma_f32_16x16x32_bf16 v[24:27], v[228:231], v[172:175], v[24:27]
s_waitcnt lgkmcnt(7)
v_mfma_f32_16x16x32_bf16 v[28:31], v[228:231], v[116:119], v[28:31]
ds_read_b128 v[116:119], v5 offset:23040
s_waitcnt lgkmcnt(7)
v_mfma_f32_16x16x32_bf16 v[24:27], v[72:75], v[144:147], v[24:27]
s_waitcnt lgkmcnt(6)
v_mfma_f32_16x16x32_bf16 v[24:27], v[96:99], v[112:115], v[24:27]
ds_read_b128 v[144:147], v5 offset:25600
v_mfma_f32_16x16x32_bf16 v[28:31], v[72:75], v[112:115], v[28:31]
s_waitcnt lgkmcnt(6)
v_mfma_f32_16x16x32_bf16 v[28:31], v[96:99], v[188:191], v[28:31]
ds_read_b128 v[72:75], v5 offset:28160
v_mfma_f32_16x16x32_bf16 v[24:27], v[100:103], v[188:191], v[24:27]
s_waitcnt lgkmcnt(6)
v_mfma_f32_16x16x32_bf16 v[24:27], v[92:95], v[192:195], v[24:27]
ds_read_b128 v[96:99], v5 offset:30720
v_mfma_f32_16x16x32_bf16 v[28:31], v[100:103], v[192:195], v[28:31]
s_waitcnt lgkmcnt(6)
v_mfma_f32_16x16x32_bf16 v[28:31], v[92:95], v[52:55], v[28:31]
ds_read_b128 v[92:95], v5 offset:33280
v_mfma_f32_16x16x32_bf16 v[24:27], v[120:123], v[52:55], v[24:27]
s_waitcnt lgkmcnt(6)
v_mfma_f32_16x16x32_bf16 v[24:27], v[132:135], v[200:203], v[24:27]
ds_read_b128 v[52:55], v5 offset:35840
v_mfma_f32_16x16x32_bf16 v[28:31], v[120:123], v[200:203], v[28:31]
s_waitcnt lgkmcnt(6)
v_mfma_f32_16x16x32_bf16 v[28:31], v[132:135], v[128:131], v[28:31]
ds_read_b128 v[100:103], v5 offset:38400
v_mfma_f32_16x16x32_bf16 v[24:27], v[84:87], v[128:131], v[24:27]
s_waitcnt lgkmcnt(6)
v_mfma_f32_16x16x32_bf16 v[24:27], v[48:51], v[116:119], v[24:27]
ds_read_b128 v[112:115], v7 offset:20480
v_mfma_f32_16x16x32_bf16 v[28:31], v[84:87], v[116:119], v[28:31]
s_waitcnt lgkmcnt(6)
v_mfma_f32_16x16x32_bf16 v[28:31], v[48:51], v[144:147], v[28:31]
ds_read_b128 v[48:51], v7 offset:23040
v_mfma_f32_16x16x32_bf16 v[24:27], v[88:91], v[144:147], v[24:27]
s_waitcnt lgkmcnt(6)
v_mfma_f32_16x16x32_bf16 v[24:27], v[108:111], v[72:75], v[24:27]
ds_read_b128 v[84:87], v7 offset:25600
v_mfma_f32_16x16x32_bf16 v[28:31], v[88:91], v[72:75], v[28:31]
s_waitcnt lgkmcnt(6)
v_mfma_f32_16x16x32_bf16 v[28:31], v[108:111], v[96:99], v[28:31]
ds_read_b128 v[72:75], v7 offset:28160
v_mfma_f32_16x16x32_bf16 v[24:27], v[68:71], v[96:99], v[24:27]
s_waitcnt lgkmcnt(6)
v_mfma_f32_16x16x32_bf16 v[24:27], v[136:139], v[92:95], v[24:27]
ds_read_b128 v[88:91], v7 offset:30720
v_mfma_f32_16x16x32_bf16 v[28:31], v[68:71], v[92:95], v[28:31]
buffer_load_dwordx4 v[68:71], v14, s[28:31], s41 offen offset:0 sc1
s_waitcnt lgkmcnt(6)
v_mfma_f32_16x16x32_bf16 v[28:31], v[136:139], v[52:55], v[28:31]
ds_read_b128 v[92:95], v7 offset:33280
v_mfma_f32_16x16x32_bf16 v[24:27], v[140:143], v[52:55], v[24:27]
s_waitcnt lgkmcnt(6)
v_mfma_f32_16x16x32_bf16 v[24:27], v[56:59], v[100:103], v[24:27]
ds_read_b128 v[52:55], v7 offset:35840
v_mfma_f32_16x16x32_bf16 v[28:31], v[140:143], v[100:103], v[28:31]
s_waitcnt lgkmcnt(6)
v_mfma_f32_16x16x32_bf16 v[28:31], v[56:59], v[112:115], v[28:31]
ds_read_b128 v[56:59], v7 offset:38400
v_mfma_f32_16x16x32_bf16 v[24:27], v[148:151], v[112:115], v[24:27]
s_waitcnt lgkmcnt(6)
v_mfma_f32_16x16x32_bf16 v[24:27], v[152:155], v[48:51], v[24:27]
ds_read_b128 v[96:99], v9 offset:20480
v_mfma_f32_16x16x32_bf16 v[28:31], v[148:151], v[48:51], v[28:31]
s_waitcnt lgkmcnt(6)
v_mfma_f32_16x16x32_bf16 v[28:31], v[152:155], v[84:87], v[28:31]
ds_read_b128 v[48:51], v9 offset:23040
v_mfma_f32_16x16x32_bf16 v[24:27], v[156:159], v[84:87], v[24:27]
s_waitcnt lgkmcnt(6)
v_mfma_f32_16x16x32_bf16 v[24:27], v[64:67], v[72:75], v[24:27]
ds_read_b128 v[84:87], v9 offset:25600
v_mfma_f32_16x16x32_bf16 v[28:31], v[156:159], v[72:75], v[28:31]
s_waitcnt lgkmcnt(6)
v_mfma_f32_16x16x32_bf16 v[28:31], v[64:67], v[88:91], v[28:31]
ds_read_b128 v[64:67], v9 offset:28160
v_mfma_f32_16x16x32_bf16 v[24:27], v[164:167], v[88:91], v[24:27]
buffer_load_dwordx4 v[72:75], v14, s[28:31], s41 offen offset:0 sc1
s_waitcnt lgkmcnt(6)
v_mfma_f32_16x16x32_bf16 v[24:27], v[168:171], v[92:95], v[24:27]
ds_read_b128 v[88:91], v9 offset:30720
v_mfma_f32_16x16x32_bf16 v[28:31], v[164:167], v[92:95], v[28:31]
s_waitcnt lgkmcnt(6)
v_mfma_f32_16x16x32_bf16 v[28:31], v[168:171], v[52:55], v[28:31]
ds_read_b128 v[92:95], v9 offset:33280
v_mfma_f32_16x16x32_bf16 v[24:27], v[80:83], v[52:55], v[24:27]
s_waitcnt lgkmcnt(6)
v_mfma_f32_16x16x32_bf16 v[24:27], v[176:179], v[56:59], v[24:27]
ds_read_b128 v[52:55], v9 offset:35840
v_mfma_f32_16x16x32_bf16 v[28:31], v[80:83], v[56:59], v[28:31]
s_waitcnt lgkmcnt(6)
v_mfma_f32_16x16x32_bf16 v[28:31], v[176:179], v[96:99], v[28:31]
ds_read_b128 v[56:59], v9 offset:38400
v_mfma_f32_16x16x32_bf16 v[24:27], v[104:107], v[96:99], v[24:27]
s_waitcnt lgkmcnt(6)
v_mfma_f32_16x16x32_bf16 v[24:27], v[60:63], v[48:51], v[24:27]
ds_read_b128 v[80:83], v11 offset:20480
v_mfma_f32_16x16x32_bf16 v[28:31], v[104:107], v[48:51], v[28:31]
s_waitcnt lgkmcnt(6)
v_mfma_f32_16x16x32_bf16 v[28:31], v[60:63], v[84:87], v[28:31]
ds_read_b128 v[48:51], v11 offset:23040
v_mfma_f32_16x16x32_bf16 v[24:27], v[124:127], v[84:87], v[24:27]
s_waitcnt lgkmcnt(6)
v_mfma_f32_16x16x32_bf16 v[24:27], v[180:183], v[64:67], v[24:27]
v_mfma_f32_16x16x32_bf16 v[28:31], v[124:127], v[64:67], v[28:31]
s_waitcnt lgkmcnt(5)
v_mfma_f32_16x16x32_bf16 v[28:31], v[180:183], v[88:91], v[28:31]
v_mfma_f32_16x16x32_bf16 v[24:27], v[76:79], v[88:91], v[24:27]
s_waitcnt lgkmcnt(4)
v_mfma_f32_16x16x32_bf16 v[24:27], v[196:199], v[92:95], v[24:27]
v_mfma_f32_16x16x32_bf16 v[28:31], v[76:79], v[92:95], v[28:31]
s_waitcnt lgkmcnt(3)
v_mfma_f32_16x16x32_bf16 v[28:31], v[196:199], v[52:55], v[28:31]
v_mfma_f32_16x16x32_bf16 v[24:27], v[224:227], v[52:55], v[24:27]
s_waitcnt lgkmcnt(2)
v_mfma_f32_16x16x32_bf16 v[24:27], v[208:211], v[56:59], v[24:27]
v_mfma_f32_16x16x32_bf16 v[28:31], v[224:227], v[56:59], v[28:31]
s_waitcnt lgkmcnt(1)
v_mfma_f32_16x16x32_bf16 v[28:31], v[208:211], v[80:83], v[28:31]
v_mfma_f32_16x16x32_bf16 v[24:27], v[184:187], v[80:83], v[24:27]
s_waitcnt lgkmcnt(0)
v_mfma_f32_16x16x32_bf16 v[28:31], v[184:187], v[48:51], v[28:31]
L_pl1:
s_waitcnt vmcnt(1)
v_max3_u32 v56, v68, v69, v70
v_max_u32 v56, v56, v71
v_cmp_eq_u32 vcc, -1, v56
s_cbranch_vccz L_got1_0
buffer_load_dwordx4 v[68:71], v14, s[28:31], s41 offen offset:0 sc1
s_waitcnt vmcnt(1)
v_max3_u32 v56, v72, v73, v74
v_max_u32 v56, v56, v75
v_cmp_eq_u32 vcc, -1, v56
s_cbranch_vccz L_got1_1
buffer_load_dwordx4 v[72:75], v14, s[28:31], s41 offen offset:0 sc1
s_branch L_pl1
L_got1_1:
v_lshlrev_b32 v48, 16, v72
v_and_b32 v49, 0xffff0000, v72
v_lshlrev_b32 v50, 16, v73
v_and_b32 v51, 0xffff0000, v73
v_lshlrev_b32 v52, 16, v74
v_and_b32 v53, 0xffff0000, v74
v_lshlrev_b32 v54, 16, v75
v_and_b32 v55, 0xffff0000, v75
s_branch L_ok1
L_got1_0:
v_lshlrev_b32 v48, 16, v68
v_and_b32 v49, 0xffff0000, v68
v_lshlrev_b32 v50, 16, v69
v_and_b32 v51, 0xffff0000, v69
v_lshlrev_b32 v52, 16, v70
v_and_b32 v53, 0xffff0000, v70
v_lshlrev_b32 v54, 16, v71
v_and_b32 v55, 0xffff0000, v71
L_ok1:
v_add_f32 v48, v24, v48
v_add_f32 v49, v25, v49
v_add_f32 v50, v26, v50
v_add_f32 v51, v27, v51
v_add_f32 v52, v28, v52
v_add_f32 v53, v29, v53
v_add_f32 v54, v30, v54
v_add_f32 v55, v31, v55
v_mul_f32 v48, s45, v48
v_mul_f32 v49, s45, v49
v_mul_f32 v50, s45, v50
v_mul_f32 v51, s45, v51
v_mul_f32 v52, s45, v52
v_mul_f32 v53, s45, v53
v_mul_f32 v54, s45, v54
v_mul_f32 v55, s45, v55
s_barrier
ds_read_b128 v[60:63], v1 offset:0
ds_read_b128 v[64:67], v1 offset:1024
v_exp_f32 v48, v48
v_exp_f32 v49, v49
v_exp_f32 v50, v50
v_exp_f32 v51, v51
v_exp_f32 v52, v52
v_exp_f32 v53, v53
v_exp_f32 v54, v54
v_exp_f32 v55, v55
v_fma_f32 v48, v48, 0.5, 0.5
v_fma_f32 v49, v49, 0.5, 0.5
v_fma_f32 v50, v50, 0.5, 0.5
v_fma_f32 v51, v51, 0.5, 0.5
v_fma_f32 v52, v52, 0.5, 0.5
v_fma_f32 v53, v53, 0.5, 0.5
v_fma_f32 v54, v54, 0.5, 0.5
v_fma_f32 v55, v55, 0.5, 0.5
v_rcp_f32 v48, v48
v_rcp_f32 v49, v49
v_rcp_f32 v50, v50
v_rcp_f32 v51, v51
v_rcp_f32 v52, v52
v_rcp_f32 v53, v53
v_rcp_f32 v54, v54
v_rcp_f32 v55, v55
s_waitcnt lgkmcnt(0)
v_fma_f32 v48, -v48, v60, v60
v_fma_f32 v49, -v49, v61, v61
v_fma_f32 v50, -v50, v62, v62
v_fma_f32 v51, -v51, v63, v63
v_cvt_pk_bf16_f32 v24, v48, v49
v_cvt_pk_bf16_f32 v25, v50, v51
buffer_store_dwordx2 v[24:25], v15, s[24:27], 0 offen offset:0
v_fma_f32 v52, -v52, v64, v64
v_fma_f32 v53, -v53, v65, v65
v_fma_f32 v54, -v54, v66, v66
v_fma_f32 v55, -v55, v67, v67
v_cvt_pk_bf16_f32 v26, v52, v53
v_cvt_pk_bf16_f32 v27, v54, v55
buffer_store_dwordx2 v[26:27], v15, s[24:27], 0 offen offset:1024
s_endpgm
.p2align 6
L_warm2:
s_setpc_b64 s[50:51]
L_fin2:
s_cmp_eq_u32 0, 1
v_mfma_f32_16x16x32_bf16 v[40:43], v[76:79], v[52:55], v[40:43]
ds_read_b64_tr_b16 v[178:179], v13 offset:20992
s_waitcnt lgkmcnt(9)
v_mfma_f32_16x16x32_bf16 v[40:43], v[144:147], v[124:127], v[40:43]
ds_read_b128 v[180:183], v8 offset:28160
v_mfma_f32_16x16x32_bf16 v[44:47], v[76:79], v[124:127], v[44:47]
ds_read_b128 v[76:79], v8 offset:30720
s_waitcnt lgkmcnt(8)
v_mfma_f32_16x16x32_bf16 v[44:47], v[144:147], v[128:131], v[44:47]
ds_read_b64_tr_b16 v[144:145], v13 offset:24576
s_waitcnt lgkmcnt(7)
v_mfma_f32_16x16x32_bf16 v[16:19], v[160:163], v[116:119], v[16:19]
ds_read_b64_tr_b16 v[146:147], v13 offset:25088
s_waitcnt lgkmcnt(6)
v_mfma_f32_16x16x32_bf16 v[16:19], v[172:175], v[104:107], v[16:19]
ds_read_b64_tr_b16 v[116:117], v13 offset:28672
v_mfma_f32_16x16x32_bf16 v[20:23], v[160:163], v[104:107], v[20:23]
ds_read_b64_tr_b16 v[118:119], v13 offset:29184
v_mfma_f32_16x16x32_bf16 v[20:23], v[172:175], v[112:115], v[20:23]
v_mfma_f32_16x16x32_bf16 v[24:27], v[160:163], v[112:115], v[24:27]
v_mfma_f32_16x16x32_bf16 v[24:27], v[172:175], v[60:63], v[24:27]
v_mfma_f32_16x16x32_bf16 v[28:31], v[160:163], v[60:63], v[28:31]
s_waitcnt lgkmcnt(6)
s_barrier
ds_read_b64_tr_b16 v[104:105], v13 offset:32768
v_mfma_f32_16x16x32_bf16 v[28:31], v[172:175], v[52:55], v[28:31]
ds_read_b64_tr_b16 v[106:107], v13 offset:33280
v_mfma_f32_16x16x32_bf16 v[40:43], v[160:163], v[128:131], v[40:43]
ds_read_b128 v[184:187], v8 offset:33280
s_waitcnt lgkmcnt(8)
v_mfma_f32_16x16x32_bf16 v[40:43], v[172:175], v[180:183], v[40:43]
ds_read_b128 v[188:191], v8 offset:35840
v_mfma_f32_16x16x32_bf16 v[44:47], v[160:163], v[180:183], v[44:47]
ds_read_b64_tr_b16 v[192:193], v13 offset:36864
s_waitcnt lgkmcnt(9)
v_mfma_f32_16x16x32_bf16 v[44:47], v[172:175], v[76:79], v[44:47]
ds_read_b64_tr_b16 v[194:195], v13 offset:37376
s_waitcnt lgkmcnt(8)
v_mfma_f32_16x16x32_bf16 v[16:19], v[144:147], v[112:115], v[16:19]
ds_read_b64_tr_b16 v[112:113], v13 offset:40960
s_waitcnt lgkmcnt(7)
v_mfma_f32_16x16x32_bf16 v[16:19], v[116:119], v[60:63], v[16:19]
ds_read_b64_tr_b16 v[114:115], v13 offset:41472
v_mfma_f32_16x16x32_bf16 v[20:23], v[144:147], v[60:63], v[20:23]
v_mfma_f32_16x16x32_bf16 v[20:23], v[116:119], v[52:55], v[20:23]
v_mfma_f32_16x16x32_bf16 v[24:27], v[144:147], v[52:55], v[24:27]
v_mfma_f32_16x16x32_bf16 v[24:27], v[116:119], v[124:127], v[24:27]
ds_read_b64_tr_b16 v[60:61], v13 offset:45056
v_mfma_f32_16x16x32_bf16 v[28:31], v[144:147], v[124:127], v[28:31]
ds_read_b64_tr_b16 v[62:63], v13 offset:45568
v_mfma_f32_16x16x32_bf16 v[28:31], v[116:119], v[128:131], v[28:31]
ds_read_b128 v[196:199], v8 offset:38400
v_mfma_f32_16x16x32_bf16 v[40:43], v[144:147], v[76:79], v[40:43]
s_waitcnt lgkmcnt(8)
v_mfma_f32_16x16x32_bf16 v[40:43], v[116:119], v[184:187], v[40:43]
ds_read_b128 v[200:203], v10 offset:20480
v_mfma_f32_16x16x32_bf16 v[44:47], v[144:147], v[184:187], v[44:47]
ds_read_b64_tr_b16 v[204:205], v12 offset:0
s_waitcnt lgkmcnt(9)
v_mfma_f32_16x16x32_bf16 v[44:47], v[116:119], v[188:191], v[44:47]
ds_read_b64_tr_b16 v[206:207], v12 offset:512
s_waitcnt lgkmcnt(8)
v_mfma_f32_16x16x32_bf16 v[16:19], v[192:195], v[52:55], v[16:19]
ds_read_b64_tr_b16 v[52:53], v12 offset:4096
s_waitcnt lgkmcnt(7)
v_mfma_f32_16x16x32_bf16 v[16:19], v[112:115], v[124:127], v[16:19]
ds_read_b64_tr_b16 v[54:55], v12 offset:4608
v_mfma_f32_16x16x32_bf16 v[20:23], v[192:195], v[124:127], v[20:23]
v_mfma_f32_16x16x32_bf16 v[20:23], v[112:115], v[128:131], v[20:23]
v_mfma_f32_16x16x32_bf16 v[24:27], v[192:195], v[128:131], v[24:27]
ds_read_b64_tr_b16 v[124:125], v12 offset:8192
v_mfma_f32_16x16x32_bf16 v[24:27], v[112:115], v[180:183], v[24:27]
ds_read_b64_tr_b16 v[126:127], v12 offset:8704
v_mfma_f32_16x16x32_bf16 v[28:31], v[192:195], v[180:183], v[28:31]
v_mfma_f32_16x16x32_bf16 v[28:31], v[112:115], v[76:79], v[28:31]
ds_read_b128 v[208:211], v10 offset:23040
v_mfma_f32_16x16x32_bf16 v[40:43], v[192:195], v[188:191], v[40:43]
s_waitcnt lgkmcnt(8)
v_mfma_f32_16x16x32_bf16 v[40:43], v[112:115], v[196:199], v[40:43]
ds_read_b128 v[212:215], v10 offset:25600
v_mfma_f32_16x16x32_bf16 v[44:47], v[192:195], v[196:199], v[44:47]
ds_read_b64_tr_b16 v[216:217], v12 offset:12288
s_waitcnt lgkmcnt(9)
v_mfma_f32_16x16x32_bf16 v[44:47], v[112:115], v[200:203], v[44:47]
ds_read_b64_tr_b16 v[218:219], v12 offset:12800
s_waitcnt lgkmcnt(8)
v_mfma_f32_16x16x32_bf16 v[16:19], v[204:207], v[128:131], v[16:19]
ds_read_b64_tr_b16 v[128:129], v12 offset:16384
s_waitcnt lgkmcnt(7)
L_pg2_0:
s_cbranch_scc1 L_ret
v_mfma_f32_16x16x32_bf16 v[16:19], v[52:55], v[180:183], v[16:19]
ds_read_b64_tr_b16 v[130:131], v12 offset:16896
v_mfma_f32_16x16x32_bf16 v[20:23], v[204:207], v[180:183], v[20:23]
v_mfma_f32_16x16x32_bf16 v[20:23], v[52:55], v[76:79], v[20:23]
v_mfma_f32_16x16x32_bf16 v[24:27], v[204:207], v[76:79], v[24:27]
s_waitcnt lgkmcnt(6)
s_barrier
ds_read_b64_tr_b16 v[180:181], v12 offset:20480
v_mfma_f32_16x16x32_bf16 v[24:27], v[52:55], v[184:187], v[24:27]
ds_read_b64_tr_b16 v[182:183], v12 offset:20992
v_mfma_f32_16x16x32_bf16 v[28:31], v[204:207], v[184:187], v[28:31]
v_mfma_f32_16x16x32_bf16 v[28:31], v[52:55], v[188:191], v[28:31]
ds_read_b128 v[220:223], v10 offset:28160
v_mfma_f32_16x16x32_bf16 v[40:43], v[204:207], v[200:203], v[40:43]
s_waitcnt lgkmcnt(8)
v_mfma_f32_16x16x32_bf16 v[40:43], v[52:55], v[208:211], v[40:43]
ds_read_b128 v[224:227], v10 offset:30720
v_mfma_f32_16x16x32_bf16 v[44:47], v[204:207], v[208:211], v[44:47]
ds_read_b64_tr_b16 v[228:229], v12 offset:24576
s_waitcnt lgkmcnt(9)
v_mfma_f32_16x16x32_bf16 v[44:47], v[52:55], v[212:215], v[44:47]
ds_read_b64_tr_b16 v[230:231], v12 offset:25088
s_waitcnt lgkmcnt(8)
v_mfma_f32_16x16x32_bf16 v[16:19], v[216:219], v[76:79], v[16:19]
s_waitcnt lgkmcnt(6)
v_mfma_f32_16x16x32_bf16 v[16:19], v[128:131], v[184:187], v[16:19]
v_mfma_f32_16x16x32_bf16 v[20:23], v[216:219], v[184:187], v[20:23]
v_mfma_f32_16x16x32_bf16 v[20:23], v[128:131], v[188:191], v[20:23]
ds_read_b64_tr_b16 v[76:77], v12 offset:28672
v_mfma_f32_16x16x32_bf16 v[24:27], v[216:219], v[188:191], v[24:27]
ds_read_b64_tr_b16 v[78:79], v12 offset:29184
v_mfma_f32_16x16x32_bf16 v[24:27], v[128:131], v[196:199], v[24:27]
ds_read_b128 v[184:187], v10 offset:33280
v_mfma_f32_16x16x32_bf16 v[28:31], v[216:219], v[196:199], v[28:31]
ds_read_b128 v[232:235], v3 offset:20480
v_mfma_f32_16x16x32_bf16 v[28:31], v[128:131], v[200:203], v[28:31]
ds_read_b128 v[236:239], v3 offset:23040
v_mfma_f32_16x16x32_bf16 v[40:43], v[216:219], v[212:215], v[40:43]
ds_read_b128 v[212:215], v3 offset:25600
s_waitcnt lgkmcnt(9)
v_mfma_f32_16x16x32_bf16 v[40:43], v[128:131], v[220:223], v[40:43]
ds_read_b128 v[240:243], v3 offset:28160
v_mfma_f32_16x16x32_bf16 v[44:47], v[216:219], v[220:223], v[44:47]
s_waitcnt lgkmcnt(9)
v_mfma_f32_16x16x32_bf16 v[44:47], v[128:131], v[224:227], v[44:47]
ds_read_b128 v[220:223], v3 offset:30720
s_waitcnt lgkmcnt(8)
v_mfma_f32_16x16x32_bf16 v[16:19], v[228:231], v[188:191], v[16:19]
v_mfma_f32_16x16x32_bf16 v[20:23], v[228:231], v[196:199], v[20:23]
ds_read_b128 v[188:191], v3 offset:33280
v_mfma_f32_16x16x32_bf16 v[24:27], v[228:231], v[200:203], v[24:27]
ds_read_b64_tr_b16 v[196:197], v12 offset:32768
v_mfma_f32_16x16x32_bf16 v[28:31], v[228:231], v[208:211], v[28:31]
ds_read_b64_tr_b16 v[198:199], v12 offset:33280
v_mfma_f32_16x16x32_bf16 v[40:43], v[228:231], v[224:227], v[40:43]
ds_read_b128 v[200:203], v3 offset:35840
s_waitcnt lgkmcnt(9)
v_mfma_f32_16x16x32_bf16 v[44:47], v[228:231], v[184:187], v[44:47]
ds_read_b128 v[184:187], v3 offset:38400
s_waitcnt lgkmcnt(9)
v_mfma_f32_16x16x32_bf16 v[16:19], v[72:75], v[232:235], v[16:19]
s_waitcnt lgkmcnt(8)
v_mfma_f32_16x16x32_bf16 v[16:19], v[96:99], v[236:239], v[16:19]
ds_read_b128 v[208:211], v5 offset:20480
v_mfma_f32_16x16x32_bf16 v[20:23], v[72:75], v[236:239], v[20:23]
s_waitcnt lgkmcnt(8)
v_mfma_f32_16x16x32_bf16 v[20:23], v[96:99], v[212:215], v[20:23]
ds_read_b128 v[224:227], v5 offset:23040
v_mfma_f32_16x16x32_bf16 v[16:19], v[100:103], v[212:215], v[16:19]
s_waitcnt lgkmcnt(8)
v_mfma_f32_16x16x32_bf16 v[16:19], v[92:95], v[240:243], v[16:19]
ds_read_b128 v[212:215], v5 offset:25600
v_mfma_f32_16x16x32_bf16 v[20:23], v[100:103], v[240:243], v[20:23]
s_waitcnt lgkmcnt(8)
v_mfma_f32_16x16x32_bf16 v[20:23], v[92:95], v[220:223], v[20:23]
s_waitcnt lgkmcnt(5)
s_barrier
ds_read_b64_tr_b16 v[232:233], v12 offset:36864
v_mfma_f32_16x16x32_bf16 v[16:19], v[120:123], v[220:223], v[16:19]
ds_read_b64_tr_b16 v[234:235], v12 offset:37376
v_mfma_f32_16x16x32_bf16 v[16:19], v[132:135], v[188:191], v[16:19]
ds_read_b128 v[220:223], v5 offset:28160
v_mfma_f32_16x16x32_bf16 v[20:23], v[120:123], v[188:191], v[20:23]
ds_read_b128 v[188:191], v5 offset:30720
s_waitcnt lgkmcnt(8)
v_mfma_f32_16x16x32_bf16 v[20:23], v[132:135], v[200:203], v[20:23]
ds_read_b128 v[236:239], v5 offset:33280
v_mfma_f32_16x16x32_bf16 v[16:19], v[84:87], v[200:203], v[16:19]
s_waitcnt lgkmcnt(8)
v_mfma_f32_16x16x32_bf16 v[16:19], v[48:51], v[184:187], v[16:19]
ds_read_b128 v[200:203], v5 offset:35840
v_mfma_f32_16x16x32_bf16 v[20:23], v[84:87], v[184:187], v[20:23]
s_waitcnt lgkmcnt(8)
v_mfma_f32_16x16x32_bf16 v[20:23], v[48:51], v[208:211], v[20:23]
ds_read_b128 v[184:187], v5 offset:38400
v_mfma_f32_16x16x32_bf16 v[16:19], v[88:91], v[208:211], v[16:19]
s_waitcnt lgkmcnt(8)
v_mfma_f32_16x16x32_bf16 v[16:19], v[108:111], v[224:227], v[16:19]
ds_read_b128 v[208:211], v7 offset:20480
v_mfma_f32_16x16x32_bf16 v[20:23], v[88:91], v[224:227], v[20:23]
ds_read_b64_tr_b16 v[224:225], v12 offset:40960
s_waitcnt lgkmcnt(9)
v_mfma_f32_16x16x32_bf16 v[20:23], v[108:111], v[212:215], v[20:23]
ds_read_b64_tr_b16 v[226:227], v12 offset:41472
v_mfma_f32_16x16x32_bf16 v[16:19], v[68:71], v[212:215], v[16:19]
ds_read_b128 v[212:215], v7 offset:23040
s_waitcnt lgkmcnt(8)
v_mfma_f32_16x16x32_bf16 v[16:19], v[136:139], v[220:223], v[16:19]
ds_read_b128 v[240:243], v7 offset:25600
v_mfma_f32_16x16x32_bf16 v[20:23], v[68:71], v[220:223], v[20:23]
s_waitcnt lgkmcnt(8)
v_mfma_f32_16x16x32_bf16 v[20:23], v[136:139], v[188:191], v[20:23]
ds_read_b128 v[220:223], v7 offset:28160
v_mfma_f32_16x16x32_bf16 v[16:19], v[140:143], v[188:191], v[16:19]
s_waitcnt lgkmcnt(8)
v_mfma_f32_16x16x32_bf16 v[16:19], v[56:59], v[236:239], v[16:19]
ds_read_b128 v[188:191], v7 offset:30720
v_mfma_f32_16x16x32_bf16 v[20:23], v[140:143], v[236:239], v[20:23]
s_waitcnt lgkmcnt(8)
v_mfma_f32_16x16x32_bf16 v[20:23], v[56:59], v[200:203], v[20:23]
ds_read_b128 v[236:239], v7 offset:33280
v_mfma_f32_16x16x32_bf16 v[16:19], v[148:151], v[200:203], v[16:19]
s_waitcnt lgkmcnt(8)
v_mfma_f32_16x16x32_bf16 v[16:19], v[152:155], v[184:187], v[16:19]
ds_read_b128 v[200:203], v7 offset:35840
v_mfma_f32_16x16x32_bf16 v[20:23], v[148:151], v[184:187], v[20:23]
ds_read_b64_tr_b16 v[184:185], v12 offset:45056
s_waitcnt lgkmcnt(9)
v_mfma_f32_16x16x32_bf16 v[20:23], v[152:155], v[208:211], v[20:23]
ds_read_b64_tr_b16 v[186:187], v12 offset:45568
v_mfma_f32_16x16x32_bf16 v[16:19], v[156:159], v[208:211], v[16:19]
ds_read_b128 v[208:211], v7 offset:38400
s_waitcnt lgkmcnt(8)
v_mfma_f32_16x16x32_bf16 v[16:19], v[64:67], v[212:215], v[16:19]
ds_read_b128 v[244:247], v9 offset:20480
v_mfma_f32_16x16x32_bf16 v[20:23], v[156:159], v[212:215], v[20:23]
s_waitcnt lgkmcnt(8)
v_mfma_f32_16x16x32_bf16 v[20:23], v[64:67], v[240:243], v[20:23]
ds_read_b128 v[212:215], v9 offset:23040
v_mfma_f32_16x16x32_bf16 v[16:19], v[164:167], v[240:243], v[16:19]
s_waitcnt lgkmcnt(8)
v_mfma_f32_16x16x32_bf16 v[16:19], v[168:171], v[220:223], v[16:19]
ds_read_b128 v[240:243], v9 offset:25600
v_mfma_f32_16x16x32_bf16 v[20:23], v[164:167], v[220:223], v[20:23]
s_waitcnt lgkmcnt(8)
v_mfma_f32_16x16x32_bf16 v[20:23], v[168:171], v[188:191], v[20:23]
ds_read_b128 v[220:223], v9 offset:28160
v_mfma_f32_16x16x32_bf16 v[16:19], v[80:83], v[188:191], v[16:19]
s_waitcnt lgkmcnt(8)
v_mfma_f32_16x16x32_bf16 v[16:19], v[176:179], v[236:239], v[16:19]
ds_read_b128 v[188:191], v9 offset:30720
v_mfma_f32_16x16x32_bf16 v[20:23], v[80:83], v[236:239], v[20:23]
s_waitcnt lgkmcnt(8)
v_mfma_f32_16x16x32_bf16 v[20:23], v[176:179], v[200:203], v[20:23]
ds_read_b128 v[236:239], v9 offset:33280
v_mfma_f32_16x16x32_bf16 v[16:19], v[104:107], v[200:203], v[16:19]
s_waitcnt lgkmcnt(6)
v_mfma_f32_16x16x32_bf16 v[16:19], v[60:63], v[208:211], v[16:19]
ds_read_b128 v[200:203], v9 offset:35840
v_mfma_f32_16x16x32_bf16 v[20:23], v[104:107], v[208:211], v[20:23]
s_waitcnt lgkmcnt(6)
v_mfma_f32_16x16x32_bf16 v[20:23], v[60:63], v[244:247], v[20:23]
ds_read_b128 v[208:211], v9 offset:38400
v_mfma_f32_16x16x32_bf16 v[16:19], v[124:127], v[244:247], v[16:19]
ds_read_b128 v[244:247], v3 offset:25600
s_waitcnt lgkmcnt(7)
v_mfma_f32_16x16x32_bf16 v[16:19], v[180:183], v[212:215], v[16:19]
ds_read_b128 v[248:251], v3 offset:28160
v_mfma_f32_16x16x32_bf16 v[20:23], v[124:127], v[212:215], v[20:23]
s_waitcnt lgkmcnt(7)
v_mfma_f32_16x16x32_bf16 v[20:23], v[180:183], v[240:243], v[20:23]
ds_read_b128 v[212:215], v3 offset:30720
v_mfma_f32_16x16x32_bf16 v[16:19], v[76:79], v[240:243], v[16:19]
s_waitcnt lgkmcnt(7)
v_mfma_f32_16x16x32_bf16 v[16:19], v[196:199], v[220:223], v[16:19]
ds_read_b128 v[240:243], v3 offset:33280
v_mfma_f32_16x16x32_bf16 v[20:23], v[76:79], v[220:223], v[20:23]
s_waitcnt lgkmcnt(7)
v_mfma_f32_16x16x32_bf16 v[20:23], v[196:199], v[188:191], v[20:23]
ds_read_b128 v[220:223], v3 offset:35840
v_mfma_f32_16x16x32_bf16 v[16:19], v[232:235], v[188:191], v[16:19]
s_waitcnt lgkmcnt(7)
v_mfma_f32_16x16x32_bf16 v[16:19], v[224:227], v[236:239], v[16:19]
ds_read_b128 v[188:191], v3 offset:38400
v_mfma_f32_16x16x32_bf16 v[20:23], v[232:235], v[236:239], v[20:23]
s_waitcnt lgkmcnt(7)
v_mfma_f32_16x16x32_bf16 v[20:23], v[224:227], v[200:203], v[20:23]
ds_read_b128 v[236:239], v5 offset:20480
v_mfma_f32_16x16x32_bf16 v[16:19], v[184:187], v[200:203], v[16:19]
s_waitcnt lgkmcnt(7)
v_mfma_f32_16x16x32_bf16 v[20:23], v[184:187], v[208:211], v[20:23]
ds_read_b128 v[200:203], v5 offset:23040
s_waitcnt lgkmcnt(7)
v_mfma_f32_16x16x32_bf16 v[24:27], v[72:75], v[244:247], v[24:27]
s_waitcnt lgkmcnt(6)
v_mfma_f32_16x16x32_bf16 v[24:27], v[96:99], v[248:251], v[24:27]
ds_read_b128 v[208:211], v5 offset:25600
v_mfma_f32_16x16x32_bf16 v[28:31], v[72:75], v[248:251], v[28:31]
s_waitcnt lgkmcnt(6)
v_mfma_f32_16x16x32_bf16 v[28:31], v[96:99], v[212:215], v[28:31]
ds_read_b128 v[244:247], v5 offset:28160
v_mfma_f32_16x16x32_bf16 v[24:27], v[100:103], v[212:215], v[24:27]
s_add_u32 s40, s44, 0
s_waitcnt lgkmcnt(6)
v_mfma_f32_16x16x32_bf16 v[24:27], v[92:95], v[240:243], v[24:27]
ds_read_b128 v[212:215], v5 offset:30720
v_cvt_pk_bf16_f32 v16, v16, v17
v_mfma_f32_16x16x32_bf16 v[28:31], v[100:103], v[240:243], v[28:31]
v_cvt_pk_bf16_f32 v17, v18, v19
v_cvt_pk_bf16_f32 v18, v20, v21
s_waitcnt lgkmcnt(6)
v_mfma_f32_16x16x32_bf16 v[28:31], v[92:95], v[220:223], v[28:31]
v_cvt_pk_bf16_f32 v19, v22, v23
v_min_u32 v16, 0xfffffffe, v16
v_mfma_f32_16x16x32_bf16 v[24:27], v[120:123], v[220:223], v[24:27]
v_min_u32 v17, 0xfffffffe, v17
v_min_u32 v18, 0xfffffffe, v18
s_waitcnt lgkmcnt(5)
v_mfma_f32_16x16x32_bf16 v[24:27], v[132:135], v[188:191], v[24:27]
v_min_u32 v19, 0xfffffffe, v19
buffer_store_dwordx4 v[16:19], v14, s[28:31], s40 offen sc1
v_mfma_f32_16x16x32_bf16 v[28:31], v[120:123], v[188:191], v[28:31]
ds_read_b128 v[188:191], v5 offset:33280
ds_read_b128 v[220:223], v5 offset:35840
s_waitcnt lgkmcnt(6)
v_mfma_f32_16x16x32_bf16 v[28:31], v[132:135], v[236:239], v[28:31]
ds_read_b128 v[240:243], v5 offset:38400
v_mfma_f32_16x16x32_bf16 v[24:27], v[84:87], v[236:239], v[24:27]
s_waitcnt lgkmcnt(6)
v_mfma_f32_16x16x32_bf16 v[24:27], v[48:51], v[200:203], v[24:27]
ds_read_b128 v[236:239], v7 offset:20480
v_mfma_f32_16x16x32_bf16 v[28:31], v[84:87], v[200:203], v[28:31]
s_waitcnt lgkmcnt(6)
v_mfma_f32_16x16x32_bf16 v[28:31], v[48:51], v[208:211], v[28:31]
ds_read_b128 v[200:203], v7 offset:23040
v_mfma_f32_16x16x32_bf16 v[24:27], v[88:91], v[208:211], v[24:27]
s_waitcnt lgkmcnt(6)
v_mfma_f32_16x16x32_bf16 v[24:27], v[108:111], v[244:247], v[24:27]
ds_read_b128 v[208:211], v7 offset:25600
v_mfma_f32_16x16x32_bf16 v[28:31], v[88:91], v[244:247], v[28:31]
s_waitcnt lgkmcnt(6)
v_mfma_f32_16x16x32_bf16 v[28:31], v[108:111], v[212:215], v[28:31]
ds_read_b128 v[244:247], v7 offset:28160
v_mfma_f32_16x16x32_bf16 v[24:27], v[68:71], v[212:215], v[24:27]
s_waitcnt lgkmcnt(6)
v_mfma_f32_16x16x32_bf16 v[24:27], v[136:139], v[188:191], v[24:27]
ds_read_b128 v[212:215], v7 offset:30720
v_mfma_f32_16x16x32_bf16 v[28:31], v[68:71], v[188:191], v[28:31]
s_waitcnt lgkmcnt(6)
v_mfma_f32_16x16x32_bf16 v[28:31], v[136:139], v[220:223], v[28:31]
ds_read_b128 v[188:191], v7 offset:33280
v_mfma_f32_16x16x32_bf16 v[24:27], v[140:143], v[220:223], v[24:27]
s_waitcnt lgkmcnt(6)
v_mfma_f32_16x16x32_bf16 v[24:27], v[56:59], v[240:243], v[24:27]
ds_read_b128 v[220:223], v7 offset:35840
v_mfma_f32_16x16x32_bf16 v[28:31], v[140:143], v[240:243], v[28:31]
s_waitcnt lgkmcnt(6)
v_mfma_f32_16x16x32_bf16 v[28:31], v[56:59], v[236:239], v[28:31]
ds_read_b128 v[240:243], v7 offset:38400
v_mfma_f32_16x16x32_bf16 v[24:27], v[148:151], v[236:239], v[24:27]
s_waitcnt lgkmcnt(6)
v_mfma_f32_16x16x32_bf16 v[24:27], v[152:155], v[200:203], v[24:27]
ds_read_b128 v[236:239], v9 offset:20480
v_mfma_f32_16x16x32_bf16 v[28:31], v[148:151], v[200:203], v[28:31]
s_waitcnt lgkmcnt(6)
v_mfma_f32_16x16x32_bf16 v[28:31], v[152:155], v[208:211], v[28:31]
ds_read_b128 v[200:203], v9 offset:23040
v_mfma_f32_16x16x32_bf16 v[24:27], v[156:159], v[208:211], v[24:27]
s_waitcnt lgkmcnt(6)
v_mfma_f32_16x16x32_bf16 v[24:27], v[64:67], v[244:247], v[24:27]
ds_read_b128 v[208:211], v9 offset:25600
v_mfma_f32_16x16x32_bf16 v[28:31], v[156:159], v[244:247], v[28:31]
s_waitcnt lgkmcnt(6)
v_mfma_f32_16x16x32_bf16 v[28:31], v[64:67], v[212:215], v[28:31]
ds_read_b128 v[244:247], v9 offset:28160
v_mfma_f32_16x16x32_bf16 v[24:27], v[164:167], v[212:215], v[24:27]
s_waitcnt lgkmcnt(6)
v_mfma_f32_16x16x32_bf16 v[24:27], v[168:171], v[188:191], v[24:27]
ds_read_b128 v[212:215], v9 offset:30720
v_mfma_f32_16x16x32_bf16 v[28:31], v[164:167], v[188:191], v[28:31]
s_waitcnt lgkmcnt(6)
v_mfma_f32_16x16x32_bf16 v[28:31], v[168:171], v[220:223], v[28:31]
ds_read_b128 v[188:191], v9 offset:33280
v_mfma_f32_16x16x32_bf16 v[24:27], v[80:83], v[220:223], v[24:27]
s_barrier
s_waitcnt lgkmcnt(6)
v_mfma_f32_16x16x32_bf16 v[24:27], v[176:179], v[240:243], v[24:27]
ds_read_b128 v[220:223], v9 offset:35840
v_mfma_f32_16x16x32_bf16 v[28:31], v[80:83], v[240:243], v[28:31]
s_waitcnt lgkmcnt(6)
v_mfma_f32_16x16x32_bf16 v[28:31], v[176:179], v[236:239], v[28:31]
ds_read_b128 v[240:243], v9 offset:38400
v_mfma_f32_16x16x32_bf16 v[24:27], v[104:107], v[236:239], v[24:27]
s_waitcnt lgkmcnt(6)
v_mfma_f32_16x16x32_bf16 v[24:27], v[60:63], v[200:203], v[24:27]
ds_read_b128 v[236:239], v11 offset:20480
v_mfma_f32_16x16x32_bf16 v[28:31], v[104:107], v[200:203], v[28:31]
s_waitcnt lgkmcnt(6)
v_mfma_f32_16x16x32_bf16 v[28:31], v[60:63], v[208:211], v[28:31]
ds_read_b128 v[200:203], v11 offset:23040
v_mfma_f32_16x16x32_bf16 v[24:27], v[124:127], v[208:211], v[24:27]
ds_read_b128 v[208:211], v3 offset:35840
s_waitcnt lgkmcnt(7)
v_mfma_f32_16x16x32_bf16 v[24:27], v[180:183], v[244:247], v[24:27]
ds_read_b128 v[248:251], v3 offset:38400
v_mfma_f32_16x16x32_bf16 v[28:31], v[124:127], v[244:247], v[28:31]
s_waitcnt lgkmcnt(7)
v_mfma_f32_16x16x32_bf16 v[28:31], v[180:183], v[212:215], v[28:31]
ds_read_b128 v[244:247], v5 offset:20480
v_mfma_f32_16x16x32_bf16 v[24:27], v[76:79], v[212:215], v[24:27]
s_waitcnt lgkmcnt(7)
v_mfma_f32_16x16x32_bf16 v[24:27], v[196:199], v[188:191], v[24:27]
ds_read_b128 v[212:215], v5 offset:23040
v_mfma_f32_16x16x32_bf16 v[28:31], v[76:79], v[188:191], v[28:31]
s_waitcnt lgkmcnt(7)
v_mfma_f32_16x16x32_bf16 v[28:31], v[196:199], v[220:223], v[28:31]
ds_read_b128 v[188:191], v5 offset:25600
v_mfma_f32_16x16x32_bf16 v[24:27], v[232:235], v[220:223], v[24:27]
s_waitcnt lgkmcnt(7)
v_mfma_f32_16x16x32_bf16 v[24:27], v[224:227], v[240:243], v[24:27]
ds_read_b128 v[220:223], v5 offset:28160
v_mfma_f32_16x16x32_bf16 v[28:31], v[232:235], v[240:243], v[28:31]
s_waitcnt lgkmcnt(7)
v_mfma_f32_16x16x32_bf16 v[28:31], v[224:227], v[236:239], v[28:31]
ds_read_b128 v[240:243], v5 offset:30720
v_mfma_f32_16x16x32_bf16 v[24:27], v[184:187], v[236:239], v[24:27]
s_waitcnt lgkmcnt(7)
v_mfma_f32_16x16x32_bf16 v[28:31], v[184:187], v[200:203], v[28:31]
ds_read_b128 v[200:203], v5 offset:33280
s_waitcnt lgkmcnt(7)
v_mfma_f32_16x16x32_bf16 v[40:43], v[72:75], v[208:211], v[40:43]
s_waitcnt lgkmcnt(6)
v_mfma_f32_16x16x32_bf16 v[40:43], v[96:99], v[248:251], v[40:43]
ds_read_b128 v[208:211], v5 offset:35840
v_mfma_f32_16x16x32_bf16 v[44:47], v[72:75], v[248:251], v[44:47]
s_waitcnt lgkmcnt(6)
v_mfma_f32_16x16x32_bf16 v[44:47], v[96:99], v[244:247], v[44:47]
ds_read_b128 v[236:239], v5 offset:38400
v_mfma_f32_16x16x32_bf16 v[40:43], v[100:103], v[244:247], v[40:43]
s_add_u32 s40, s44, 16384
s_waitcnt lgkmcnt(6)
v_mfma_f32_16x16x32_bf16 v[40:43], v[92:95], v[212:215], v[40:43]
ds_read_b128 v[244:247], v7 offset:20480
v_cvt_pk_bf16_f32 v24, v24, v25
v_mfma_f32_16x16x32_bf16 v[44:47], v[100:103], v[212:215], v[44:47]
v_cvt_pk_bf16_f32 v25, v26, v27
v_cvt_pk_bf16_f32 v26, v28, v29
s_waitcnt lgkmcnt(6)
v_mfma_f32_16x16x32_bf16 v[44:47], v[92:95], v[188:191], v[44:47]
v_cvt_pk_bf16_f32 v27, v30, v31
v_min_u32 v24, 0xfffffffe, v24
v_mfma_f32_16x16x32_bf16 v[40:43], v[120:123], v[188:191], v[40:43]
v_min_u32 v25, 0xfffffffe, v25
v_min_u32 v26, 0xfffffffe, v26
s_waitcnt lgkmcnt(5)
v_mfma_f32_16x16x32_bf16 v[40:43], v[132:135], v[220:223], v[40:43]
v_min_u32 v27, 0xfffffffe, v27
buffer_store_dwordx4 v[24:27], v14, s[28:31], s40 offen sc1
v_mfma_f32_16x16x32_bf16 v[44:47], v[120:123], v[220:223], v[44:47]
ds_read_b128 v[188:191], v7 offset:23040
ds_read_b128 v[212:215], v7 offset:25600
s_waitcnt lgkmcnt(6)
v_mfma_f32_16x16x32_bf16 v[44:47], v[132:135], v[240:243], v[44:47]
ds_read_b128 v[220:223], v7 offset:28160
v_mfma_f32_16x16x32_bf16 v[40:43], v[84:87], v[240:243], v[40:43]
s_waitcnt lgkmcnt(6)
v_mfma_f32_16x16x32_bf16 v[40:43], v[48:51], v[200:203], v[40:43]
ds_read_b128 v[240:243], v7 offset:30720
v_mfma_f32_16x16x32_bf16 v[44:47], v[84:87], v[200:203], v[44:47]
s_waitcnt lgkmcnt(6)
v_mfma_f32_16x16x32_bf16 v[44:47], v[48:51], v[208:211], v[44:47]
ds_read_b128 v[200:203], v7 offset:33280
v_mfma_f32_16x16x32_bf16 v[40:43], v[88:91], v[208:211], v[40:43]
s_waitcnt lgkmcnt(6)
v_mfma_f32_16x16x32_bf16 v[40:43], v[108:111], v[236:239], v[40:43]
ds_read_b128 v[208:211], v7 offset:35840
v_mfma_f32_16x16x32_bf16 v[44:47], v[88:91], v[236:239], v[44:47]
s_waitcnt lgkmcnt(6)
v_mfma_f32_16x16x32_bf16 v[44:47], v[108:111], v[244:247], v[44:47]
ds_read_b128 v[236:239], v7 offset:38400
v_mfma_f32_16x16x32_bf16 v[40:43], v[68:71], v[244:247], v[40:43]
s_waitcnt lgkmcnt(6)
v_mfma_f32_16x16x32_bf16 v[40:43], v[136:139], v[188:191], v[40:43]
ds_read_b128 v[244:247], v9 offset:20480
v_mfma_f32_16x16x32_bf16 v[44:47], v[68:71], v[188:191], v[44:47]
s_waitcnt lgkmcnt(6)
v_mfma_f32_16x16x32_bf16 v[44:47], v[136:139], v[212:215], v[44:47]
ds_read_b128 v[188:191], v9 offset:23040
v_mfma_f32_16x16x32_bf16 v[40:43], v[140:143], v[212:215], v[40:43]
s_waitcnt lgkmcnt(6)
v_mfma_f32_16x16x32_bf16 v[40:43], v[56:59], v[220:223], v[40:43]
ds_read_b128 v[212:215], v9 offset:25600
v_mfma_f32_16x16x32_bf16 v[44:47], v[140:143], v[220:223], v[44:47]
s_waitcnt lgkmcnt(6)
v_mfma_f32_16x16x32_bf16 v[44:47], v[56:59], v[240:243], v[44:47]
ds_read_b128 v[220:223], v9 offset:28160
v_mfma_f32_16x16x32_bf16 v[40:43], v[148:151], v[240:243], v[40:43]
s_waitcnt lgkmcnt(6)
v_mfma_f32_16x16x32_bf16 v[40:43], v[152:155], v[200:203], v[40:43]
ds_read_b128 v[240:243], v9 offset:30720
v_mfma_f32_16x16x32_bf16 v[44:47], v[148:151], v[200:203], v[44:47]
s_waitcnt lgkmcnt(6)
v_mfma_f32_16x16x32_bf16 v[44:47], v[152:155], v[208:211], v[44:47]
ds_read_b128 v[200:203], v9 offset:33280
v_mfma_f32_16x16x32_bf16 v[40:43], v[156:159], v[208:211], v[40:43]
s_waitcnt lgkmcnt(6)
v_mfma_f32_16x16x32_bf16 v[40:43], v[64:67], v[236:239], v[40:43]
ds_read_b128 v[208:211], v9 offset:35840
v_mfma_f32_16x16x32_bf16 v[44:47], v[156:159], v[236:239], v[44:47]
s_waitcnt lgkmcnt(6)
v_mfma_f32_16x16x32_bf16 v[44:47], v[64:67], v[244:247], v[44:47]
ds_read_b128 v[236:239], v9 offset:38400
v_mfma_f32_16x16x32_bf16 v[40:43], v[164:167], v[244:247], v[40:43]
s_barrier
s_waitcnt lgkmcnt(6)
v_mfma_f32_16x16x32_bf16 v[40:43], v[168:171], v[188:191], v[40:43]
ds_read_b128 v[244:247], v11 offset:20480
v_mfma_f32_16x16x32_bf16 v[44:47], v[164:167], v[188:191], v[44:47]
s_waitcnt lgkmcnt(6)
v_mfma_f32_16x16x32_bf16 v[44:47], v[168:171], v[212:215], v[44:47]
ds_read_b128 v[188:191], v11 offset:23040
v_mfma_f32_16x16x32_bf16 v[40:43], v[80:83], v[212:215], v[40:43]
s_waitcnt lgkmcnt(6)
v_mfma_f32_16x16x32_bf16 v[40:43], v[176:179], v[220:223], v[40:43]
ds_read_b128 v[212:215], v11 offset:25600
v_mfma_f32_16x16x32_bf16 v[44:47], v[80:83], v[220:223], v[44:47]
s_waitcnt lgkmcnt(6)
v_mfma_f32_16x16x32_bf16 v[44:47], v[176:179], v[240:243], v[44:47]
ds_read_b128 v[220:223], v11 offset:28160
v_mfma_f32_16x16x32_bf16 v[40:43], v[104:107], v[240:243], v[40:43]
s_waitcnt lgkmcnt(6)
v_mfma_f32_16x16x32_bf16 v[40:43], v[60:63], v[200:203], v[40:43]
ds_read_b128 v[240:243], v11 offset:30720
v_mfma_f32_16x16x32_bf16 v[44:47], v[104:107], v[200:203], v[44:47]
s_waitcnt lgkmcnt(6)
v_mfma_f32_16x16x32_bf16 v[44:47], v[60:63], v[208:211], v[44:47]
ds_read_b128 v[200:203], v11 offset:33280
v_mfma_f32_16x16x32_bf16 v[40:43], v[124:127], v[208:211], v[40:43]
ds_read_b128 v[208:211], v8 offset:20480
s_waitcnt lgkmcnt(7)
v_mfma_f32_16x16x32_bf16 v[40:43], v[180:183], v[236:239], v[40:43]
ds_read_b128 v[248:251], v8 offset:23040
v_mfma_f32_16x16x32_bf16 v[44:47], v[124:127], v[236:239], v[44:47]
s_waitcnt lgkmcnt(7)
v_mfma_f32_16x16x32_bf16 v[44:47], v[180:183], v[244:247], v[44:47]
ds_read_b128 v[236:239], v8 offset:25600
v_mfma_f32_16x16x32_bf16 v[40:43], v[76:79], v[244:247], v[40:43]
s_waitcnt lgkmcnt(7)
v_mfma_f32_16x16x32_bf16 v[40:43], v[196:199], v[188:191], v[40:43]
ds_read_b128 v[244:247], v8 offset:28160
v_mfma_f32_16x16x32_bf16 v[44:47], v[76:79], v[188:191], v[44:47]
s_waitcnt lgkmcnt(7)
v_mfma_f32_16x16x32_bf16 v[44:47], v[196:199], v[212:215], v[44:47]
ds_read_b128 v[188:191], v8 offset:30720
v_mfma_f32_16x16x32_bf16 v[40:43], v[232:235], v[212:215], v[40:43]
s_waitcnt lgkmcnt(7)
v_mfma_f32_16x16x32_bf16 v[40:43], v[224:227], v[220:223], v[40:43]
ds_read_b128 v[212:215], v8 offset:33280
v_mfma_f32_16x16x32_bf16 v[44:47], v[232:235], v[220:223], v[44:47]
s_waitcnt lgkmcnt(7)
v_mfma_f32_16x16x32_bf16 v[44:47], v[224:227], v[240:243], v[44:47]
ds_read_b128 v[220:223], v8 offset:35840
v_mfma_f32_16x16x32_bf16 v[40:43], v[184:187], v[240:243], v[40:43]
s_waitcnt lgkmcnt(7)
v_mfma_f32_16x16x32_bf16 v[44:47], v[184:187], v[200:203], v[44:47]
ds_read_b128 v[200:203], v8 offset:38400
s_waitcnt lgkmcnt(7)
v_mfma_f32_16x16x32_bf16 v[32:35], v[160:163], v[208:211], v[32:35]
s_add_u32 s41, s44, 32768
s_waitcnt lgkmcnt(6)
v_mfma_f32_16x16x32_bf16 v[32:35], v[172:175], v[248:251], v[32:35]
ds_read_b128 v[208:211], v10 offset:20480
v_mfma_f32_16x16x32_bf16 v[36:39], v[160:163], v[248:251], v[36:39]
s_waitcnt lgkmcnt(6)
v_mfma_f32_16x16x32_bf16 v[36:39], v[172:175], v[236:239], v[36:39]
ds_read_b128 v[160:163], v10 offset:23040
v_mfma_f32_16x16x32_bf16 v[32:35], v[144:147], v[236:239], v[32:35]
s_add_u32 s40, s44, 45056
s_waitcnt lgkmcnt(6)
v_mfma_f32_16x16x32_bf16 v[32:35], v[116:119], v[244:247], v[32:35]
ds_read_b128 v[172:175], v10 offset:25600
v_cvt_pk_bf16_f32 v40, v40, v41
v_mfma_f32_16x16x32_bf16 v[36:39], v[144:147], v[244:247], v[36:39]
v_cvt_pk_bf16_f32 v41, v42, v43
v_cvt_pk_bf16_f32 v42, v44, v45
s_waitcnt lgkmcnt(6)
v_mfma_f32_16x16x32_bf16 v[36:39], v[116:119], v[188:191], v[36:39]
v_cvt_pk_bf16_f32 v43, v46, v47
v_min_u32 v40, 0xfffffffe, v40
v_mfma_f32_16x16x32_bf16 v[32:35], v[192:195], v[188:191], v[32:35]
v_min_u32 v41, 0xfffffffe, v41
v_min_u32 v42, 0xfffffffe, v42
s_waitcnt lgkmcnt(5)
v_mfma_f32_16x16x32_bf16 v[32:35], v[112:115], v[212:215], v[32:35]
v_min_u32 v43, 0xfffffffe, v43
buffer_store_dwordx4 v[40:43], v14, s[28:31], s40 offen sc1
v_mfma_f32_16x16x32_bf16 v[36:39], v[192:195], v[212:215], v[36:39]
ds_read_b128 v[116:119], v10 offset:28160
ds_read_b128 v[144:147], v3 offset:30720
s_waitcnt lgkmcnt(6)
v_mfma_f32_16x16x32_bf16 v[36:39], v[112:115], v[220:223], v[36:39]
ds_read_b128 v[112:115], v3 offset:33280
v_mfma_f32_16x16x32_bf16 v[32:35], v[204:207], v[220:223], v[32:35]
ds_read_b128 v[188:191], v3 offset:35840
s_waitcnt lgkmcnt(7)
v_mfma_f32_16x16x32_bf16 v[32:35], v[52:55], v[200:203], v[32:35]
ds_read_b128 v[192:195], v3 offset:38400
v_mfma_f32_16x16x32_bf16 v[36:39], v[204:207], v[200:203], v[36:39]
s_waitcnt lgkmcnt(7)
v_mfma_f32_16x16x32_bf16 v[36:39], v[52:55], v[208:211], v[36:39]
ds_read_b128 v[52:55], v5 offset:20480
v_mfma_f32_16x16x32_bf16 v[32:35], v[216:219], v[208:211], v[32:35]
s_waitcnt lgkmcnt(7)
v_mfma_f32_16x16x32_bf16 v[32:35], v[128:131], v[160:163], v[32:35]
ds_read_b128 v[200:203], v5 offset:23040
v_mfma_f32_16x16x32_bf16 v[36:39], v[216:219], v[160:163], v[36:39]
s_waitcnt lgkmcnt(7)
v_mfma_f32_16x16x32_bf16 v[36:39], v[128:131], v[172:175], v[36:39]
ds_read_b128 v[128:131], v5 offset:25600
v_mfma_f32_16x16x32_bf16 v[32:35], v[228:231], v[172:175], v[32:35]
s_waitcnt lgkmcnt(7)
v_mfma_f32_16x16x32_bf16 v[36:39], v[228:231], v[116:119], v[36:39]
ds_read_b128 v[116:119], v5 offset:28160
s_waitcnt lgkmcnt(7)
v_mfma_f32_16x16x32_bf16 v[32:35], v[72:75], v[144:147], v[32:35]
s_waitcnt lgkmcnt(6)
v_mfma_f32_16x16x32_bf16 v[32:35], v[96:99], v[112:115], v[32:35]
ds_read_b128 v[144:147], v5 offset:30720
v_mfma_f32_16x16x32_bf16 v[36:39], v[72:75], v[112:115], v[36:39]
s_waitcnt lgkmcnt(6)
v_mfma_f32_16x16x32_bf16 v[36:39], v[96:99], v[188:191], v[36:39]
ds_read_b128 v[72:75], v5 offset:33280
v_mfma_f32_16x16x32_bf16 v[32:35], v[100:103], v[188:191], v[32:35]
s_waitcnt lgkmcnt(6)
v_mfma_f32_16x16x32_bf16 v[32:35], v[92:95], v[192:195], v[32:35]
ds_read_b128 v[96:99], v5 offset:35840
v_mfma_f32_16x16x32_bf16 v[36:39], v[100:103], v[192:195], v[36:39]
s_waitcnt lgkmcnt(6)
v_mfma_f32_16x16x32_bf16 v[36:39], v[92:95], v[52:55], v[36:39]
ds_read_b128 v[92:95], v5 offset:38400
v_mfma_f32_16x16x32_bf16 v[32:35], v[120:123], v[52:55], v[32:35]
s_waitcnt lgkmcnt(6)
v_mfma_f32_16x16x32_bf16 v[32:35], v[132:135], v[200:203], v[32:35]
ds_read_b128 v[52:55], v7 offset:20480
v_mfma_f32_16x16x32_bf16 v[36:39], v[120:123], v[200:203], v[36:39]
s_waitcnt lgkmcnt(6)
v_mfma_f32_16x16x32_bf16 v[36:39], v[132:135], v[128:131], v[36:39]
ds_read_b128 v[100:103], v7 offset:23040
v_mfma_f32_16x16x32_bf16 v[32:35], v[84:87], v[128:131], v[32:35]
s_waitcnt lgkmcnt(6)
v_mfma_f32_16x16x32_bf16 v[32:35], v[48:51], v[116:119], v[32:35]
ds_read_b128 v[112:115], v7 offset:25600
v_mfma_f32_16x16x32_bf16 v[36:39], v[84:87], v[116:119], v[36:39]
s_waitcnt lgkmcnt(6)
v_mfma_f32_16x16x32_bf16 v[36:39], v[48:51], v[144:147], v[36:39]
ds_read_b128 v[48:51], v7 offset:28160
v_mfma_f32_16x16x32_bf16 v[32:35], v[88:91], v[144:147], v[32:35]
s_waitcnt lgkmcnt(6)
v_mfma_f32_16x16x32_bf16 v[32:35], v[108:111], v[72:75], v[32:35]
ds_read_b128 v[84:87], v7 offset:30720
v_mfma_f32_16x16x32_bf16 v[36:39], v[88:91], v[72:75], v[36:39]
s_waitcnt lgkmcnt(6)
v_mfma_f32_16x16x32_bf16 v[36:39], v[108:111], v[96:99], v[36:39]
ds_read_b128 v[72:75], v7 offset:33280
v_mfma_f32_16x16x32_bf16 v[32:35], v[68:71], v[96:99], v[32:35]
s_waitcnt lgkmcnt(6)
v_mfma_f32_16x16x32_bf16 v[32:35], v[136:139], v[92:95], v[32:35]
ds_read_b128 v[88:91], v7 offset:35840
v_mfma_f32_16x16x32_bf16 v[36:39], v[68:71], v[92:95], v[36:39]
buffer_load_dwordx4 v[68:71], v14, s[28:31], s41 offen offset:0 sc1
s_waitcnt lgkmcnt(6)
v_mfma_f32_16x16x32_bf16 v[36:39], v[136:139], v[52:55], v[36:39]
ds_read_b128 v[92:95], v7 offset:38400
v_mfma_f32_16x16x32_bf16 v[32:35], v[140:143], v[52:55], v[32:35]
s_waitcnt lgkmcnt(6)
v_mfma_f32_16x16x32_bf16 v[32:35], v[56:59], v[100:103], v[32:35]
ds_read_b128 v[52:55], v9 offset:20480
v_mfma_f32_16x16x32_bf16 v[36:39], v[140:143], v[100:103], v[36:39]
s_waitcnt lgkmcnt(6)
v_mfma_f32_16x16x32_bf16 v[36:39], v[56:59], v[112:115], v[36:39]
ds_read_b128 v[56:59], v9 offset:23040
v_mfma_f32_16x16x32_bf16 v[32:35], v[148:151], v[112:115], v[32:35]
s_waitcnt lgkmcnt(6)
v_mfma_f32_16x16x32_bf16 v[32:35], v[152:155], v[48:51], v[32:35]
ds_read_b128 v[96:99], v9 offset:25600
v_mfma_f32_16x16x32_bf16 v[36:39], v[148:151], v[48:51], v[36:39]
s_waitcnt lgkmcnt(6)
L_pg2_1:
s_cbranch_scc1 L_ret
v_mfma_f32_16x16x32_bf16 v[36:39], v[152:155], v[84:87], v[36:39]
ds_read_b128 v[48:51], v9 offset:28160
v_mfma_f32_16x16x32_bf16 v[32:35], v[156:159], v[84:87], v[32:35]
s_waitcnt lgkmcnt(6)
v_mfma_f32_16x16x32_bf16 v[32:35], v[64:67], v[72:75], v[32:35]
ds_read_b128 v[84:87], v9 offset:30720
v_mfma_f32_16x16x32_bf16 v[36:39], v[156:159], v[72:75], v[36:39]
s_waitcnt lgkmcnt(6)
v_mfma_f32_16x16x32_bf16 v[36:39], v[64:67], v[88:91], v[36:39]
ds_read_b128 v[64:67], v9 offset:33280
v_mfma_f32_16x16x32_bf16 v[32:35], v[164:167], v[88:91], v[32:35]
buffer_load_dwordx4 v[72:75], v14, s[28:31], s41 offen offset:0 sc1
s_waitcnt lgkmcnt(6)
v_mfma_f32_16x16x32_bf16 v[32:35], v[168:171], v[92:95], v[32:35]
ds_read_b128 v[88:91], v9 offset:35840
v_mfma_f32_16x16x32_bf16 v[36:39], v[164:167], v[92:95], v[36:39]
s_waitcnt lgkmcnt(6)
v_mfma_f32_16x16x32_bf16 v[36:39], v[168:171], v[52:55], v[36:39]
ds_read_b128 v[92:95], v9 offset:38400
v_mfma_f32_16x16x32_bf16 v[32:35], v[80:83], v[52:55], v[32:35]
s_waitcnt lgkmcnt(6)
v_mfma_f32_16x16x32_bf16 v[32:35], v[176:179], v[56:59], v[32:35]
ds_read_b128 v[52:55], v11 offset:20480
v_mfma_f32_16x16x32_bf16 v[36:39], v[80:83], v[56:59], v[36:39]
s_waitcnt lgkmcnt(6)
v_mfma_f32_16x16x32_bf16 v[36:39], v[176:179], v[96:99], v[36:39]
ds_read_b128 v[56:59], v11 offset:23040
v_mfma_f32_16x16x32_bf16 v[32:35], v[104:107], v[96:99], v[32:35]
s_waitcnt lgkmcnt(6)
v_mfma_f32_16x16x32_bf16 v[32:35], v[60:63], v[48:51], v[32:35]
ds_read_b128 v[80:83], v11 offset:25600
v_mfma_f32_16x16x32_bf16 v[36:39], v[104:107], v[48:51], v[36:39]
s_waitcnt lgkmcnt(6)
v_mfma_f32_16x16x32_bf16 v[36:39], v[60:63], v[84:87], v[36:39]
ds_read_b128 v[48:51], v11 offset:28160
v_mfma_f32_16x16x32_bf16 v[32:35], v[124:127], v[84:87], v[32:35]
s_waitcnt lgkmcnt(6)
v_mfma_f32_16x16x32_bf16 v[32:35], v[180:183], v[64:67], v[32:35]
v_mfma_f32_16x16x32_bf16 v[36:39], v[124:127], v[64:67], v[36:39]
s_waitcnt lgkmcnt(5)
v_mfma_f32_16x16x32_bf16 v[36:39], v[180:183], v[88:91], v[36:39]
v_mfma_f32_16x16x32_bf16 v[32:35], v[76:79], v[88:91], v[32:35]
s_waitcnt lgkmcnt(4)
v_mfma_f32_16x16x32_bf16 v[32:35], v[196:199], v[92:95], v[32:35]
v_mfma_f32_16x16x32_bf16 v[36:39], v[76:79], v[92:95], v[36:39]
s_waitcnt lgkmcnt(3)
v_mfma_f32_16x16x32_bf16 v[36:39], v[196:199], v[52:55], v[36:39]
v_mfma_f32_16x16x32_bf16 v[32:35], v[232:235], v[52:55], v[32:35]
s_waitcnt lgkmcnt(2)
v_mfma_f32_16x16x32_bf16 v[32:35], v[224:227], v[56:59], v[32:35]
v_mfma_f32_16x16x32_bf16 v[36:39], v[232:235], v[56:59], v[36:39]
s_waitcnt lgkmcnt(1)
v_mfma_f32_16x16x32_bf16 v[36:39], v[224:227], v[80:83], v[36:39]
v_mfma_f32_16x16x32_bf16 v[32:35], v[184:187], v[80:83], v[32:35]
s_waitcnt lgkmcnt(0)
v_mfma_f32_16x16x32_bf16 v[36:39], v[184:187], v[48:51], v[36:39]
L_pl2:
s_waitcnt vmcnt(1)
v_max3_u32 v56, v68, v69, v70
v_max_u32 v56, v56, v71
v_cmp_eq_u32 vcc, -1, v56
s_cbranch_vccz L_got2_0
buffer_load_dwordx4 v[68:71], v14, s[28:31], s41 offen offset:0 sc1
s_waitcnt vmcnt(1)
v_max3_u32 v56, v72, v73, v74
v_max_u32 v56, v56, v75
v_cmp_eq_u32 vcc, -1, v56
s_cbranch_vccz L_got2_1
buffer_load_dwordx4 v[72:75], v14, s[28:31], s41 offen offset:0 sc1
s_branch L_pl2
L_got2_1:
v_lshlrev_b32 v48, 16, v72
v_and_b32 v49, 0xffff0000, v72
v_lshlrev_b32 v50, 16, v73
v_and_b32 v51, 0xffff0000, v73
v_lshlrev_b32 v52, 16, v74
v_and_b32 v53, 0xffff0000, v74
v_lshlrev_b32 v54, 16, v75
v_and_b32 v55, 0xffff0000, v75
s_branch L_ok2
L_got2_0:
v_lshlrev_b32 v48, 16, v68
v_and_b32 v49, 0xffff0000, v68
v_lshlrev_b32 v50, 16, v69
v_and_b32 v51, 0xffff0000, v69
v_lshlrev_b32 v52, 16, v70
v_and_b32 v53, 0xffff0000, v70
v_lshlrev_b32 v54, 16, v71
v_and_b32 v55, 0xffff0000, v71
L_ok2:
v_add_f32 v48, v32, v48
v_add_f32 v49, v33, v49
v_add_f32 v50, v34, v50
v_add_f32 v51, v35, v51
v_add_f32 v52, v36, v52
v_add_f32 v53, v37, v53
v_add_f32 v54, v38, v54
v_add_f32 v55, v39, v55
v_mul_f32 v48, s46, v48
v_mul_f32 v49, s46, v49
v_mul_f32 v50, s46, v50
v_mul_f32 v51, s46, v51
v_mul_f32 v52, s46, v52
v_mul_f32 v53, s46, v53
v_mul_f32 v54, s46, v54
v_mul_f32 v55, s46, v55
s_barrier
ds_read_b128 v[60:63], v1 offset:0
ds_read_b128 v[64:67], v1 offset:1024
v_exp_f32 v48, v48
v_exp_f32 v49, v49
v_exp_f32 v50, v50
v_exp_f32 v51, v51
v_exp_f32 v52, v52
v_exp_f32 v53, v53
v_exp_f32 v54, v54
v_exp_f32 v55, v55
v_add_f32 v48, 1.0, v48
v_add_f32 v49, 1.0, v49
v_add_f32 v50, 1.0, v50
v_add_f32 v51, 1.0, v51
v_add_f32 v52, 1.0, v52
v_add_f32 v53, 1.0, v53
v_add_f32 v54, 1.0, v54
v_add_f32 v55, 1.0, v55
v_rcp_f32 v48, v48
v_rcp_f32 v49, v49
v_rcp_f32 v50, v50
v_rcp_f32 v51, v51
v_rcp_f32 v52, v52
v_rcp_f32 v53, v53
v_rcp_f32 v54, v54
v_rcp_f32 v55, v55
s_waitcnt lgkmcnt(0)
v_mul_f32 v48, v48, v60
v_mul_f32 v49, v49, v61
v_mul_f32 v50, v50, v62
v_mul_f32 v51, v51, v63
v_cvt_pk_bf16_f32 v32, v48, v49
v_cvt_pk_bf16_f32 v33, v50, v51
buffer_store_dwordx2 v[32:33], v15, s[24:27], 0 offen offset:0
v_mul_f32 v52, v52, v64
v_mul_f32 v53, v53, v65
v_mul_f32 v54, v54, v66
v_mul_f32 v55, v55, v67
v_cvt_pk_bf16_f32 v34, v52, v53
v_cvt_pk_bf16_f32 v35, v54, v55
buffer_store_dwordx2 v[34:35], v15, s[24:27], 0 offen offset:1024
s_endpgm
.p2align 6
L_warm3:
s_setpc_b64 s[50:51]
L_fin3:
s_cmp_eq_u32 0, 1
v_mfma_f32_16x16x32_bf16 v[40:43], v[76:79], v[52:55], v[40:43]
ds_read_b64_tr_b16 v[178:179], v13 offset:20992
s_waitcnt lgkmcnt(9)
v_mfma_f32_16x16x32_bf16 v[40:43], v[144:147], v[124:127], v[40:43]
ds_read_b128 v[180:183], v8 offset:28160
v_mfma_f32_16x16x32_bf16 v[44:47], v[76:79], v[124:127], v[44:47]
ds_read_b64_tr_b16 v[76:77], v13 offset:24576
s_waitcnt lgkmcnt(8)
v_mfma_f32_16x16x32_bf16 v[44:47], v[144:147], v[128:131], v[44:47]
ds_read_b64_tr_b16 v[78:79], v13 offset:25088
s_waitcnt lgkmcnt(7)
v_mfma_f32_16x16x32_bf16 v[16:19], v[160:163], v[116:119], v[16:19]
ds_read_b64_tr_b16 v[116:117], v13 offset:28672
s_waitcnt lgkmcnt(6)
v_mfma_f32_16x16x32_bf16 v[16:19], v[172:175], v[104:107], v[16:19]
ds_read_b64_tr_b16 v[118:119], v13 offset:29184
v_mfma_f32_16x16x32_bf16 v[20:23], v[160:163], v[104:107], v[20:23]
v_mfma_f32_16x16x32_bf16 v[20:23], v[172:175], v[112:115], v[20:23]
v_mfma_f32_16x16x32_bf16 v[24:27], v[160:163], v[112:115], v[24:27]
v_mfma_f32_16x16x32_bf16 v[24:27], v[172:175], v[60:63], v[24:27]
v_mfma_f32_16x16x32_bf16 v[28:31], v[160:163], v[60:63], v[28:31]
s_waitcnt lgkmcnt(5)
s_barrier
ds_read_b64_tr_b16 v[104:105], v13 offset:32768
v_mfma_f32_16x16x32_bf16 v[28:31], v[172:175], v[52:55], v[28:31]
ds_read_b64_tr_b16 v[106:107], v13 offset:33280
v_mfma_f32_16x16x32_bf16 v[32:35], v[160:163], v[52:55], v[32:35]
v_mfma_f32_16x16x32_bf16 v[32:35], v[172:175], v[124:127], v[32:35]
ds_read_b128 v[144:147], v8 offset:30720
v_mfma_f32_16x16x32_bf16 v[36:39], v[160:163], v[124:127], v[36:39]
ds_read_b64_tr_b16 v[184:185], v13 offset:36864
v_mfma_f32_16x16x32_bf16 v[36:39], v[172:175], v[128:131], v[36:39]
ds_read_b64_tr_b16 v[186:187], v13 offset:37376
s_waitcnt lgkmcnt(7)
v_mfma_f32_16x16x32_bf16 v[16:19], v[76:79], v[112:115], v[16:19]
ds_read_b64_tr_b16 v[112:113], v13 offset:40960
s_waitcnt lgkmcnt(6)
v_mfma_f32_16x16x32_bf16 v[16:19], v[116:119], v[60:63], v[16:19]
ds_read_b64_tr_b16 v[114:115], v13 offset:41472
v_mfma_f32_16x16x32_bf16 v[20:23], v[76:79], v[60:63], v[20:23]
v_mfma_f32_16x16x32_bf16 v[20:23], v[116:119], v[52:55], v[20:23]
v_mfma_f32_16x16x32_bf16 v[24:27], v[76:79], v[52:55], v[24:27]
v_mfma_f32_16x16x32_bf16 v[24:27], v[116:119], v[124:127], v[24:27]
ds_read_b64_tr_b16 v[60:61], v13 offset:45056
v_mfma_f32_16x16x32_bf16 v[28:31], v[76:79], v[124:127], v[28:31]
ds_read_b64_tr_b16 v[62:63], v13 offset:45568
v_mfma_f32_16x16x32_bf16 v[28:31], v[116:119], v[128:131], v[28:31]
ds_read_b128 v[188:191], v8 offset:33280
v_mfma_f32_16x16x32_bf16 v[32:35], v[76:79], v[128:131], v[32:35]
v_mfma_f32_16x16x32_bf16 v[32:35], v[116:119], v[180:183], v[32:35]
ds_read_b128 v[192:195], v8 offset:35840
v_mfma_f32_16x16x32_bf16 v[36:39], v[76:79], v[180:183], v[36:39]
ds_read_b64_tr_b16 v[196:197], v12 offset:0
s_waitcnt lgkmcnt(9)
v_mfma_f32_16x16x32_bf16 v[36:39], v[116:119], v[144:147], v[36:39]
ds_read_b64_tr_b16 v[198:199], v12 offset:512
s_waitcnt lgkmcnt(8)
v_mfma_f32_16x16x32_bf16 v[16:19], v[184:187], v[52:55], v[16:19]
ds_read_b64_tr_b16 v[52:53], v12 offset:4096
s_waitcnt lgkmcnt(7)
v_mfma_f32_16x16x32_bf16 v[16:19], v[112:115], v[124:127], v[16:19]
ds_read_b64_tr_b16 v[54:55], v12 offset:4608
v_mfma_f32_16x16x32_bf16 v[20:23], v[184:187], v[124:127], v[20:23]
v_mfma_f32_16x16x32_bf16 v[20:23], v[112:115], v[128:131], v[20:23]
v_mfma_f32_16x16x32_bf16 v[24:27], v[184:187], v[128:131], v[24:27]
ds_read_b64_tr_b16 v[124:125], v12 offset:8192
v_mfma_f32_16x16x32_bf16 v[24:27], v[112:115], v[180:183], v[24:27]
ds_read_b64_tr_b16 v[126:127], v12 offset:8704
v_mfma_f32_16x16x32_bf16 v[28:31], v[184:187], v[180:183], v[28:31]
v_mfma_f32_16x16x32_bf16 v[28:31], v[112:115], v[144:147], v[28:31]
ds_read_b128 v[200:203], v8 offset:38400
v_mfma_f32_16x16x32_bf16 v[32:35], v[184:187], v[144:147], v[32:35]
s_waitcnt lgkmcnt(8)
v_mfma_f32_16x16x32_bf16 v[32:35], v[112:115], v[188:191], v[32:35]
ds_read_b128 v[204:207], v10 offset:20480
v_mfma_f32_16x16x32_bf16 v[36:39], v[184:187], v[188:191], v[36:39]
ds_read_b64_tr_b16 v[208:209], v12 offset:12288
s_waitcnt lgkmcnt(9)
v_mfma_f32_16x16x32_bf16 v[36:39], v[112:115], v[192:195], v[36:39]
ds_read_b64_tr_b16 v[210:211], v12 offset:12800
s_waitcnt lgkmcnt(8)
v_mfma_f32_16x16x32_bf16 v[16:19], v[196:199], v[128:131], v[16:19]
ds_read_b64_tr_b16 v[128:129], v12 offset:16384
s_waitcnt lgkmcnt(7)
v_mfma_f32_16x16x32_bf16 v[16:19], v[52:55], v[180:183], v[16:19]
ds_read_b64_tr_b16 v[130:131], v12 offset:16896
v_mfma_f32_16x16x32_bf16 v[20:23], v[196:199], v[180:183], v[20:23]
v_mfma_f32_16x16x32_bf16 v[20:23], v[52:55], v[144:147], v[20:23]
v_mfma_f32_16x16x32_bf16 v[24:27], v[196:199], v[144:147], v[24:27]
s_waitcnt lgkmcnt(6)
s_barrier
ds_read_b64_tr_b16 v[180:181], v12 offset:20480
v_mfma_f32_16x16x32_bf16 v[24:27], v[52:55], v[188:191], v[24:27]
ds_read_b64_tr_b16 v[182:183], v12 offset:20992
v_mfma_f32_16x16x32_bf16 v[28:31], v[196:199], v[188:191], v[28:31]
v_mfma_f32_16x16x32_bf16 v[28:31], v[52:55], v[192:195], v[28:31]
ds_read_b128 v[212:215], v10 offset:23040
v_mfma_f32_16x16x32_bf16 v[32:35], v[196:199], v[192:195], v[32:35]
s_waitcnt lgkmcnt(8)
v_mfma_f32_16x16x32_bf16 v[32:35], v[52:55], v[200:203], v[32:35]
ds_read_b128 v[216:219], v10 offset:25600
v_mfma_f32_16x16x32_bf16 v[36:39], v[196:199], v[200:203], v[36:39]
ds_read_b64_tr_b16 v[220:221], v12 offset:24576
s_waitcnt lgkmcnt(9)
v_mfma_f32_16x16x32_bf16 v[36:39], v[52:55], v[204:207], v[36:39]
ds_read_b64_tr_b16 v[222:223], v12 offset:25088
s_waitcnt lgkmcnt(8)
v_mfma_f32_16x16x32_bf16 v[16:19], v[208:211], v[144:147], v[16:19]
s_waitcnt lgkmcnt(6)
v_mfma_f32_16x16x32_bf16 v[16:19], v[128:131], v[188:191], v[16:19]
v_mfma_f32_16x16x32_bf16 v[20:23], v[208:211], v[188:191], v[20:23]
v_mfma_f32_16x16x32_bf16 v[20:23], v[128:131], v[192:195], v[20:23]
ds_read_b64_tr_b16 v[144:145], v12 offset:28672
v_mfma_f32_16x16x32_bf16 v[24:27], v[208:211], v[192:195], v[24:27]
ds_read_b64_tr_b16 v[146:147], v12 offset:29184
v_mfma_f32_16x16x32_bf16 v[24:27], v[128:131], v[200:203], v[24:27]
ds_read_b128 v[188:191], v10 offset:28160
v_mfma_f32_16x16x32_bf16 v[28:31], v[208:211], v[200:203], v[28:31]
ds_read_b128 v[224:227], v3 offset:25600
v_mfma_f32_16x16x32_bf16 v[28:31], v[128:131], v[204:207], v[28:31]
ds_read_b128 v[228:231], v3 offset:28160
v_mfma_f32_16x16x32_bf16 v[32:35], v[208:211], v[204:207], v[32:35]
ds_read_b128 v[232:235], v3 offset:30720
s_waitcnt lgkmcnt(9)
v_mfma_f32_16x16x32_bf16 v[32:35], v[128:131], v[212:215], v[32:35]
ds_read_b128 v[236:239], v3 offset:33280
v_mfma_f32_16x16x32_bf16 v[36:39], v[208:211], v[212:215], v[36:39]
s_waitcnt lgkmcnt(9)
v_mfma_f32_16x16x32_bf16 v[36:39], v[128:131], v[216:219], v[36:39]
ds_read_b128 v[240:243], v3 offset:35840
s_waitcnt lgkmcnt(8)
v_mfma_f32_16x16x32_bf16 v[16:19], v[220:223], v[192:195], v[16:19]
v_mfma_f32_16x16x32_bf16 v[20:23], v[220:223], v[200:203], v[20:23]
ds_read_b128 v[192:195], v3 offset:38400
v_mfma_f32_16x16x32_bf16 v[24:27], v[220:223], v[204:207], v[24:27]
ds_read_b64_tr_b16 v[200:201], v12 offset:32768
v_mfma_f32_16x16x32_bf16 v[28:31], v[220:223], v[212:215], v[28:31]
ds_read_b64_tr_b16 v[202:203], v12 offset:33280
v_mfma_f32_16x16x32_bf16 v[32:35], v[220:223], v[216:219], v[32:35]
ds_read_b128 v[204:207], v5 offset:20480
s_waitcnt lgkmcnt(9)
v_mfma_f32_16x16x32_bf16 v[36:39], v[220:223], v[188:191], v[36:39]
ds_read_b128 v[188:191], v5 offset:23040
s_waitcnt lgkmcnt(9)
v_mfma_f32_16x16x32_bf16 v[24:27], v[72:75], v[224:227], v[24:27]
s_waitcnt lgkmcnt(8)
v_mfma_f32_16x16x32_bf16 v[24:27], v[96:99], v[228:231], v[24:27]
ds_read_b128 v[212:215], v5 offset:25600
v_mfma_f32_16x16x32_bf16 v[28:31], v[72:75], v[228:231], v[28:31]
s_waitcnt lgkmcnt(8)
v_mfma_f32_16x16x32_bf16 v[28:31], v[96:99], v[232:235], v[28:31]
ds_read_b128 v[216:219], v5 offset:28160
v_mfma_f32_16x16x32_bf16 v[24:27], v[100:103], v[232:235], v[24:27]
s_waitcnt lgkmcnt(8)
v_mfma_f32_16x16x32_bf16 v[24:27], v[92:95], v[236:239], v[24:27]
ds_read_b128 v[224:227], v5 offset:30720
v_mfma_f32_16x16x32_bf16 v[28:31], v[100:103], v[236:239], v[28:31]
s_waitcnt lgkmcnt(8)
v_mfma_f32_16x16x32_bf16 v[28:31], v[92:95], v[240:243], v[28:31]
s_waitcnt lgkmcnt(5)
s_barrier
ds_read_b64_tr_b16 v[228:229], v12 offset:36864
v_mfma_f32_16x16x32_bf16 v[24:27], v[120:123], v[240:243], v[24:27]
ds_read_b64_tr_b16 v[230:231], v12 offset:37376
v_mfma_f32_16x16x32_bf16 v[24:27], v[132:135], v[192:195], v[24:27]
ds_read_b128 v[232:235], v5 offset:33280
v_mfma_f32_16x16x32_bf16 v[28:31], v[120:123], v[192:195], v[28:31]
ds_read_b128 v[192:195], v5 offset:35840
s_waitcnt lgkmcnt(8)
v_mfma_f32_16x16x32_bf16 v[28:31], v[132:135], v[204:207], v[28:31]
ds_read_b128 v[236:239], v5 offset:38400
v_mfma_f32_16x16x32_bf16 v[24:27], v[84:87], v[204:207], v[24:27]
s_waitcnt lgkmcnt(8)
v_mfma_f32_16x16x32_bf16 v[24:27], v[48:51], v[188:191], v[24:27]
ds_read_b128 v[204:207], v7 offset:20480
v_mfma_f32_16x16x32_bf16 v[28:31], v[84:87], v[188:191], v[28:31]
s_waitcnt lgkmcnt(8)
v_mfma_f32_16x16x32_bf16 v[28:31], v[48:51], v[212:215], v[28:31]
ds_read_b128 v[188:191], v7 offset:23040
v_mfma_f32_16x16x32_bf16 v[24:27], v[88:91], v[212:215], v[24:27]
s_waitcnt lgkmcnt(8)
v_mfma_f32_16x16x32_bf16 v[24:27], v[108:111], v[216:219], v[24:27]
ds_read_b128 v[212:215], v7 offset:25600
v_mfma_f32_16x16x32_bf16 v[28:31], v[88:91], v[216:219], v[28:31]
ds_read_b64_tr_b16 v[216:217], v12 offset:40960
s_waitcnt lgkmcnt(9)
v_mfma_f32_16x16x32_bf16 v[28:31], v[108:111], v[224:227], v[28:31]
ds_read_b64_tr_b16 v[218:219], v12 offset:41472
v_mfma_f32_16x16x32_bf16 v[24:27], v[68:71], v[224:227], v[24:27]
ds_read_b128 v[224:227], v7 offset:28160
s_waitcnt lgkmcnt(8)
v_mfma_f32_16x16x32_bf16 v[24:27], v[136:139], v[232:235], v[24:27]
ds_read_b128 v[240:243], v7 offset:30720
v_mfma_f32_16x16x32_bf16 v[28:31], v[68:71], v[232:235], v[28:31]
s_waitcnt lgkmcnt(8)
v_mfma_f32_16x16x32_bf16 v[28:31], v[136:139], v[192:195], v[28:31]
ds_read_b128 v[232:235], v7 offset:33280
v_mfma_f32_16x16x32_bf16 v[24:27], v[140:143], v[192:195], v[24:27]
s_waitcnt lgkmcnt(8)
v_mfma_f32_16x16x32_bf16 v[24:27], v[56:59], v[236:239], v[24:27]
ds_read_b128 v[192:195], v7 offset:35840
v_mfma_f32_16x16x32_bf16 v[28:31], v[140:143], v[236:239], v[28:31]
s_waitcnt lgkmcnt(8)
v_mfma_f32_16x16x32_bf16 v[28:31], v[56:59], v[204:207], v[28:31]
ds_read_b128 v[236:239], v7 offset:38400
v_mfma_f32_16x16x32_bf16 v[24:27], v[148:151], v[204:207], v[24:27]
s_waitcnt lgkmcnt(8)
v_mfma_f32_16x16x32_bf16 v[24:27], v[152:155], v[188:191], v[24:27]
ds_read_b128 v[204:207], v9 offset:20480
v_mfma_f32_16x16x32_bf16 v[28:31], v[148:151], v[188:191], v[28:31]
ds_read_b64_tr_b16 v[188:189], v12 offset:45056
s_waitcnt lgkmcnt(9)
v_mfma_f32_16x16x32_bf16 v[28:31], v[152:155], v[212:215], v[28:31]
ds_read_b64_tr_b16 v[190:191], v12 offset:45568
v_mfma_f32_16x16x32_bf16 v[24:27], v[156:159], v[212:215], v[24:27]
ds_read_b128 v[212:215], v9 offset:23040
s_waitcnt lgkmcnt(8)
v_mfma_f32_16x16x32_bf16 v[24:27], v[64:67], v[224:227], v[24:27]
ds_read_b128 v[244:247], v9 offset:25600
v_mfma_f32_16x16x32_bf16 v[28:31], v[156:159], v[224:227], v[28:31]
s_waitcnt lgkmcnt(8)
v_mfma_f32_16x16x32_bf16 v[28:31], v[64:67], v[240:243], v[28:31]
ds_read_b128 v[224:227], v9 offset:28160
v_mfma_f32_16x16x32_bf16 v[24:27], v[164:167], v[240:243], v[24:27]
s_waitcnt lgkmcnt(8)
v_mfma_f32_16x16x32_bf16 v[24:27], v[168:171], v[232:235], v[24:27]
ds_read_b128 v[240:243], v9 offset:30720
v_mfma_f32_16x16x32_bf16 v[28:31], v[164:167], v[232:235], v[28:31]
s_waitcnt lgkmcnt(8)
v_mfma_f32_16x16x32_bf16 v[28:31], v[168:171], v[192:195], v[28:31]
ds_read_b128 v[232:235], v9 offset:33280
v_mfma_f32_16x16x32_bf16 v[24:27], v[80:83], v[192:195], v[24:27]
s_waitcnt lgkmcnt(8)
v_mfma_f32_16x16x32_bf16 v[24:27], v[176:179], v[236:239], v[24:27]
ds_read_b128 v[192:195], v9 offset:35840
v_mfma_f32_16x16x32_bf16 v[28:31], v[80:83], v[236:239], v[28:31]
s_waitcnt lgkmcnt(8)
v_mfma_f32_16x16x32_bf16 v[28:31], v[176:179], v[204:207], v[28:31]
ds_read_b128 v[236:239], v9 offset:38400
v_mfma_f32_16x16x32_bf16 v[24:27], v[104:107], v[204:207], v[24:27]
s_waitcnt lgkmcnt(6)
v_mfma_f32_16x16x32_bf16 v[24:27], v[60:63], v[212:215], v[24:27]
ds_read_b128 v[204:207], v11 offset:20480
v_mfma_f32_16x16x32_bf16 v[28:31], v[104:107], v[212:215], v[28:31]
s_waitcnt lgkmcnt(6)
v_mfma_f32_16x16x32_bf16 v[28:31], v[60:63], v[244:247], v[28:31]
ds_read_b128 v[212:215], v11 offset:23040
v_mfma_f32_16x16x32_bf16 v[24:27], v[124:127], v[244:247], v[24:27]
ds_read_b128 v[244:247], v3 offset:20480
s_waitcnt lgkmcnt(7)
v_mfma_f32_16x16x32_bf16 v[24:27], v[180:183], v[224:227], v[24:27]
ds_read_b128 v[248:251], v3 offset:23040
v_mfma_f32_16x16x32_bf16 v[28:31], v[124:127], v[224:227], v[28:31]
s_waitcnt lgkmcnt(7)
v_mfma_f32_16x16x32_bf16 v[28:31], v[180:183], v[240:243], v[28:31]
ds_read_b128 v[224:227], v3 offset:25600
v_mfma_f32_16x16x32_bf16 v[24:27], v[144:147], v[240:243], v[24:27]
s_waitcnt lgkmcnt(7)
v_mfma_f32_16x16x32_bf16 v[24:27], v[200:203], v[232:235], v[24:27]
ds_read_b128 v[240:243], v3 offset:28160
v_mfma_f32_16x16x32_bf16 v[28:31], v[144:147], v[232:235], v[28:31]
s_waitcnt lgkmcnt(7)
v_mfma_f32_16x16x32_bf16 v[28:31], v[200:203], v[192:195], v[28:31]
ds_read_b128 v[232:235], v3 offset:30720
v_mfma_f32_16x16x32_bf16 v[24:27], v[228:231], v[192:195], v[24:27]
s_waitcnt lgkmcnt(7)
v_mfma_f32_16x16x32_bf16 v[24:27], v[216:219], v[236:239], v[24:27]
ds_read_b128 v[192:195], v3 offset:33280
v_mfma_f32_16x16x32_bf16 v[28:31], v[228:231], v[236:239], v[28:31]
s_waitcnt lgkmcnt(7)
v_mfma_f32_16x16x32_bf16 v[28:31], v[216:219], v[204:207], v[28:31]
ds_read_b128 v[236:239], v3 offset:35840
v_mfma_f32_16x16x32_bf16 v[24:27], v[188:191], v[204:207], v[24:27]
s_waitcnt lgkmcnt(7)
v_mfma_f32_16x16x32_bf16 v[28:31], v[188:191], v[212:215], v[28:31]
ds_read_b128 v[204:207], v3 offset:38400
s_waitcnt lgkmcnt(7)
v_mfma_f32_16x16x32_bf16 v[16:19], v[72:75], v[244:247], v[16:19]
s_waitcnt lgkmcnt(6)
v_mfma_f32_16x16x32_bf16 v[16:19], v[96:99], v[248:251], v[16:19]
ds_read_b128 v[212:215], v5 offset:20480
v_mfma_f32_16x16x32_bf16 v[20:23], v[72:75], v[248:251], v[20:23]
s_waitcnt lgkmcnt(6)
v_mfma_f32_16x16x32_bf16 v[20:23], v[96:99], v[224:227], v[20:23]
ds_read_b128 v[244:247], v5 offset:23040
v_mfma_f32_16x16x32_bf16 v[16:19], v[100:103], v[224:227], v[16:19]
s_add_u32 s40, s44, 12288
s_waitcnt lgkmcnt(6)
v_mfma_f32_16x16x32_bf16 v[16:19], v[92:95], v[240:243], v[16:19]
ds_read_b128 v[224:227], v5 offset:25600
v_cvt_pk_bf16_f32 v24, v24, v25
v_mfma_f32_16x16x32_bf16 v[20:23], v[100:103], v[240:243], v[20:23]
v_cvt_pk_bf16_f32 v25, v26, v27
v_cvt_pk_bf16_f32 v26, v28, v29
s_waitcnt lgkmcnt(6)
v_mfma_f32_16x16x32_bf16 v[20:23], v[92:95], v[232:235], v[20:23]
v_cvt_pk_bf16_f32 v27, v30, v31
v_min_u32 v24, 0xfffffffe, v24
v_mfma_f32_16x16x32_bf16 v[16:19], v[120:123], v[232:235], v[16:19]
v_min_u32 v25, 0xfffffffe, v25
v_min_u32 v26, 0xfffffffe, v26
s_waitcnt lgkmcnt(5)
v_mfma_f32_16x16x32_bf16 v[16:19], v[132:135], v[192:195], v[16:19]
v_min_u32 v27, 0xfffffffe, v27
buffer_store_dwordx4 v[24:27], v14, s[28:31], s40 offen sc1
v_mfma_f32_16x16x32_bf16 v[20:23], v[120:123], v[192:195], v[20:23]
ds_read_b128 v[192:195], v5 offset:28160
ds_read_b128 v[232:235], v5 offset:30720
s_waitcnt lgkmcnt(6)
v_mfma_f32_16x16x32_bf16 v[20:23], v[132:135], v[236:239], v[20:23]
ds_read_b128 v[240:243], v5 offset:33280
v_mfma_f32_16x16x32_bf16 v[16:19], v[84:87], v[236:239], v[16:19]
s_waitcnt lgkmcnt(6)
v_mfma_f32_16x16x32_bf16 v[16:19], v[48:51], v[204:207], v[16:19]
ds_read_b128 v[236:239], v5 offset:35840
v_mfma_f32_16x16x32_bf16 v[20:23], v[84:87], v[204:207], v[20:23]
s_waitcnt lgkmcnt(6)
v_mfma_f32_16x16x32_bf16 v[20:23], v[48:51], v[212:215], v[20:23]
ds_read_b128 v[204:207], v5 offset:38400
v_mfma_f32_16x16x32_bf16 v[16:19], v[88:91], v[212:215], v[16:19]
s_waitcnt lgkmcnt(6)
v_mfma_f32_16x16x32_bf16 v[16:19], v[108:111], v[244:247], v[16:19]
ds_read_b128 v[212:215], v7 offset:20480
v_mfma_f32_16x16x32_bf16 v[20:23], v[88:91], v[244:247], v[20:23]
s_waitcnt lgkmcnt(6)
v_mfma_f32_16x16x32_bf16 v[20:23], v[108:111], v[224:227], v[20:23]
ds_read_b128 v[244:247], v7 offset:23040
v_mfma_f32_16x16x32_bf16 v[16:19], v[68:71], v[224:227], v[16:19]
s_waitcnt lgkmcnt(6)
v_mfma_f32_16x16x32_bf16 v[16:19], v[136:139], v[192:195], v[16:19]
ds_read_b128 v[224:227], v7 offset:25600
v_mfma_f32_16x16x32_bf16 v[20:23], v[68:71], v[192:195], v[20:23]
s_waitcnt lgkmcnt(6)
v_mfma_f32_16x16x32_bf16 v[20:23], v[136:139], v[232:235], v[20:23]
ds_read_b128 v[192:195], v7 offset:28160
v_mfma_f32_16x16x32_bf16 v[16:19], v[140:143], v[232:235], v[16:19]
s_waitcnt lgkmcnt(6)
v_mfma_f32_16x16x32_bf16 v[16:19], v[56:59], v[240:243], v[16:19]
ds_read_b128 v[232:235], v7 offset:30720
v_mfma_f32_16x16x32_bf16 v[20:23], v[140:143], v[240:243], v[20:23]
s_waitcnt lgkmcnt(6)
v_mfma_f32_16x16x32_bf16 v[20:23], v[56:59], v[236:239], v[20:23]
ds_read_b128 v[240:243], v7 offset:33280
v_mfma_f32_16x16x32_bf16 v[16:19], v[148:151], v[236:239], v[16:19]
s_waitcnt lgkmcnt(6)
v_mfma_f32_16x16x32_bf16 v[16:19], v[152:155], v[204:207], v[16:19]
ds_read_b128 v[236:239], v7 offset:35840
v_mfma_f32_16x16x32_bf16 v[20:23], v[148:151], v[204:207], v[20:23]
s_waitcnt lgkmcnt(6)
v_mfma_f32_16x16x32_bf16 v[20:23], v[152:155], v[212:215], v[20:23]
ds_read_b128 v[204:207], v7 offset:38400
v_mfma_f32_16x16x32_bf16 v[16:19], v[156:159], v[212:215], v[16:19]
s_waitcnt lgkmcnt(6)
v_mfma_f32_16x16x32_bf16 v[16:19], v[64:67], v[244:247], v[16:19]
ds_read_b128 v[212:215], v9 offset:20480
v_mfma_f32_16x16x32_bf16 v[20:23], v[156:159], v[244:247], v[20:23]
s_waitcnt lgkmcnt(6)
v_mfma_f32_16x16x32_bf16 v[20:23], v[64:67], v[224:227], v[20:23]
ds_read_b128 v[244:247], v9 offset:23040
v_mfma_f32_16x16x32_bf16 v[16:19], v[164:167], v[224:227], v[16:19]
s_waitcnt lgkmcnt(6)
v_mfma_f32_16x16x32_bf16 v[16:19], v[168:171], v[192:195], v[16:19]
ds_read_b128 v[224:227], v9 offset:25600
v_mfma_f32_16x16x32_bf16 v[20:23], v[164:167], v[192:195], v[20:23]
s_waitcnt lgkmcnt(6)
v_mfma_f32_16x16x32_bf16 v[20:23], v[168:171], v[232:235], v[20:23]
ds_read_b128 v[192:195], v9 offset:28160
v_mfma_f32_16x16x32_bf16 v[16:19], v[80:83], v[232:235], v[16:19]
s_barrier
s_waitcnt lgkmcnt(6)
v_mfma_f32_16x16x32_bf16 v[16:19], v[176:179], v[240:243], v[16:19]
ds_read_b128 v[232:235], v9 offset:30720
v_mfma_f32_16x16x32_bf16 v[20:23], v[80:83], v[240:243], v[20:23]
s_waitcnt lgkmcnt(6)
v_mfma_f32_16x16x32_bf16 v[20:23], v[176:179], v[236:239], v[20:23]
ds_read_b128 v[240:243], v9 offset:33280
v_mfma_f32_16x16x32_bf16 v[16:19], v[104:107], v[236:239], v[16:19]
s_waitcnt lgkmcnt(6)
v_mfma_f32_16x16x32_bf16 v[16:19], v[60:63], v[204:207], v[16:19]
ds_read_b128 v[236:239], v9 offset:35840
v_mfma_f32_16x16x32_bf16 v[20:23], v[104:107], v[204:207], v[20:23]
s_waitcnt lgkmcnt(6)
v_mfma_f32_16x16x32_bf16 v[20:23], v[60:63], v[212:215], v[20:23]
ds_read_b128 v[204:207], v9 offset:38400
v_mfma_f32_16x16x32_bf16 v[16:19], v[124:127], v[212:215], v[16:19]
ds_read_b128 v[212:215], v3 offset:30720
s_waitcnt lgkmcnt(7)
v_mfma_f32_16x16x32_bf16 v[16:19], v[180:183], v[244:247], v[16:19]
ds_read_b128 v[248:251], v3 offset:33280
v_mfma_f32_16x16x32_bf16 v[20:23], v[124:127], v[244:247], v[20:23]
s_waitcnt lgkmcnt(7)
v_mfma_f32_16x16x32_bf16 v[20:23], v[180:183], v[224:227], v[20:23]
ds_read_b128 v[244:247], v3 offset:35840
v_mfma_f32_16x16x32_bf16 v[16:19], v[144:147], v[224:227], v[16:19]
s_waitcnt lgkmcnt(7)
v_mfma_f32_16x16x32_bf16 v[16:19], v[200:203], v[192:195], v[16:19]
ds_read_b128 v[224:227], v3 offset:38400
v_mfma_f32_16x16x32_bf16 v[20:23], v[144:147], v[192:195], v[20:23]
s_waitcnt lgkmcnt(7)
v_mfma_f32_16x16x32_bf16 v[20:23], v[200:203], v[232:235], v[20:23]
ds_read_b128 v[192:195], v5 offset:20480
v_mfma_f32_16x16x32_bf16 v[16:19], v[228:231], v[232:235], v[16:19]
s_waitcnt lgkmcnt(7)
v_mfma_f32_16x16x32_bf16 v[16:19], v[216:219], v[240:243], v[16:19]
ds_read_b128 v[232:235], v5 offset:23040
v_mfma_f32_16x16x32_bf16 v[20:23], v[228:231], v[240:243], v[20:23]
s_waitcnt lgkmcnt(7)
v_mfma_f32_16x16x32_bf16 v[20:23], v[216:219], v[236:239], v[20:23]
ds_read_b128 v[240:243], v5 offset:25600
v_mfma_f32_16x16x32_bf16 v[16:19], v[188:191], v[236:239], v[16:19]
s_waitcnt lgkmcnt(7)
v_mfma_f32_16x16x32_bf16 v[20:23], v[188:191], v[204:207], v[20:23]
ds_read_b128 v[204:207], v5 offset:28160
s_waitcnt lgkmcnt(7)
v_mfma_f32_16x16x32_bf16 v[32:35], v[72:75], v[212:215], v[32:35]
s_waitcnt lgkmcnt(6)
v_mfma_f32_16x16x32_bf16 v[32:35], v[96:99], v[248:251], v[32:35]
ds_read_b128 v[212:215], v5 offset:30720
v_mfma_f32_16x16x32_bf16 v[36:39], v[72:75], v[248:251], v[36:39]
s_waitcnt lgkmcnt(6)
v_mfma_f32_16x16x32_bf16 v[36:39], v[96:99], v[244:247], v[36:39]
ds_read_b128 v[236:239], v5 offset:33280
v_mfma_f32_16x16x32_bf16 v[32:35], v[100:103], v[244:247], v[32:35]
s_add_u32 s40, s44, 4096
s_waitcnt lgkmcnt(6)
v_mfma_f32_16x16x32_bf16 v[32:35], v[92:95], v[224:227], v[32:35]
ds_read_b128 v[244:247], v5 offset:35840
v_cvt_pk_bf16_f32 v16, v16, v17
v_mfma_f32_16x16x32_bf16 v[36:39], v[100:103], v[224:227], v[36:39]
v_cvt_pk_bf16_f32 v17, v18, v19
v_cvt_pk_bf16_f32 v18, v20, v21
s_waitcnt lgkmcnt(6)
v_mfma_f32_16x16x32_bf16 v[36:39], v[92:95], v[192:195], v[36:39]
v_cvt_pk_bf16_f32 v19, v22, v23
v_min_u32 v16, 0xfffffffe, v16
v_mfma_f32_16x16x32_bf16 v[32:35], v[120:123], v[192:195], v[32:35]
v_min_u32 v17, 0xfffffffe, v17
v_min_u32 v18, 0xfffffffe, v18
s_waitcnt lgkmcnt(5)
v_mfma_f32_16x16x32_bf16 v[32:35], v[132:135], v[232:235], v[32:35]
v_min_u32 v19, 0xfffffffe, v19
buffer_store_dwordx4 v[16:19], v14, s[28:31], s40 offen sc1
v_mfma_f32_16x16x32_bf16 v[36:39], v[120:123], v[232:235], v[36:39]
ds_read_b128 v[192:195], v5 offset:38400
ds_read_b128 v[224:227], v7 offset:20480
s_waitcnt lgkmcnt(6)
v_mfma_f32_16x16x32_bf16 v[36:39], v[132:135], v[240:243], v[36:39]
ds_read_b128 v[232:235], v7 offset:23040
v_mfma_f32_16x16x32_bf16 v[32:35], v[84:87], v[240:243], v[32:35]
s_waitcnt lgkmcnt(6)
v_mfma_f32_16x16x32_bf16 v[32:35], v[48:51], v[204:207], v[32:35]
ds_read_b128 v[240:243], v7 offset:25600
v_mfma_f32_16x16x32_bf16 v[36:39], v[84:87], v[204:207], v[36:39]
s_waitcnt lgkmcnt(6)
L_pg3_0:
s_cbranch_scc1 L_ret
v_mfma_f32_16x16x32_bf16 v[36:39], v[48:51], v[212:215], v[36:39]
ds_read_b128 v[204:207], v7 offset:28160
v_mfma_f32_16x16x32_bf16 v[32:35], v[88:91], v[212:215], v[32:35]
s_waitcnt lgkmcnt(6)
v_mfma_f32_16x16x32_bf16 v[32:35], v[108:111], v[236:239], v[32:35]
ds_read_b128 v[212:215], v7 offset:30720
v_mfma_f32_16x16x32_bf16 v[36:39], v[88:91], v[236:239], v[36:39]
s_waitcnt lgkmcnt(6)
v_mfma_f32_16x16x32_bf16 v[36:39], v[108:111], v[244:247], v[36:39]
ds_read_b128 v[236:239], v7 offset:33280
v_mfma_f32_16x16x32_bf16 v[32:35], v[68:71], v[244:247], v[32:35]
s_waitcnt lgkmcnt(6)
v_mfma_f32_16x16x32_bf16 v[32:35], v[136:139], v[192:195], v[32:35]
ds_read_b128 v[244:247], v7 offset:35840
v_mfma_f32_16x16x32_bf16 v[36:39], v[68:71], v[192:195], v[36:39]
s_waitcnt lgkmcnt(6)
v_mfma_f32_16x16x32_bf16 v[36:39], v[136:139], v[224:227], v[36:39]
ds_read_b128 v[192:195], v7 offset:38400
v_mfma_f32_16x16x32_bf16 v[32:35], v[140:143], v[224:227], v[32:35]
s_waitcnt lgkmcnt(6)
v_mfma_f32_16x16x32_bf16 v[32:35], v[56:59], v[232:235], v[32:35]
ds_read_b128 v[224:227], v9 offset:20480
v_mfma_f32_16x16x32_bf16 v[36:39], v[140:143], v[232:235], v[36:39]
s_waitcnt lgkmcnt(6)
v_mfma_f32_16x16x32_bf16 v[36:39], v[56:59], v[240:243], v[36:39]
ds_read_b128 v[232:235], v9 offset:23040
v_mfma_f32_16x16x32_bf16 v[32:35], v[148:151], v[240:243], v[32:35]
s_waitcnt lgkmcnt(6)
v_mfma_f32_16x16x32_bf16 v[32:35], v[152:155], v[204:207], v[32:35]
ds_read_b128 v[240:243], v9 offset:25600
v_mfma_f32_16x16x32_bf16 v[36:39], v[148:151], v[204:207], v[36:39]
s_waitcnt lgkmcnt(6)
v_mfma_f32_16x16x32_bf16 v[36:39], v[152:155], v[212:215], v[36:39]
ds_read_b128 v[204:207], v9 offset:28160
v_mfma_f32_16x16x32_bf16 v[32:35], v[156:159], v[212:215], v[32:35]
s_waitcnt lgkmcnt(6)
v_mfma_f32_16x16x32_bf16 v[32:35], v[64:67], v[236:239], v[32:35]
ds_read_b128 v[212:215], v9 offset:30720
v_mfma_f32_16x16x32_bf16 v[36:39], v[156:159], v[236:239], v[36:39]
s_waitcnt lgkmcnt(6)
v_mfma_f32_16x16x32_bf16 v[36:39], v[64:67], v[244:247], v[36:39]
ds_read_b128 v[236:239], v9 offset:33280
v_mfma_f32_16x16x32_bf16 v[32:35], v[164:167], v[244:247], v[32:35]
s_barrier
s_waitcnt lgkmcnt(6)
v_mfma_f32_16x16x32_bf16 v[32:35], v[168:171], v[192:195], v[32:35]
ds_read_b128 v[244:247], v9 offset:35840
v_mfma_f32_16x16x32_bf16 v[36:39], v[164:167], v[192:195], v[36:39]
s_waitcnt lgkmcnt(6)
v_mfma_f32_16x16x32_bf16 v[36:39], v[168:171], v[224:227], v[36:39]
ds_read_b128 v[192:195], v9 offset:38400
v_mfma_f32_16x16x32_bf16 v[32:35], v[80:83], v[224:227], v[32:35]
s_waitcnt lgkmcnt(6)
v_mfma_f32_16x16x32_bf16 v[32:35], v[176:179], v[232:235], v[32:35]
ds_read_b128 v[224:227], v11 offset:20480
v_mfma_f32_16x16x32_bf16 v[36:39], v[80:83], v[232:235], v[36:39]
s_waitcnt lgkmcnt(6)
v_mfma_f32_16x16x32_bf16 v[36:39], v[176:179], v[240:243], v[36:39]
ds_read_b128 v[232:235], v11 offset:23040
v_mfma_f32_16x16x32_bf16 v[32:35], v[104:107], v[240:243], v[32:35]
s_waitcnt lgkmcnt(6)
v_mfma_f32_16x16x32_bf16 v[32:35], v[60:63], v[204:207], v[32:35]
ds_read_b128 v[240:243], v11 offset:25600
v_mfma_f32_16x16x32_bf16 v[36:39], v[104:107], v[204:207], v[36:39]
s_waitcnt lgkmcnt(6)
v_mfma_f32_16x16x32_bf16 v[36:39], v[60:63], v[212:215], v[36:39]
ds_read_b128 v[204:207], v11 offset:28160
v_mfma_f32_16x16x32_bf16 v[32:35], v[124:127], v[212:215], v[32:35]
ds_read_b128 v[212:215], v8 offset:25600
s_waitcnt lgkmcnt(7)
v_mfma_f32_16x16x32_bf16 v[32:35], v[180:183], v[236:239], v[32:35]
ds_read_b128 v[248:251], v8 offset:28160
v_mfma_f32_16x16x32_bf16 v[36:39], v[124:127], v[236:239], v[36:39]
s_waitcnt lgkmcnt(7)
v_mfma_f32_16x16x32_bf16 v[36:39], v[180:183], v[244:247], v[36:39]
ds_read_b128 v[236:239], v8 offset:30720
v_mfma_f32_16x16x32_bf16 v[32:35], v[144:147], v[244:247], v[32:35]
s_waitcnt lgkmcnt(7)
v_mfma_f32_16x16x32_bf16 v[32:35], v[200:203], v[192:195], v[32:35]
ds_read_b128 v[244:247], v8 offset:33280
v_mfma_f32_16x16x32_bf16 v[36:39], v[144:147], v[192:195], v[36:39]
s_waitcnt lgkmcnt(7)
v_mfma_f32_16x16x32_bf16 v[36:39], v[200:203], v[224:227], v[36:39]
ds_read_b128 v[192:195], v8 offset:35840
v_mfma_f32_16x16x32_bf16 v[32:35], v[228:231], v[224:227], v[32:35]
s_waitcnt lgkmcnt(7)
v_mfma_f32_16x16x32_bf16 v[32:35], v[216:219], v[232:235], v[32:35]
ds_read_b128 v[224:227], v8 offset:38400
v_mfma_f32_16x16x32_bf16 v[36:39], v[228:231], v[232:235], v[36:39]
s_waitcnt lgkmcnt(7)
v_mfma_f32_16x16x32_bf16 v[36:39], v[216:219], v[240:243], v[36:39]
ds_read_b128 v[232:235], v10 offset:20480
v_mfma_f32_16x16x32_bf16 v[32:35], v[188:191], v[240:243], v[32:35]
s_waitcnt lgkmcnt(7)
v_mfma_f32_16x16x32_bf16 v[36:39], v[188:191], v[204:207], v[36:39]
ds_read_b128 v[204:207], v10 offset:23040
s_waitcnt lgkmcnt(7)
v_mfma_f32_16x16x32_bf16 v[40:43], v[160:163], v[212:215], v[40:43]
s_add_u32 s41, s44, 45056
s_waitcnt lgkmcnt(6)
v_mfma_f32_16x16x32_bf16 v[40:43], v[172:175], v[248:251], v[40:43]
ds_read_b128 v[212:215], v10 offset:25600
v_mfma_f32_16x16x32_bf16 v[44:47], v[160:163], v[248:251], v[44:47]
s_waitcnt lgkmcnt(6)
v_mfma_f32_16x16x32_bf16 v[44:47], v[172:175], v[236:239], v[44:47]
ds_read_b128 v[160:163], v10 offset:28160
v_mfma_f32_16x16x32_bf16 v[40:43], v[76:79], v[236:239], v[40:43]
s_add_u32 s40, s44, 32768
s_waitcnt lgkmcnt(6)
v_mfma_f32_16x16x32_bf16 v[40:43], v[116:119], v[244:247], v[40:43]
ds_read_b128 v[172:175], v10 offset:30720
v_cvt_pk_bf16_f32 v32, v32, v33
v_mfma_f32_16x16x32_bf16 v[44:47], v[76:79], v[244:247], v[44:47]
v_cvt_pk_bf16_f32 v33, v34, v35
v_cvt_pk_bf16_f32 v34, v36, v37
s_waitcnt lgkmcnt(6)
v_mfma_f32_16x16x32_bf16 v[44:47], v[116:119], v[192:195], v[44:47]
v_cvt_pk_bf16_f32 v35, v38, v39
v_min_u32 v32, 0xfffffffe, v32
v_mfma_f32_16x16x32_bf16 v[40:43], v[184:187], v[192:195], v[40:43]
v_min_u32 v33, 0xfffffffe, v33
v_min_u32 v34, 0xfffffffe, v34
s_waitcnt lgkmcnt(5)
v_mfma_f32_16x16x32_bf16 v[40:43], v[112:115], v[224:227], v[40:43]
v_min_u32 v35, 0xfffffffe, v35
buffer_store_dwordx4 v[32:35], v14, s[28:31], s40 offen sc1
v_mfma_f32_16x16x32_bf16 v[44:47], v[184:187], v[224:227], v[44:47]
ds_read_b128 v[76:79], v10 offset:33280
ds_read_b128 v[116:119], v3 offset:35840
s_waitcnt lgkmcnt(6)
v_mfma_f32_16x16x32_bf16 v[44:47], v[112:115], v[232:235], v[44:47]
ds_read_b128 v[112:115], v3 offset:38400
v_mfma_f32_16x16x32_bf16 v[40:43], v[196:199], v[232:235], v[40:43]
ds_read_b128 v[184:187], v5 offset:20480
s_waitcnt lgkmcnt(7)
v_mfma_f32_16x16x32_bf16 v[40:43], v[52:55], v[204:207], v[40:43]
ds_read_b128 v[192:195], v5 offset:23040
v_mfma_f32_16x16x32_bf16 v[44:47], v[196:199], v[204:207], v[44:47]
s_waitcnt lgkmcnt(7)
v_mfma_f32_16x16x32_bf16 v[44:47], v[52:55], v[212:215], v[44:47]
ds_read_b128 v[52:55], v5 offset:25600
v_mfma_f32_16x16x32_bf16 v[40:43], v[208:211], v[212:215], v[40:43]
s_waitcnt lgkmcnt(7)
v_mfma_f32_16x16x32_bf16 v[40:43], v[128:131], v[160:163], v[40:43]
ds_read_b128 v[196:199], v5 offset:28160
v_mfma_f32_16x16x32_bf16 v[44:47], v[208:211], v[160:163], v[44:47]
s_waitcnt lgkmcnt(7)
v_mfma_f32_16x16x32_bf16 v[44:47], v[128:131], v[172:175], v[44:47]
ds_read_b128 v[128:131], v5 offset:30720
v_mfma_f32_16x16x32_bf16 v[40:43], v[220:223], v[172:175], v[40:43]
s_waitcnt lgkmcnt(7)
v_mfma_f32_16x16x32_bf16 v[44:47], v[220:223], v[76:79], v[44:47]
ds_read_b128 v[76:79], v5 offset:33280
s_waitcnt lgkmcnt(7)
v_mfma_f32_16x16x32_bf16 v[40:43], v[72:75], v[116:119], v[40:43]
s_waitcnt lgkmcnt(6)
v_mfma_f32_16x16x32_bf16 v[40:43], v[96:99], v[112:115], v[40:43]
ds_read_b128 v[116:119], v5 offset:35840
v_mfma_f32_16x16x32_bf16 v[44:47], v[72:75], v[112:115], v[44:47]
s_waitcnt lgkmcnt(6)
v_mfma_f32_16x16x32_bf16 v[44:47], v[96:99], v[184:187], v[44:47]
ds_read_b128 v[72:75], v5 offset:38400
v_mfma_f32_16x16x32_bf16 v[40:43], v[100:103], v[184:187], v[40:43]
s_waitcnt lgkmcnt(6)
v_mfma_f32_16x16x32_bf16 v[40:43], v[92:95], v[192:195], v[40:43]
ds_read_b128 v[96:99], v7 offset:20480
v_mfma_f32_16x16x32_bf16 v[44:47], v[100:103], v[192:195], v[44:47]
s_waitcnt lgkmcnt(6)
v_mfma_f32_16x16x32_bf16 v[44:47], v[92:95], v[52:55], v[44:47]
ds_read_b128 v[92:95], v7 offset:23040
v_mfma_f32_16x16x32_bf16 v[40:43], v[120:123], v[52:55], v[40:43]
s_waitcnt lgkmcnt(6)
v_mfma_f32_16x16x32_bf16 v[40:43], v[132:135], v[196:199], v[40:43]
ds_read_b128 v[52:55], v7 offset:25600
v_mfma_f32_16x16x32_bf16 v[44:47], v[120:123], v[196:199], v[44:47]
s_waitcnt lgkmcnt(6)
v_mfma_f32_16x16x32_bf16 v[44:47], v[132:135], v[128:131], v[44:47]
ds_read_b128 v[100:103], v7 offset:28160
v_mfma_f32_16x16x32_bf16 v[40:43], v[84:87], v[128:131], v[40:43]
s_waitcnt lgkmcnt(6)
v_mfma_f32_16x16x32_bf16 v[40:43], v[48:51], v[76:79], v[40:43]
ds_read_b128 v[112:115], v7 offset:30720
v_mfma_f32_16x16x32_bf16 v[44:47], v[84:87], v[76:79], v[44:47]
s_waitcnt lgkmcnt(6)
v_mfma_f32_16x16x32_bf16 v[44:47], v[48:51], v[116:119], v[44:47]
ds_read_b128 v[48:51], v7 offset:33280
v_mfma_f32_16x16x32_bf16 v[40:43], v[88:91], v[116:119], v[40:43]
s_waitcnt lgkmcnt(6)
v_mfma_f32_16x16x32_bf16 v[40:43], v[108:111], v[72:75], v[40:43]
ds_read_b128 v[76:79], v7 offset:35840
v_mfma_f32_16x16x32_bf16 v[44:47], v[88:91], v[72:75], v[44:47]
s_waitcnt lgkmcnt(6)
v_mfma_f32_16x16x32_bf16 v[44:47], v[108:111], v[96:99], v[44:47]
ds_read_b128 v[72:75], v7 offset:38400
v_mfma_f32_16x16x32_bf16 v[40:43], v[68:71], v[96:99], v[40:43]
s_waitcnt lgkmcnt(6)
v_mfma_f32_16x16x32_bf16 v[40:43], v[136:139], v[92:95], v[40:43]
ds_read_b128 v[84:87], v9 offset:20480
v_mfma_f32_16x16x32_bf16 v[44:47], v[68:71], v[92:95], v[44:47]
buffer_load_dwordx4 v[68:71], v14, s[28:31], s41 offen offset:0 sc1
s_waitcnt lgkmcnt(6)
v_mfma_f32_16x16x32_bf16 v[44:47], v[136:139], v[52:55], v[44:47]
ds_read_b128 v[88:91], v9 offset:23040
v_mfma_f32_16x16x32_bf16 v[40:43], v[140:143], v[52:55], v[40:43]
s_waitcnt lgkmcnt(6)
v_mfma_f32_16x16x32_bf16 v[40:43], v[56:59], v[100:103], v[40:43]
ds_read_b128 v[52:55], v9 offset:25600
v_mfma_f32_16x16x32_bf16 v[44:47], v[140:143], v[100:103], v[44:47]
s_waitcnt lgkmcnt(6)
v_mfma_f32_16x16x32_bf16 v[44:47], v[56:59], v[112:115], v[44:47]
ds_read_b128 v[56:59], v9 offset:28160
v_mfma_f32_16x16x32_bf16 v[40:43], v[148:151], v[112:115], v[40:43]
s_waitcnt lgkmcnt(6)
v_mfma_f32_16x16x32_bf16 v[40:43], v[152:155], v[48:51], v[40:43]
ds_read_b128 v[92:95], v9 offset:30720
v_mfma_f32_16x16x32_bf16 v[44:47], v[148:151], v[48:51], v[44:47]
s_waitcnt lgkmcnt(6)
v_mfma_f32_16x16x32_bf16 v[44:47], v[152:155], v[76:79], v[44:47]
ds_read_b128 v[48:51], v9 offset:33280
v_mfma_f32_16x16x32_bf16 v[40:43], v[156:159], v[76:79], v[40:43]
s_waitcnt lgkmcnt(6)
v_mfma_f32_16x16x32_bf16 v[40:43], v[64:67], v[72:75], v[40:43]
ds_read_b128 v[76:79], v9 offset:35840
v_mfma_f32_16x16x32_bf16 v[44:47], v[156:159], v[72:75], v[44:47]
s_waitcnt lgkmcnt(6)
v_mfma_f32_16x16x32_bf16 v[44:47], v[64:67], v[84:87], v[44:47]
ds_read_b128 v[64:67], v9 offset:38400
v_mfma_f32_16x16x32_bf16 v[40:43], v[164:167], v[84:87], v[40:43]
buffer_load_dwordx4 v[72:75], v14, s[28:31], s41 offen offset:0 sc1
s_waitcnt lgkmcnt(6)
v_mfma_f32_16x16x32_bf16 v[40:43], v[168:171], v[88:91], v[40:43]
ds_read_b128 v[84:87], v11 offset:20480
v_mfma_f32_16x16x32_bf16 v[44:47], v[164:167], v[88:91], v[44:47]
s_waitcnt lgkmcnt(6)
v_mfma_f32_16x16x32_bf16 v[44:47], v[168:171], v[52:55], v[44:47]
ds_read_b128 v[88:91], v11 offset:23040
v_mfma_f32_16x16x32_bf16 v[40:43], v[80:83], v[52:55], v[40:43]
s_waitcnt lgkmcnt(6)
v_mfma_f32_16x16x32_bf16 v[40:43], v[176:179], v[56:59], v[40:43]
ds_read_b128 v[52:55], v11 offset:25600
v_mfma_f32_16x16x32_bf16 v[44:47], v[80:83], v[56:59], v[44:47]
s_waitcnt lgkmcnt(6)
v_mfma_f32_16x16x32_bf16 v[44:47], v[176:179], v[92:95], v[44:47]
ds_read_b128 v[56:59], v11 offset:28160
v_mfma_f32_16x16x32_bf16 v[40:43], v[104:107], v[92:95], v[40:43]
s_waitcnt lgkmcnt(6)
v_mfma_f32_16x16x32_bf16 v[40:43], v[60:63], v[48:51], v[40:43]
ds_read_b128 v[80:83], v11 offset:30720
v_mfma_f32_16x16x32_bf16 v[44:47], v[104:107], v[48:51], v[44:47]
s_waitcnt lgkmcnt(6)
v_mfma_f32_16x16x32_bf16 v[44:47], v[60:63], v[76:79], v[44:47]
ds_read_b128 v[48:51], v11 offset:33280
v_mfma_f32_16x16x32_bf16 v[40:43], v[124:127], v[76:79], v[40:43]
s_waitcnt lgkmcnt(6)
v_mfma_f32_16x16x32_bf16 v[40:43], v[180:183], v[64:67], v[40:43]
v_mfma_f32_16x16x32_bf16 v[44:47], v[124:127], v[64:67], v[44:47]
s_waitcnt lgkmcnt(5)
v_mfma_f32_16x16x32_bf16 v[44:47], v[180:183], v[84:87], v[44:47]
v_mfma_f32_16x16x32_bf16 v[40:43], v[144:147], v[84:87], v[40:43]
s_waitcnt lgkmcnt(4)
v_mfma_f32_16x16x32_bf16 v[40:43], v[200:203], v[88:91], v[40:43]
v_mfma_f32_16x16x32_bf16 v[44:47], v[144:147], v[88:91], v[44:47]
s_waitcnt lgkmcnt(3)
v_mfma_f32_16x16x32_bf16 v[44:47], v[200:203], v[52:55], v[44:47]
v_mfma_f32_16x16x32_bf16 v[40:43], v[228:231], v[52:55], v[40:43]
s_waitcnt lgkmcnt(2)
v_mfma_f32_16x16x32_bf16 v[40:43], v[216:219], v[56:59], v[40:43]
v_mfma_f32_16x16x32_bf16 v[44:47], v[228:231], v[56:59], v[44:47]
s_waitcnt lgkmcnt(1)
v_mfma_f32_16x16x32_bf16 v[44:47], v[216:219], v[80:83], v[44:47]
v_mfma_f32_16x16x32_bf16 v[40:43], v[188:191], v[80:83], v[40:43]
s_waitcnt lgkmcnt(0)
v_mfma_f32_16x16x32_bf16 v[44:47], v[188:191], v[48:51], v[44:47]
L_pl3:
s_waitcnt vmcnt(1)
v_max3_u32 v56, v68, v69, v70
v_max_u32 v56, v56, v71
v_cmp_eq_u32 vcc, -1, v56
s_cbranch_vccz L_got3_0
buffer_load_dwordx4 v[68:71], v14, s[28:31], s41 offen offset:0 sc1
s_waitcnt vmcnt(1)
v_max3_u32 v56, v72, v73, v74
v_max_u32 v56, v56, v75
v_cmp_eq_u32 vcc, -1, v56
s_cbranch_vccz L_got3_1
buffer_load_dwordx4 v[72:75], v14, s[28:31], s41 offen offset:0 sc1
s_branch L_pl3
L_got3_1:
v_lshlrev_b32 v48, 16, v72
v_and_b32 v49, 0xffff0000, v72
v_lshlrev_b32 v50, 16, v73
v_and_b32 v51, 0xffff0000, v73
v_lshlrev_b32 v52, 16, v74
v_and_b32 v53, 0xffff0000, v74
v_lshlrev_b32 v54, 16, v75
v_and_b32 v55, 0xffff0000, v75
s_branch L_ok3
L_got3_0:
v_lshlrev_b32 v48, 16, v68
v_and_b32 v49, 0xffff0000, v68
v_lshlrev_b32 v50, 16, v69
v_and_b32 v51, 0xffff0000, v69
v_lshlrev_b32 v52, 16, v70
v_and_b32 v53, 0xffff0000, v70
v_lshlrev_b32 v54, 16, v71
v_and_b32 v55, 0xffff0000, v71
L_ok3:
v_add_f32 v48, v40, v48
v_add_f32 v49, v41, v49
v_add_f32 v50, v42, v50
v_add_f32 v51, v43, v51
v_add_f32 v52, v44, v52
v_add_f32 v53, v45, v53
v_add_f32 v54, v46, v54
v_add_f32 v55, v47, v55
v_mul_f32 v48, s46, v48
v_mul_f32 v49, s46, v49
v_mul_f32 v50, s46, v50
v_mul_f32 v51, s46, v51
v_mul_f32 v52, s46, v52
v_mul_f32 v53, s46, v53
v_mul_f32 v54, s46, v54
v_mul_f32 v55, s46, v55
s_barrier
ds_read_b128 v[60:63], v1 offset:0
ds_read_b128 v[64:67], v1 offset:1024
v_exp_f32 v48, v48
v_exp_f32 v49, v49
v_exp_f32 v50, v50
v_exp_f32 v51, v51
v_exp_f32 v52, v52
v_exp_f32 v53, v53
v_exp_f32 v54, v54
v_exp_f32 v55, v55
v_add_f32 v48, 1.0, v48
v_add_f32 v49, 1.0, v49
v_add_f32 v50, 1.0, v50
v_add_f32 v51, 1.0, v51
v_add_f32 v52, 1.0, v52
v_add_f32 v53, 1.0, v53
v_add_f32 v54, 1.0, v54
v_add_f32 v55, 1.0, v55
v_rcp_f32 v48, v48
v_rcp_f32 v49, v49
v_rcp_f32 v50, v50
v_rcp_f32 v51, v51
v_rcp_f32 v52, v52
v_rcp_f32 v53, v53
v_rcp_f32 v54, v54
v_rcp_f32 v55, v55
s_waitcnt lgkmcnt(0)
v_mul_f32 v48, v48, v60
v_mul_f32 v49, v49, v61
v_mul_f32 v50, v50, v62
v_mul_f32 v51, v51, v63
v_cvt_pk_bf16_f32 v40, v48, v49
v_cvt_pk_bf16_f32 v41, v50, v51
buffer_store_dwordx2 v[40:41], v15, s[24:27], 0 offen offset:0
v_mul_f32 v52, v52, v64
v_mul_f32 v53, v53, v65
v_mul_f32 v54, v54, v66
v_mul_f32 v55, v55, v67
v_cvt_pk_bf16_f32 v42, v52, v53
v_cvt_pk_bf16_f32 v43, v54, v55
buffer_store_dwordx2 v[42:43], v15, s[24:27], 0 offen offset:1024
s_endpgm
L_helper:
s_lshr_b32 s40, s36, 2
s_cmp_eq_u32 s40, 1
s_cbranch_scc1 L_hg1
s_cmp_eq_u32 s40, 2
s_cbranch_scc1 L_hg2
s_cmp_eq_u32 s40, 3
s_cbranch_scc1 L_hg3
L_hg0:
s_add_u32 m0, s45, 16384
s_mov_b32 s46, 1048576
buffer_load_dwordx4 v57, s[20:23], s46 offen  lds
s_add_u32 m0, s45, 20480
s_mov_b32 s46, 1310720
buffer_load_dwordx4 v57, s[20:23], s46 offen  lds
s_add_u32 m0, s45, 24576
s_mov_b32 s46, 1572864
buffer_load_dwordx4 v57, s[20:23], s46 offen  lds
s_add_u32 m0, s45, 28672
s_mov_b32 s46, 1835008
buffer_load_dwordx4 v57, s[20:23], s46 offen  lds
s_cmp_lg_u32 s32, 7
s_cbranch_scc1 L_ng70
s_add_u32 s54, s36, 16
s_lshl_b32 s54, s54, 18
s_cmp_eq_u32 s36, 15
s_cselect_b32 s54, 0x8000, s54
s_mov_b32 exec_hi, 0
buffer_load_dword v0, v58, s[20:23], s54 offen
s_mov_b64 exec, -1
L_ng70:
s_barrier
s_add_u32 m0, s45, 32768
s_mov_b32 s46, 2097152
buffer_load_dwordx4 v57, s[20:23], s46 offen  lds
s_and_b32 s40, s36, 3
s_lshl_b32 s40, s40, 1
s_or_b32 s40, s40, s35
v_lshrrev_b32 v62, 4, v1
v_mul_u32_u24 v62, 8, v62
v_add_u32 v62, s40, v62
v_min_u32 v62, 22, v62
s_add_u32 m0, s45, 36864
s_mov_b32 s46, 2359296
buffer_load_dwordx4 v57, s[20:23], s46 offen  lds
v_add_u32 v60, 32, v62
v_cmp_le_u32 vcc, 22, v62
v_add_u32 v63, 71, v62
s_nop 0
v_cndmask_b32 v60, v60, v63, vcc
v_mul_u32_u24 v63, 2115, v60
v_lshrrev_b32 v63, 16, v63
s_add_u32 m0, s45, 40960
s_mov_b32 s46, 2621440
buffer_load_dwordx4 v57, s[20:23], s46 offen  lds
v_mul_u32_u24 v64, 31, v63
v_sub_u32 v60, v60, v64
v_lshlrev_b32 v60, 18, v60
v_lshl_add_u32 v60, v63, 15, v60
v_and_b32 v62, 7, v1
v_lshl_add_u32 v60, v62, 10, v60
v_bfe_u32 v62, v1, 3, 1
s_waitcnt vmcnt(8)
s_cmp_eq_u32 s32, 7
s_cbranch_scc1 L_w70_1
s_waitcnt vmcnt(7)
L_w70_1:
s_barrier
s_add_u32 m0, s45, 45056
s_mov_b32 s46, 2883584
buffer_load_dwordx4 v57, s[20:23], s46 offen  lds
v_lshl_add_u32 v60, v62, 9, v60
s_andn2_b32 s40, s47, 512
s_lshl_b32 s41, s42, 13
s_add_u32 s40, s40, s41
v_add_u32 v60, s40, v60
v_mov_b32 v16, -1
v_mov_b32 v17, -1
s_waitcnt vmcnt(5)
s_cmp_eq_u32 s32, 7
s_cbranch_scc1 L_w70_2
s_waitcnt vmcnt(4)
L_w70_2:
s_barrier
s_add_u32 m0, s45, 49152
s_mov_b32 s46, 3145728
buffer_load_dwordx4 v57, s[20:23], s46 offen  lds
v_mov_b32 v18, -1
v_mov_b32 v19, -1
s_xor_b32 s58, s37, 2
s_mul_i32 s58, s58, 12288
s_add_u32 s58, s58, 0
s_add_u32 s58, s58, s44
s_xor_b32 s59, s37, 3
s_add_u32 m0, s45, 53248
s_mov_b32 s46, 3407872
buffer_load_dwordx4 v57, s[20:23], s46 offen  lds
s_mul_i32 s59, s59, 12288
s_add_u32 s59, s59, 4096
s_add_u32 s59, s59, s44
s_xor_b32 s39, s37, 1
s_mul_i32 s39, s39, 12288
s_add_u32 s39, s39, 8192
s_add_u32 s39, s39, s44
s_add_u32 m0, s45, 57344
s_mov_b32 s46, 3670016
buffer_load_dwordx4 v57, s[20:23], s46 offen  lds
s_lshl_b32 s40, s38, 2
v_mov_b32 v20, s40
v_mov_b32 v21, 1
s_mul_i32 s40, s38, 49408
s_add_u32 s40, s40, 49152
v_mov_b32 v66, s40
s_mov_b32 s28, s12
s_add_u32 m0, s45, 61440
s_mov_b32 s46, 3932160
buffer_load_dwordx4 v57, s[20:23], s46 offen  lds
s_mov_b32 s29, s13
s_mov_b32 s30, 0x10000000
s_mov_b32 s31, 0x20000
s_add_u32 m0, s45, 65536
s_mov_b32 s46, 4194304
buffer_load_dwordx4 v57, s[20:23], s46 offen  lds
s_add_u32 m0, s45, 69632
s_mov_b32 s46, 4456448
buffer_load_dwordx4 v57, s[20:23], s46 offen  lds
s_add_u32 m0, s45, 73728
s_mov_b32 s46, 4718592
buffer_load_dwordx4 v57, s[20:23], s46 offen  lds
s_waitcnt vmcnt(7)
s_barrier
s_add_u32 m0, s45, 77824
s_mov_b32 s46, 4980736
buffer_load_dwordx4 v57, s[20:23], s46 offen  lds
s_add_u32 m0, s45, 81920
s_mov_b32 s46, 5242880
buffer_load_dwordx4 v57, s[20:23], s46 offen  lds
s_add_u32 m0, s45, 86016
s_mov_b32 s46, 5505024
buffer_load_dwordx4 v57, s[20:23], s46 offen  lds
s_add_u32 m0, s45, 90112
s_mov_b32 s46, 5767168
buffer_load_dwordx4 v57, s[20:23], s46 offen  lds
s_add_u32 m0, s45, 94208
s_mov_b32 s46, 6029312
buffer_load_dwordx4 v57, s[20:23], s46 offen  lds
s_add_u32 m0, s45, 98304
s_mov_b32 s46, 6291456
buffer_load_dwordx4 v57, s[20:23], s46 offen  lds
s_add_u32 m0, s45, 102400
s_mov_b32 s46, 6553600
buffer_load_dwordx4 v57, s[20:23], s46 offen  lds
s_mov_b32 exec_hi, 65535
buffer_load_dword v61, v60, s[20:23], 0 offen
s_mov_b64 exec, -1
buffer_load_dwordx4 v[68:71], v66, s[28:31], 0 offen sc1
s_waitcnt vmcnt(12)
s_barrier
s_add_u32 m0, s45, 106496
s_mov_b32 s46, 6815744
buffer_load_dwordx4 v57, s[20:23], s46 offen  lds
s_cmp_lg_u32 s32, 4
s_cbranch_scc1 L_wk0_0
s_cmp_eq_u32 0, 0
s_call_b64 s[50:51], L_pgc_0
L_wk0_0:
s_cmp_lg_u32 s32, 5
s_cbranch_scc1 L_wk0_1
s_cmp_eq_u32 0, 0
s_call_b64 s[50:51], L_pgc_1
L_wk0_1:
s_cmp_lg_u32 s32, 6
s_cbranch_scc1 L_wk0_2
s_cmp_lg_u32 s37, 0
s_cbranch_scc1 L_wq0_3
s_cmp_eq_u32 0, 0
s_call_b64 s[50:51], L_pg0_0
L_wq0_3:
s_cmp_lg_u32 s37, 1
s_cbranch_scc1 L_wq0_4
s_cmp_eq_u32 0, 0
s_call_b64 s[50:51], L_pg1_0
L_wq0_4:
s_cmp_lg_u32 s37, 2
s_cbranch_scc1 L_wq0_5
s_cmp_eq_u32 0, 0
s_call_b64 s[50:51], L_pg2_0
L_wq0_5:
s_cmp_lg_u32 s37, 2
s_cbranch_scc1 L_wq0_6
s_cmp_eq_u32 0, 0
s_call_b64 s[50:51], L_pg2_1
L_wq0_6:
s_cmp_lg_u32 s37, 3
s_cbranch_scc1 L_wq0_7
s_cmp_eq_u32 0, 0
s_call_b64 s[50:51], L_pg3_0
L_wq0_7:
L_wk0_2:
s_cmp_lg_u32 s32, 7
s_cbranch_scc1 L_wk0_3
s_cmp_lg_u32 s37, 1
s_cbranch_scc1 L_wq0_8
s_cmp_eq_u32 0, 0
s_call_b64 s[50:51], L_warm1
L_wq0_8:
s_cmp_lg_u32 s37, 2
s_cbranch_scc1 L_wq0_9
s_cmp_eq_u32 0, 0
s_call_b64 s[50:51], L_warm2
L_wq0_9:
s_cmp_lg_u32 s37, 3
s_cbranch_scc1 L_wq0_10
s_cmp_eq_u32 0, 0
s_call_b64 s[50:51], L_warm3
L_wq0_10:
L_wk0_3:
v_add_u32 v48, 128, v56
v_add_u32 v49, 65664, v56
v_add_u32 v50, 131200, v56
s_add_u32 m0, s43, 20480
s_nop 0
buffer_load_dwordx4 v48, s[16:19], 0 offen lds
s_add_u32 m0, s43, 21504
s_nop 0
buffer_load_dwordx4 v49, s[16:19], 0 offen lds
s_add_u32 m0, s43, 22528
s_mov_b32 exec_hi, 0
buffer_load_dwordx4 v50, s[16:19], 0 offen lds
s_mov_b64 exec, -1
s_waitcnt vmcnt(12)
s_barrier
s_add_u32 m0, s45, 110592
s_mov_b32 s46, 7077888
buffer_load_dwordx4 v57, s[20:23], s46 offen  lds
v_add_u32 v48, 4224, v56
v_add_u32 v49, 69760, v56
v_add_u32 v50, 135296, v56
s_add_u32 m0, s43, 30720
s_nop 0
buffer_load_dwordx4 v48, s[16:19], 0 offen lds
s_add_u32 m0, s43, 31744
s_nop 0
buffer_load_dwordx4 v49, s[16:19], 0 offen lds
s_add_u32 m0, s43, 32768
s_mov_b32 exec_hi, 0
buffer_load_dwordx4 v50, s[16:19], 0 offen lds
s_mov_b64 exec, -1
s_waitcnt vmcnt(12)
s_barrier
s_add_u32 m0, s45, 0
s_mov_b32 s46, 7340032
buffer_load_dwordx4 v57, s[20:23], s46 offen  lds
s_add_u32 m0, s45, 4096
s_mov_b32 s46, 7602176
buffer_load_dwordx4 v57, s[20:23], s46 offen  lds
s_add_u32 m0, s45, 8192
s_mov_b32 s46, 7864320
buffer_load_dwordx4 v57, s[20:23], s46 offen  lds
s_add_u32 m0, s45, 12288
s_mov_b32 s46, 32768
buffer_load_dwordx4 v57, s[20:23], s46 offen  lds
s_add_u32 m0, s45, 16384
s_mov_b32 s46, 294912
buffer_load_dwordx4 v57, s[20:23], s46 offen  lds
s_add_u32 m0, s45, 20480
s_mov_b32 s46, 557056
buffer_load_dwordx4 v57, s[20:23], s46 offen  lds
s_waitcnt vmcnt(9)
s_barrier
s_add_u32 m0, s45, 24576
s_mov_b32 s46, 819200
buffer_load_dwordx4 v57, s[20:23], s46 offen  lds
s_add_u32 m0, s45, 28672
s_mov_b32 s46, 1081344
buffer_load_dwordx4 v57, s[20:23], s46 offen  lds
s_add_u32 m0, s45, 32768
s_mov_b32 s46, 1343488
buffer_load_dwordx4 v57, s[20:23], s46 offen  lds
s_add_u32 m0, s45, 36864
s_mov_b32 s46, 1605632
buffer_load_dwordx4 v57, s[20:23], s46 offen  lds
s_add_u32 m0, s45, 40960
s_mov_b32 s46, 1867776
buffer_load_dwordx4 v57, s[20:23], s46 offen  lds
s_add_u32 m0, s45, 45056
s_mov_b32 s46, 2129920
buffer_load_dwordx4 v57, s[20:23], s46 offen  lds
s_add_u32 m0, s45, 49152
s_mov_b32 s46, 2392064
buffer_load_dwordx4 v57, s[20:23], s46 offen  lds
s_waitcnt vmcnt(9)
s_barrier
s_add_u32 m0, s45, 53248
s_mov_b32 s46, 2654208
buffer_load_dwordx4 v57, s[20:23], s46 offen  lds
s_add_u32 m0, s45, 57344
s_mov_b32 s46, 2916352
buffer_load_dwordx4 v57, s[20:23], s46 offen  lds
s_add_u32 m0, s45, 61440
s_mov_b32 s46, 3178496
buffer_load_dwordx4 v57, s[20:23], s46 offen  lds
s_add_u32 m0, s45, 65536
s_mov_b32 s46, 3440640
buffer_load_dwordx4 v57, s[20:23], s46 offen  lds
s_add_u32 m0, s45, 69632
s_mov_b32 s46, 3702784
buffer_load_dwordx4 v57, s[20:23], s46 offen  lds
s_add_u32 m0, s45, 73728
s_mov_b32 s46, 3964928
buffer_load_dwordx4 v57, s[20:23], s46 offen  lds
s_add_u32 m0, s45, 77824
s_mov_b32 s46, 4227072
buffer_load_dwordx4 v57, s[20:23], s46 offen  lds
s_waitcnt vmcnt(12)
s_barrier
s_add_u32 m0, s45, 81920
s_mov_b32 s46, 4489216
buffer_load_dwordx4 v57, s[20:23], s46 offen  lds
s_add_u32 m0, s45, 86016
s_mov_b32 s46, 4751360
buffer_load_dwordx4 v57, s[20:23], s46 offen  lds
s_add_u32 m0, s45, 90112
s_mov_b32 s46, 5013504
buffer_load_dwordx4 v57, s[20:23], s46 offen  lds
s_add_u32 m0, s45, 94208
s_mov_b32 s46, 5275648
buffer_load_dwordx4 v57, s[20:23], s46 offen  lds
s_add_u32 m0, s45, 98304
s_mov_b32 s46, 5537792
buffer_load_dwordx4 v57, s[20:23], s46 offen  lds
s_add_u32 m0, s45, 102400
s_mov_b32 s46, 5799936
buffer_load_dwordx4 v57, s[20:23], s46 offen  lds
s_add_u32 m0, s45, 106496
s_mov_b32 s46, 98304
buffer_load_dwordx4 v57, s[20:23], s46 offen  lds
s_waitcnt vmcnt(15)
s_barrier
s_add_u32 m0, s45, 110592
s_mov_b32 s46, 6062080
buffer_load_dwordx4 v57, s[20:23], s46 offen  lds
s_add_u32 m0, s45, 0
s_mov_b32 s46, 6324224
buffer_load_dwordx4 v57, s[20:23], s46 offen  lds
s_add_u32 m0, s45, 4096
s_mov_b32 s46, 360448
buffer_load_dwordx4 v57, s[20:23], s46 offen  lds
s_add_u32 m0, s45, 8192
s_mov_b32 s46, 6586368
buffer_load_dwordx4 v57, s[20:23], s46 offen  lds
s_add_u32 m0, s45, 12288
s_mov_b32 s46, 6848512
buffer_load_dwordx4 v57, s[20:23], s46 offen  lds
s_add_u32 m0, s45, 16384
s_mov_b32 s46, 622592
buffer_load_dwordx4 v57, s[20:23], s46 offen  lds
s_add_u32 m0, s45, 20480
s_mov_b32 s46, 884736
buffer_load_dwordx4 v57, s[20:23], s46 offen  lds
s_waitcnt vmcnt(18)
s_barrier
s_add_u32 m0, s45, 24576
s_mov_b32 s46, 7110656
buffer_load_dwordx4 v57, s[20:23], s46 offen  lds
s_add_u32 m0, s45, 28672
s_mov_b32 s46, 7372800
buffer_load_dwordx4 v57, s[20:23], s46 offen  lds
s_add_u32 m0, s45, 32768
s_mov_b32 s46, 1146880
buffer_load_dwordx4 v57, s[20:23], s46 offen  lds
s_add_u32 m0, s45, 36864
s_mov_b32 s46, 7634944
buffer_load_dwordx4 v57, s[20:23], s46 offen  lds
s_add_u32 m0, s45, 40960
s_mov_b32 s46, 7897088
buffer_load_dwordx4 v57, s[20:23], s46 offen  lds
s_add_u32 m0, s45, 45056
s_mov_b32 s46, 1409024
buffer_load_dwordx4 v57, s[20:23], s46 offen  lds
s_waitcnt vmcnt(20)
s_barrier
s_add_u32 m0, s45, 49152
s_mov_b32 s46, 65536
buffer_load_dwordx4 v57, s[20:23], s46 offen  lds
s_add_u32 m0, s45, 53248
s_mov_b32 s46, 327680
buffer_load_dwordx4 v57, s[20:23], s46 offen  lds
s_add_u32 m0, s45, 57344
s_mov_b32 s46, 1671168
buffer_load_dwordx4 v57, s[20:23], s46 offen  lds
s_add_u32 m0, s45, 61440
s_mov_b32 s46, 1933312
buffer_load_dwordx4 v57, s[20:23], s46 offen  lds
s_waitcnt vmcnt(20)
s_barrier
s_add_u32 m0, s45, 65536
s_mov_b32 s46, 589824
buffer_load_dwordx4 v57, s[20:23], s46 offen  lds
s_add_u32 m0, s45, 69632
s_mov_b32 s46, 851968
buffer_load_dwordx4 v57, s[20:23], s46 offen  lds
s_add_u32 m0, s45, 73728
s_mov_b32 s46, 2195456
buffer_load_dwordx4 v57, s[20:23], s46 offen  lds
s_add_u32 m0, s45, 77824
s_mov_b32 s46, 1114112
buffer_load_dwordx4 v57, s[20:23], s46 offen  lds
s_waitcnt vmcnt(18)
s_barrier
s_add_u32 m0, s45, 81920
s_mov_b32 s46, 1376256
buffer_load_dwordx4 v57, s[20:23], s46 offen  lds
s_add_u32 m0, s45, 86016
s_mov_b32 s46, 2457600
buffer_load_dwordx4 v57, s[20:23], s46 offen  lds
s_add_u32 m0, s45, 90112
s_mov_b32 s46, 2719744
buffer_load_dwordx4 v57, s[20:23], s46 offen  lds
s_add_u32 m0, s45, 94208
s_mov_b32 s46, 1638400
buffer_load_dwordx4 v57, s[20:23], s46 offen  lds
s_cmp_lg_u32 s32, 4
s_cbranch_scc1 L_nosig0
s_mov_b64 exec, 1
global_atomic_add v20, v21, s[10:11] sc1
s_mov_b64 exec, -1
L_nosig0:
s_waitcnt vmcnt(15)
s_barrier
s_add_u32 m0, s45, 98304
s_mov_b32 s46, 1900544
buffer_load_dwordx4 v57, s[20:23], s46 offen  lds
s_add_u32 m0, s45, 102400
s_mov_b32 s46, 2981888
buffer_load_dwordx4 v57, s[20:23], s46 offen  lds
s_add_u32 m0, s45, 106496
s_mov_b32 s46, 2162688
buffer_load_dwordx4 v57, s[20:23], s46 offen  lds
s_add_u32 m0, s45, 110592
s_mov_b32 s46, 2424832
buffer_load_dwordx4 v57, s[20:23], s46 offen  lds
s_add_u32 m0, s45, 0
s_mov_b32 s46, 3244032
buffer_load_dwordx4 v57, s[20:23], s46 offen  lds
s_waitcnt vmcnt(13)
s_barrier
s_add_u32 m0, s45, 4096
s_mov_b32 s46, 3506176
buffer_load_dwordx4 v57, s[20:23], s46 offen  lds
s_add_u32 m0, s45, 8192
s_mov_b32 s46, 2686976
buffer_load_dwordx4 v57, s[20:23], s46 offen  lds
s_add_u32 m0, s45, 12288
s_mov_b32 s46, 2949120
buffer_load_dwordx4 v57, s[20:23], s46 offen  lds
s_add_u32 m0, s45, 16384
s_mov_b32 s46, 3768320
buffer_load_dwordx4 v57, s[20:23], s46 offen  lds
s_add_u32 m0, s45, 20480
s_mov_b32 s46, 3211264
buffer_load_dwordx4 v57, s[20:23], s46 offen  lds
s_add_u32 m0, s45, 24576
s_mov_b32 s46, 3473408
buffer_load_dwordx4 v57, s[20:23], s46 offen  lds
s_waitcnt vmcnt(13)
s_barrier
s_add_u32 m0, s45, 28672
s_mov_b32 s46, 4030464
buffer_load_dwordx4 v57, s[20:23], s46 offen  lds
s_add_u32 m0, s45, 32768
s_mov_b32 s46, 3735552
buffer_load_dwordx4 v57, s[20:23], s46 offen  lds
s_add_u32 m0, s45, 36864
s_mov_b32 s46, 3997696
buffer_load_dwordx4 v57, s[20:23], s46 offen  lds
s_add_u32 m0, s45, 40960
s_mov_b32 s46, 4292608
buffer_load_dwordx4 v57, s[20:23], s46 offen  lds
s_add_u32 m0, s45, 45056
s_mov_b32 s46, 4554752
buffer_load_dwordx4 v57, s[20:23], s46 offen  lds
s_add_u32 m0, s45, 49152
s_mov_b32 s46, 4259840
buffer_load_dwordx4 v57, s[20:23], s46 offen  lds
s_add_u32 m0, s45, 53248
s_mov_b32 s46, 4521984
buffer_load_dwordx4 v57, s[20:23], s46 offen  lds
s_waitcnt vmcnt(13)
s_barrier
s_add_u32 m0, s45, 57344
s_mov_b32 s46, 4816896
buffer_load_dwordx4 v57, s[20:23], s46 offen  lds
s_add_u32 m0, s45, 61440
s_mov_b32 s46, 4784128
buffer_load_dwordx4 v57, s[20:23], s46 offen  lds
s_add_u32 m0, s45, 65536
s_mov_b32 s46, 5046272
buffer_load_dwordx4 v57, s[20:23], s46 offen  lds
s_add_u32 m0, s45, 69632
s_mov_b32 s46, 5079040
buffer_load_dwordx4 v57, s[20:23], s46 offen  lds
s_add_u32 m0, s45, 73728
s_mov_b32 s46, 5341184
buffer_load_dwordx4 v57, s[20:23], s46 offen  lds
s_add_u32 m0, s45, 77824
s_mov_b32 s46, 5308416
buffer_load_dwordx4 v57, s[20:23], s46 offen  lds
s_add_u32 m0, s45, 81920
s_mov_b32 s46, 5570560
buffer_load_dwordx4 v57, s[20:23], s46 offen  lds
s_waitcnt vmcnt(13)
s_barrier
s_add_u32 m0, s45, 86016
s_mov_b32 s46, 5603328
buffer_load_dwordx4 v57, s[20:23], s46 offen  lds
s_add_u32 m0, s45, 90112
s_mov_b32 s46, 5832704
buffer_load_dwordx4 v57, s[20:23], s46 offen  lds
s_add_u32 m0, s45, 94208
s_mov_b32 s46, 6094848
buffer_load_dwordx4 v57, s[20:23], s46 offen  lds
s_add_u32 m0, s45, 98304
s_mov_b32 s46, 5865472
buffer_load_dwordx4 v57, s[20:23], s46 offen  lds
s_add_u32 m0, s45, 102400
s_mov_b32 s46, 6356992
buffer_load_dwordx4 v57, s[20:23], s46 offen  lds
s_add_u32 m0, s45, 106496
s_mov_b32 s46, 6619136
buffer_load_dwordx4 v57, s[20:23], s46 offen  lds
s_add_u32 m0, s45, 110592
s_mov_b32 s46, 6127616
buffer_load_dwordx4 v57, s[20:23], s46 offen  lds
s_waitcnt vmcnt(13)
s_barrier
s_add_u32 m0, s45, 0
s_mov_b32 s46, 6881280
buffer_load_dwordx4 v57, s[20:23], s46 offen  lds
s_add_u32 m0, s45, 4096
s_mov_b32 s46, 7143424
buffer_load_dwordx4 v57, s[20:23], s46 offen  lds
s_add_u32 m0, s45, 8192
s_mov_b32 s46, 6389760
buffer_load_dwordx4 v57, s[20:23], s46 offen  lds
s_add_u32 m0, s45, 12288
s_mov_b32 s46, 7405568
buffer_load_dwordx4 v57, s[20:23], s46 offen  lds
s_add_u32 m0, s45, 16384
s_mov_b32 s46, 7667712
buffer_load_dwordx4 v57, s[20:23], s46 offen  lds
s_add_u32 m0, s45, 20480
s_mov_b32 s46, 6651904
buffer_load_dwordx4 v57, s[20:23], s46 offen  lds
s_add_u32 m0, s45, 24576
s_mov_b32 s46, 7929856
buffer_load_dwordx4 v57, s[20:23], s46 offen  lds
s_waitcnt vmcnt(11)
s_barrier
s_add_u32 m0, s45, 28672
s_mov_b32 s46, 6914048
buffer_load_dwordx4 v57, s[20:23], s46 offen  lds
s_add_u32 m0, s45, 32768
s_mov_b32 s46, 7176192
buffer_load_dwordx4 v57, s[20:23], s46 offen  lds
s_add_u32 m0, s45, 36864
s_mov_b32 s46, 7438336
buffer_load_dwordx4 v57, s[20:23], s46 offen  lds
s_add_u32 m0, s45, 40960
s_mov_b32 s46, 7700480
buffer_load_dwordx4 v57, s[20:23], s46 offen  lds
s_add_u32 m0, s45, 45056
s_mov_b32 s46, 7962624
buffer_load_dwordx4 v57, s[20:23], s46 offen  lds
v_mov_b32 v22, 4
s_cmp_lg_u32 s32, 4
s_cbranch_scc1 L_nopoll0
global_load_dword v22, v20, s[10:11] sc1
L_nopoll0:
buffer_store_dwordx4 v[16:19], v14, s[28:31], s58 offen sc1
buffer_store_dwordx4 v[16:19], v14, s[28:31], s59 offen sc1
buffer_store_dwordx4 v[16:19], v14, s[28:31], s39 offen sc1
s_waitcnt vmcnt(10)
s_barrier
s_waitcnt vmcnt(6)
s_barrier
s_waitcnt vmcnt(0)
L_hs0:
v_readfirstlane_b32 s40, v22
s_nop 0
s_cmp_ge_u32 s40, 4
s_cbranch_scc1 L_hsok0
s_sleep 8
global_load_dword v22, v20, s[10:11] sc1
s_waitcnt vmcnt(0)
s_branch L_hs0
L_hsok0:
s_barrier
s_cmp_lg_u32 s32, 4
s_cbranch_scc1 L_nf0
v_mov_b32 v72, v68
s_cmp_eq_u32 s37, 1
s_cselect_b64 vcc, -1, 0
v_cndmask_b32 v72, v72, v69, vcc
s_cmp_eq_u32 s37, 2
s_cselect_b64 vcc, -1, 0
v_cndmask_b32 v72, v72, v70, vcc
s_cmp_eq_u32 s37, 3
s_cselect_b64 vcc, -1, 0
v_cndmask_b32 v72, v72, v71, vcc
v_add_u32 v72, 1, v72
s_lshl_b32 s40, s37, 2
s_mov_b64 exec, 1
buffer_store_dword v72, v66, s[28:31], s40 offen sc1
s_mov_b64 exec, -1
L_nf0:
s_branch L_hend
L_hg1:
s_add_u32 m0, s45, 16384
s_mov_b32 s46, 1048576
buffer_load_dwordx4 v57, s[20:23], s46 offen  lds
s_add_u32 m0, s45, 20480
s_mov_b32 s46, 1310720
buffer_load_dwordx4 v57, s[20:23], s46 offen  lds
s_add_u32 m0, s45, 24576
s_mov_b32 s46, 1572864
buffer_load_dwordx4 v57, s[20:23], s46 offen  lds
s_add_u32 m0, s45, 28672
s_mov_b32 s46, 1835008
buffer_load_dwordx4 v57, s[20:23], s46 offen  lds
s_cmp_lg_u32 s32, 7
s_cbranch_scc1 L_ng71
s_add_u32 s54, s36, 16
s_lshl_b32 s54, s54, 18
s_cmp_eq_u32 s36, 15
s_cselect_b32 s54, 0x8000, s54
s_mov_b32 exec_hi, 0
buffer_load_dword v0, v58, s[20:23], s54 offen
s_mov_b64 exec, -1
L_ng71:
s_barrier
s_add_u32 m0, s45, 32768
s_mov_b32 s46, 2097152
buffer_load_dwordx4 v57, s[20:23], s46 offen  lds
s_and_b32 s40, s36, 3
s_lshl_b32 s40, s40, 1
s_or_b32 s40, s40, s35
v_lshrrev_b32 v62, 4, v1
v_mul_u32_u24 v62, 8, v62
v_add_u32 v62, s40, v62
v_min_u32 v62, 22, v62
s_add_u32 m0, s45, 36864
s_mov_b32 s46, 2359296
buffer_load_dwordx4 v57, s[20:23], s46 offen  lds
v_add_u32 v60, 54, v62
v_cmp_le_u32 vcc, 14, v62
v_add_u32 v63, 80, v62
s_nop 0
v_cndmask_b32 v60, v60, v63, vcc
v_mul_u32_u24 v63, 2115, v60
v_lshrrev_b32 v63, 16, v63
s_add_u32 m0, s45, 40960
s_mov_b32 s46, 2621440
buffer_load_dwordx4 v57, s[20:23], s46 offen  lds
v_mul_u32_u24 v64, 31, v63
v_sub_u32 v60, v60, v64
v_lshlrev_b32 v60, 18, v60
v_lshl_add_u32 v60, v63, 15, v60
v_and_b32 v62, 7, v1
v_lshl_add_u32 v60, v62, 10, v60
v_bfe_u32 v62, v1, 3, 1
s_waitcnt vmcnt(8)
s_cmp_eq_u32 s32, 7
s_cbranch_scc1 L_w71_1
s_waitcnt vmcnt(7)
L_w71_1:
s_barrier
s_add_u32 m0, s45, 45056
s_mov_b32 s46, 2883584
buffer_load_dwordx4 v57, s[20:23], s46 offen  lds
v_lshl_add_u32 v60, v62, 9, v60
s_andn2_b32 s40, s47, 512
s_lshl_b32 s41, s42, 13
s_add_u32 s40, s40, s41
v_add_u32 v60, s40, v60
v_mov_b32 v16, -1
v_mov_b32 v17, -1
s_waitcnt vmcnt(5)
s_cmp_eq_u32 s32, 7
s_cbranch_scc1 L_w71_2
s_waitcnt vmcnt(4)
L_w71_2:
s_barrier
s_add_u32 m0, s45, 49152
s_mov_b32 s46, 3145728
buffer_load_dwordx4 v57, s[20:23], s46 offen  lds
v_mov_b32 v18, -1
v_mov_b32 v19, -1
s_xor_b32 s58, s37, 2
s_mul_i32 s58, s58, 12288
s_add_u32 s58, s58, 0
s_add_u32 s58, s58, s44
s_xor_b32 s59, s37, 3
s_add_u32 m0, s45, 53248
s_mov_b32 s46, 3407872
buffer_load_dwordx4 v57, s[20:23], s46 offen  lds
s_mul_i32 s59, s59, 12288
s_add_u32 s59, s59, 4096
s_add_u32 s59, s59, s44
s_xor_b32 s39, s37, 1
s_mul_i32 s39, s39, 12288
s_add_u32 s39, s39, 8192
s_add_u32 s39, s39, s44
s_add_u32 m0, s45, 57344
s_mov_b32 s46, 3670016
buffer_load_dwordx4 v57, s[20:23], s46 offen  lds
s_lshl_b32 s40, s38, 2
v_mov_b32 v20, s40
v_mov_b32 v21, 1
s_mul_i32 s40, s38, 49408
s_add_u32 s40, s40, 49152
v_mov_b32 v66, s40
s_mov_b32 s28, s12
s_add_u32 m0, s45, 61440
s_mov_b32 s46, 3932160
buffer_load_dwordx4 v57, s[20:23], s46 offen  lds
s_mov_b32 s29, s13
s_mov_b32 s30, 0x10000000
s_mov_b32 s31, 0x20000
s_add_u32 m0, s45, 65536
s_mov_b32 s46, 4194304
buffer_load_dwordx4 v57, s[20:23], s46 offen  lds
s_add_u32 m0, s45, 69632
s_mov_b32 s46, 4456448
buffer_load_dwordx4 v57, s[20:23], s46 offen  lds
s_add_u32 m0, s45, 73728
s_mov_b32 s46, 4718592
buffer_load_dwordx4 v57, s[20:23], s46 offen  lds
s_waitcnt vmcnt(7)
s_barrier
s_add_u32 m0, s45, 77824
s_mov_b32 s46, 4980736
buffer_load_dwordx4 v57, s[20:23], s46 offen  lds
s_add_u32 m0, s45, 81920
s_mov_b32 s46, 5242880
buffer_load_dwordx4 v57, s[20:23], s46 offen  lds
s_add_u32 m0, s45, 86016
s_mov_b32 s46, 5505024
buffer_load_dwordx4 v57, s[20:23], s46 offen  lds
s_add_u32 m0, s45, 90112
s_mov_b32 s46, 5767168
buffer_load_dwordx4 v57, s[20:23], s46 offen  lds
s_add_u32 m0, s45, 94208
s_mov_b32 s46, 6029312
buffer_load_dwordx4 v57, s[20:23], s46 offen  lds
s_add_u32 m0, s45, 98304
s_mov_b32 s46, 6291456
buffer_load_dwordx4 v57, s[20:23], s46 offen  lds
s_add_u32 m0, s45, 102400
s_mov_b32 s46, 6553600
buffer_load_dwordx4 v57, s[20:23], s46 offen  lds
s_waitcnt vmcnt(10)
s_barrier
s_add_u32 m0, s45, 106496
s_mov_b32 s46, 6815744
buffer_load_dwordx4 v57, s[20:23], s46 offen  lds
s_add_u32 m0, s45, 110592
s_mov_b32 s46, 7077888
buffer_load_dwordx4 v57, s[20:23], s46 offen  lds
s_add_u32 m0, s45, 0
s_mov_b32 s46, 7340032
buffer_load_dwordx4 v57, s[20:23], s46 offen  lds
s_add_u32 m0, s45, 4096
s_mov_b32 s46, 7602176
buffer_load_dwordx4 v57, s[20:23], s46 offen  lds
buffer_load_dwordx4 v[68:71], v66, s[28:31], 0 offen sc1
v_add_u32 v48, 128, v56
v_add_u32 v49, 65664, v56
v_add_u32 v50, 131200, v56
s_add_u32 m0, s43, 20480
s_nop 0
buffer_load_dwordx4 v48, s[16:19], 0 offen lds
s_add_u32 m0, s43, 21504
s_nop 0
buffer_load_dwordx4 v49, s[16:19], 0 offen lds
s_add_u32 m0, s43, 22528
s_mov_b32 exec_hi, 0
buffer_load_dwordx4 v50, s[16:19], 0 offen lds
s_mov_b64 exec, -1
s_waitcnt vmcnt(14)
s_barrier
s_add_u32 m0, s45, 8192
s_mov_b32 s46, 7864320
buffer_load_dwordx4 v57, s[20:23], s46 offen  lds
s_add_u32 m0, s45, 12288
s_mov_b32 s46, 32768
buffer_load_dwordx4 v57, s[20:23], s46 offen  lds
v_add_u32 v48, 4224, v56
v_add_u32 v49, 69760, v56
v_add_u32 v50, 135296, v56
s_add_u32 m0, s43, 30720
s_nop 0
buffer_load_dwordx4 v48, s[16:19], 0 offen lds
s_add_u32 m0, s43, 31744
s_nop 0
buffer_load_dwordx4 v49, s[16:19], 0 offen lds
s_add_u32 m0, s43, 32768
s_mov_b32 exec_hi, 0
buffer_load_dwordx4 v50, s[16:19], 0 offen lds
s_mov_b64 exec, -1
s_waitcnt vmcnt(15)
s_barrier
s_add_u32 m0, s45, 16384
s_mov_b32 s46, 294912
buffer_load_dwordx4 v57, s[20:23], s46 offen  lds
s_add_u32 m0, s45, 20480
s_mov_b32 s46, 557056
buffer_load_dwordx4 v57, s[20:23], s46 offen  lds
s_add_u32 m0, s45, 24576
s_mov_b32 s46, 819200
buffer_load_dwordx4 v57, s[20:23], s46 offen  lds
s_add_u32 m0, s45, 28672
s_mov_b32 s46, 1081344
buffer_load_dwordx4 v57, s[20:23], s46 offen  lds
s_add_u32 m0, s45, 32768
s_mov_b32 s46, 1343488
buffer_load_dwordx4 v57, s[20:23], s46 offen  lds
s_add_u32 m0, s45, 36864
s_mov_b32 s46, 1605632
buffer_load_dwordx4 v57, s[20:23], s46 offen  lds
s_waitcnt vmcnt(14)
s_barrier
s_add_u32 m0, s45, 40960
s_mov_b32 s46, 1867776
buffer_load_dwordx4 v57, s[20:23], s46 offen  lds
s_add_u32 m0, s45, 45056
s_mov_b32 s46, 2129920
buffer_load_dwordx4 v57, s[20:23], s46 offen  lds
s_add_u32 m0, s45, 49152
s_mov_b32 s46, 2392064
buffer_load_dwordx4 v57, s[20:23], s46 offen  lds
s_add_u32 m0, s45, 53248
s_mov_b32 s46, 2654208
buffer_load_dwordx4 v57, s[20:23], s46 offen  lds
s_add_u32 m0, s45, 57344
s_mov_b32 s46, 2916352
buffer_load_dwordx4 v57, s[20:23], s46 offen  lds
s_add_u32 m0, s45, 61440
s_mov_b32 s46, 3178496
buffer_load_dwordx4 v57, s[20:23], s46 offen  lds
s_add_u32 m0, s45, 65536
s_mov_b32 s46, 3440640
buffer_load_dwordx4 v57, s[20:23], s46 offen  lds
s_mov_b32 exec_hi, 65535
buffer_load_dword v61, v60, s[20:23], 0 offen
s_mov_b64 exec, -1
s_cmp_lg_u32 s32, 4
s_cbranch_scc1 L_nosig1
s_mov_b64 exec, 1
global_atomic_add v20, v21, s[10:11] sc1
s_mov_b64 exec, -1
L_nosig1:
s_waitcnt vmcnt(17)
s_barrier
s_add_u32 m0, s45, 69632
s_mov_b32 s46, 3702784
buffer_load_dwordx4 v57, s[20:23], s46 offen  lds
s_cmp_lg_u32 s32, 4
s_cbranch_scc1 L_wk1_0
s_cmp_eq_u32 0, 0
s_call_b64 s[50:51], L_pgc_0
L_wk1_0:
s_cmp_lg_u32 s32, 5
s_cbranch_scc1 L_wk1_1
s_cmp_eq_u32 0, 0
s_call_b64 s[50:51], L_pgc_1
L_wk1_1:
s_cmp_lg_u32 s32, 6
s_cbranch_scc1 L_wk1_2
s_cmp_lg_u32 s37, 0
s_cbranch_scc1 L_wq1_3
s_cmp_eq_u32 0, 0
s_call_b64 s[50:51], L_pg0_0
L_wq1_3:
s_cmp_lg_u32 s37, 1
s_cbranch_scc1 L_wq1_4
s_cmp_eq_u32 0, 0
s_call_b64 s[50:51], L_pg1_0
L_wq1_4:
s_cmp_lg_u32 s37, 2
s_cbranch_scc1 L_wq1_5
s_cmp_eq_u32 0, 0
s_call_b64 s[50:51], L_pg2_0
L_wq1_5:
s_cmp_lg_u32 s37, 2
s_cbranch_scc1 L_wq1_6
s_cmp_eq_u32 0, 0
s_call_b64 s[50:51], L_pg2_1
L_wq1_6:
s_cmp_lg_u32 s37, 3
s_cbranch_scc1 L_wq1_7
s_cmp_eq_u32 0, 0
s_call_b64 s[50:51], L_pg3_0
L_wq1_7:
L_wk1_2:
s_cmp_lg_u32 s32, 7
s_cbranch_scc1 L_wk1_3
s_cmp_lg_u32 s37, 1
s_cbranch_scc1 L_wq1_8
s_cmp_eq_u32 0, 0
s_call_b64 s[50:51], L_warm1
L_wq1_8:
s_cmp_lg_u32 s37, 2
s_cbranch_scc1 L_wq1_9
s_cmp_eq_u32 0, 0
s_call_b64 s[50:51], L_warm2
L_wq1_9:
s_cmp_lg_u32 s37, 3
s_cbranch_scc1 L_wq1_10
s_cmp_eq_u32 0, 0
s_call_b64 s[50:51], L_warm3
L_wq1_10:
L_wk1_3:
s_waitcnt vmcnt(11)
s_barrier
s_add_u32 m0, s45, 73728
s_mov_b32 s46, 3964928
buffer_load_dwordx4 v57, s[20:23], s46 offen  lds
s_waitcnt vmcnt(8)
s_barrier
s_add_u32 m0, s45, 77824
s_mov_b32 s46, 4227072
buffer_load_dwordx4 v57, s[20:23], s46 offen  lds
s_add_u32 m0, s45, 81920
s_mov_b32 s46, 4489216
buffer_load_dwordx4 v57, s[20:23], s46 offen  lds
s_add_u32 m0, s45, 86016
s_mov_b32 s46, 4751360
buffer_load_dwordx4 v57, s[20:23], s46 offen  lds
s_add_u32 m0, s45, 90112
s_mov_b32 s46, 5013504
buffer_load_dwordx4 v57, s[20:23], s46 offen  lds
s_add_u32 m0, s45, 94208
s_mov_b32 s46, 5275648
buffer_load_dwordx4 v57, s[20:23], s46 offen  lds
s_add_u32 m0, s45, 98304
s_mov_b32 s46, 5537792
buffer_load_dwordx4 v57, s[20:23], s46 offen  lds
s_waitcnt vmcnt(10)
s_barrier
s_add_u32 m0, s45, 102400
s_mov_b32 s46, 5799936
buffer_load_dwordx4 v57, s[20:23], s46 offen  lds
s_add_u32 m0, s45, 106496
s_mov_b32 s46, 98304
buffer_load_dwordx4 v57, s[20:23], s46 offen  lds
s_add_u32 m0, s45, 110592
s_mov_b32 s46, 6062080
buffer_load_dwordx4 v57, s[20:23], s46 offen  lds
s_add_u32 m0, s45, 0
s_mov_b32 s46, 6324224
buffer_load_dwordx4 v57, s[20:23], s46 offen  lds
s_add_u32 m0, s45, 4096
s_mov_b32 s46, 360448
buffer_load_dwordx4 v57, s[20:23], s46 offen  lds
s_add_u32 m0, s45, 8192
s_mov_b32 s46, 6586368
buffer_load_dwordx4 v57, s[20:23], s46 offen  lds
s_add_u32 m0, s45, 12288
s_mov_b32 s46, 6848512
buffer_load_dwordx4 v57, s[20:23], s46 offen  lds
s_waitcnt vmcnt(12)
s_barrier
s_add_u32 m0, s45, 16384
s_mov_b32 s46, 622592
buffer_load_dwordx4 v57, s[20:23], s46 offen  lds
s_add_u32 m0, s45, 20480
s_mov_b32 s46, 884736
buffer_load_dwordx4 v57, s[20:23], s46 offen  lds
s_add_u32 m0, s45, 24576
s_mov_b32 s46, 7110656
buffer_load_dwordx4 v57, s[20:23], s46 offen  lds
s_add_u32 m0, s45, 28672
s_mov_b32 s46, 7372800
buffer_load_dwordx4 v57, s[20:23], s46 offen  lds
s_add_u32 m0, s45, 32768
s_mov_b32 s46, 1146880
buffer_load_dwordx4 v57, s[20:23], s46 offen  lds
s_add_u32 m0, s45, 36864
s_mov_b32 s46, 7634944
buffer_load_dwordx4 v57, s[20:23], s46 offen  lds
s_add_u32 m0, s45, 40960
s_mov_b32 s46, 7897088
buffer_load_dwordx4 v57, s[20:23], s46 offen  lds
s_waitcnt vmcnt(15)
s_barrier
s_add_u32 m0, s45, 45056
s_mov_b32 s46, 1409024
buffer_load_dwordx4 v57, s[20:23], s46 offen  lds
s_add_u32 m0, s45, 49152
s_mov_b32 s46, 65536
buffer_load_dwordx4 v57, s[20:23], s46 offen  lds
s_add_u32 m0, s45, 53248
s_mov_b32 s46, 327680
buffer_load_dwordx4 v57, s[20:23], s46 offen  lds
s_add_u32 m0, s45, 57344
s_mov_b32 s46, 1671168
buffer_load_dwordx4 v57, s[20:23], s46 offen  lds
s_add_u32 m0, s45, 61440
s_mov_b32 s46, 1933312
buffer_load_dwordx4 v57, s[20:23], s46 offen  lds
s_add_u32 m0, s45, 65536
s_mov_b32 s46, 589824
buffer_load_dwordx4 v57, s[20:23], s46 offen  lds
s_add_u32 m0, s45, 69632
s_mov_b32 s46, 851968
buffer_load_dwordx4 v57, s[20:23], s46 offen  lds
s_waitcnt vmcnt(16)
s_barrier
s_add_u32 m0, s45, 73728
s_mov_b32 s46, 2195456
buffer_load_dwordx4 v57, s[20:23], s46 offen  lds
s_add_u32 m0, s45, 77824
s_mov_b32 s46, 1114112
buffer_load_dwordx4 v57, s[20:23], s46 offen  lds
s_add_u32 m0, s45, 81920
s_mov_b32 s46, 1376256
buffer_load_dwordx4 v57, s[20:23], s46 offen  lds
s_add_u32 m0, s45, 86016
s_mov_b32 s46, 2457600
buffer_load_dwordx4 v57, s[20:23], s46 offen  lds
s_add_u32 m0, s45, 90112
s_mov_b32 s46, 2719744
buffer_load_dwordx4 v57, s[20:23], s46 offen  lds
s_add_u32 m0, s45, 94208
s_mov_b32 s46, 1638400
buffer_load_dwordx4 v57, s[20:23], s46 offen  lds
s_waitcnt vmcnt(15)
s_barrier
s_add_u32 m0, s45, 98304
s_mov_b32 s46, 1900544
buffer_load_dwordx4 v57, s[20:23], s46 offen  lds
s_add_u32 m0, s45, 102400
s_mov_b32 s46, 2981888
buffer_load_dwordx4 v57, s[20:23], s46 offen  lds
s_add_u32 m0, s45, 106496
s_mov_b32 s46, 2162688
buffer_load_dwordx4 v57, s[20:23], s46 offen  lds
s_add_u32 m0, s45, 110592
s_mov_b32 s46, 2424832
buffer_load_dwordx4 v57, s[20:23], s46 offen  lds
s_add_u32 m0, s45, 0
s_mov_b32 s46, 3244032
buffer_load_dwordx4 v57, s[20:23], s46 offen  lds
s_waitcnt vmcnt(13)
s_barrier
s_add_u32 m0, s45, 4096
s_mov_b32 s46, 3506176
buffer_load_dwordx4 v57, s[20:23], s46 offen  lds
s_add_u32 m0, s45, 8192
s_mov_b32 s46, 2686976
buffer_load_dwordx4 v57, s[20:23], s46 offen  lds
s_add_u32 m0, s45, 12288
s_mov_b32 s46, 2949120
buffer_load_dwordx4 v57, s[20:23], s46 offen  lds
s_add_u32 m0, s45, 16384
s_mov_b32 s46, 3768320
buffer_load_dwordx4 v57, s[20:23], s46 offen  lds
s_add_u32 m0, s45, 20480
s_mov_b32 s46, 3211264
buffer_load_dwordx4 v57, s[20:23], s46 offen  lds
s_add_u32 m0, s45, 24576
s_mov_b32 s46, 3473408
buffer_load_dwordx4 v57, s[20:23], s46 offen  lds
s_waitcnt vmcnt(13)
s_barrier
s_add_u32 m0, s45, 28672
s_mov_b32 s46, 4030464
buffer_load_dwordx4 v57, s[20:23], s46 offen  lds
s_add_u32 m0, s45, 32768
s_mov_b32 s46, 3735552
buffer_load_dwordx4 v57, s[20:23], s46 offen  lds
s_add_u32 m0, s45, 36864
s_mov_b32 s46, 3997696
buffer_load_dwordx4 v57, s[20:23], s46 offen  lds
s_add_u32 m0, s45, 40960
s_mov_b32 s46, 4292608
buffer_load_dwordx4 v57, s[20:23], s46 offen  lds
s_add_u32 m0, s45, 45056
s_mov_b32 s46, 4554752
buffer_load_dwordx4 v57, s[20:23], s46 offen  lds
s_add_u32 m0, s45, 49152
s_mov_b32 s46, 4259840
buffer_load_dwordx4 v57, s[20:23], s46 offen  lds
s_add_u32 m0, s45, 53248
s_mov_b32 s46, 4521984
buffer_load_dwordx4 v57, s[20:23], s46 offen  lds
s_waitcnt vmcnt(13)
s_barrier
s_add_u32 m0, s45, 57344
s_mov_b32 s46, 4816896
buffer_load_dwordx4 v57, s[20:23], s46 offen  lds
s_add_u32 m0, s45, 61440
s_mov_b32 s46, 4784128
buffer_load_dwordx4 v57, s[20:23], s46 offen  lds
s_add_u32 m0, s45, 65536
s_mov_b32 s46, 5046272
buffer_load_dwordx4 v57, s[20:23], s46 offen  lds
s_add_u32 m0, s45, 69632
s_mov_b32 s46, 5079040
buffer_load_dwordx4 v57, s[20:23], s46 offen  lds
s_add_u32 m0, s45, 73728
s_mov_b32 s46, 5341184
buffer_load_dwordx4 v57, s[20:23], s46 offen  lds
s_add_u32 m0, s45, 77824
s_mov_b32 s46, 5308416
buffer_load_dwordx4 v57, s[20:23], s46 offen  lds
s_add_u32 m0, s45, 81920
s_mov_b32 s46, 5570560
buffer_load_dwordx4 v57, s[20:23], s46 offen  lds
s_waitcnt vmcnt(13)
s_barrier
s_add_u32 m0, s45, 86016
s_mov_b32 s46, 5603328
buffer_load_dwordx4 v57, s[20:23], s46 offen  lds
s_add_u32 m0, s45, 90112
s_mov_b32 s46, 5832704
buffer_load_dwordx4 v57, s[20:23], s46 offen  lds
s_add_u32 m0, s45, 94208
s_mov_b32 s46, 6094848
buffer_load_dwordx4 v57, s[20:23], s46 offen  lds
s_add_u32 m0, s45, 98304
s_mov_b32 s46, 5865472
buffer_load_dwordx4 v57, s[20:23], s46 offen  lds
s_add_u32 m0, s45, 102400
s_mov_b32 s46, 6356992
buffer_load_dwordx4 v57, s[20:23], s46 offen  lds
s_add_u32 m0, s45, 106496
s_mov_b32 s46, 6619136
buffer_load_dwordx4 v57, s[20:23], s46 offen  lds
s_add_u32 m0, s45, 110592
s_mov_b32 s46, 6127616
buffer_load_dwordx4 v57, s[20:23], s46 offen  lds
s_waitcnt vmcnt(13)
s_barrier
s_add_u32 m0, s45, 0
s_mov_b32 s46, 6881280
buffer_load_dwordx4 v57, s[20:23], s46 offen  lds
s_add_u32 m0, s45, 4096
s_mov_b32 s46, 7143424
buffer_load_dwordx4 v57, s[20:23], s46 offen  lds
s_add_u32 m0, s45, 8192
s_mov_b32 s46, 6389760
buffer_load_dwordx4 v57, s[20:23], s46 offen  lds
s_add_u32 m0, s45, 12288
s_mov_b32 s46, 7405568
buffer_load_dwordx4 v57, s[20:23], s46 offen  lds
s_add_u32 m0, s45, 16384
s_mov_b32 s46, 7667712
buffer_load_dwordx4 v57, s[20:23], s46 offen  lds
s_add_u32 m0, s45, 20480
s_mov_b32 s46, 6651904
buffer_load_dwordx4 v57, s[20:23], s46 offen  lds
s_add_u32 m0, s45, 24576
s_mov_b32 s46, 7929856
buffer_load_dwordx4 v57, s[20:23], s46 offen  lds
s_waitcnt vmcnt(11)
s_barrier
s_add_u32 m0, s45, 28672
s_mov_b32 s46, 6914048
buffer_load_dwordx4 v57, s[20:23], s46 offen  lds
s_add_u32 m0, s45, 32768
s_mov_b32 s46, 7176192
buffer_load_dwordx4 v57, s[20:23], s46 offen  lds
s_add_u32 m0, s45, 36864
s_mov_b32 s46, 7438336
buffer_load_dwordx4 v57, s[20:23], s46 offen  lds
s_add_u32 m0, s45, 40960
s_mov_b32 s46, 7700480
buffer_load_dwordx4 v57, s[20:23], s46 offen  lds
s_add_u32 m0, s45, 45056
s_mov_b32 s46, 7962624
buffer_load_dwordx4 v57, s[20:23], s46 offen  lds
v_mov_b32 v22, 4
s_cmp_lg_u32 s32, 4
s_cbranch_scc1 L_nopoll1
global_load_dword v22, v20, s[10:11] sc1
L_nopoll1:
buffer_store_dwordx4 v[16:19], v14, s[28:31], s58 offen sc1
buffer_store_dwordx4 v[16:19], v14, s[28:31], s59 offen sc1
buffer_store_dwordx4 v[16:19], v14, s[28:31], s39 offen sc1
s_waitcnt vmcnt(10)
s_barrier
s_waitcnt vmcnt(6)
s_barrier
s_waitcnt vmcnt(0)
L_hs1:
v_readfirstlane_b32 s40, v22
s_nop 0
s_cmp_ge_u32 s40, 4
s_cbranch_scc1 L_hsok1
s_sleep 8
global_load_dword v22, v20, s[10:11] sc1
s_waitcnt vmcnt(0)
s_branch L_hs1
L_hsok1:
s_barrier
s_cmp_lg_u32 s32, 4
s_cbranch_scc1 L_nf1
v_mov_b32 v72, v68
s_cmp_eq_u32 s37, 1
s_cselect_b64 vcc, -1, 0
v_cndmask_b32 v72, v72, v69, vcc
s_cmp_eq_u32 s37, 2
s_cselect_b64 vcc, -1, 0
v_cndmask_b32 v72, v72, v70, vcc
s_cmp_eq_u32 s37, 3
s_cselect_b64 vcc, -1, 0
v_cndmask_b32 v72, v72, v71, vcc
v_add_u32 v72, 1, v72
s_lshl_b32 s40, s37, 2
s_mov_b64 exec, 1
buffer_store_dword v72, v66, s[28:31], s40 offen sc1
s_mov_b64 exec, -1
L_nf1:
s_branch L_hend
L_hg2:
s_add_u32 m0, s45, 16384
s_mov_b32 s46, 1048576
buffer_load_dwordx4 v57, s[20:23], s46 offen  lds
s_add_u32 m0, s45, 20480
s_mov_b32 s46, 1310720
buffer_load_dwordx4 v57, s[20:23], s46 offen  lds
s_add_u32 m0, s45, 24576
s_mov_b32 s46, 1572864
buffer_load_dwordx4 v57, s[20:23], s46 offen  lds
s_add_u32 m0, s45, 28672
s_mov_b32 s46, 1835008
buffer_load_dwordx4 v57, s[20:23], s46 offen  lds
s_cmp_lg_u32 s32, 7
s_cbranch_scc1 L_ng72
s_add_u32 s54, s36, 16
s_lshl_b32 s54, s54, 18
s_cmp_eq_u32 s36, 15
s_cselect_b32 s54, 0x8000, s54
s_mov_b32 exec_hi, 0
buffer_load_dword v0, v58, s[20:23], s54 offen
s_mov_b64 exec, -1
L_ng72:
s_barrier
s_add_u32 m0, s45, 32768
s_mov_b32 s46, 2097152
buffer_load_dwordx4 v57, s[20:23], s46 offen  lds
s_and_b32 s40, s36, 3
s_lshl_b32 s40, s40, 1
s_or_b32 s40, s40, s35
v_lshrrev_b32 v62, 4, v1
v_mul_u32_u24 v62, 8, v62
v_add_u32 v62, s40, v62
v_min_u32 v62, 22, v62
s_add_u32 m0, s45, 36864
s_mov_b32 s46, 2359296
buffer_load_dwordx4 v57, s[20:23], s46 offen  lds
v_add_u32 v60, 68, v62
v_cmp_le_u32 vcc, 14, v62
v_add_u32 v63, 89, v62
s_nop 0
v_cndmask_b32 v60, v60, v63, vcc
v_mul_u32_u24 v63, 2115, v60
v_lshrrev_b32 v63, 16, v63
s_add_u32 m0, s45, 40960
s_mov_b32 s46, 2621440
buffer_load_dwordx4 v57, s[20:23], s46 offen  lds
v_mul_u32_u24 v64, 31, v63
v_sub_u32 v60, v60, v64
v_lshlrev_b32 v60, 18, v60
v_lshl_add_u32 v60, v63, 15, v60
v_and_b32 v62, 7, v1
v_lshl_add_u32 v60, v62, 10, v60
v_bfe_u32 v62, v1, 3, 1
s_waitcnt vmcnt(8)
s_cmp_eq_u32 s32, 7
s_cbranch_scc1 L_w72_1
s_waitcnt vmcnt(7)
L_w72_1:
s_barrier
s_add_u32 m0, s45, 45056
s_mov_b32 s46, 2883584
buffer_load_dwordx4 v57, s[20:23], s46 offen  lds
v_lshl_add_u32 v60, v62, 9, v60
s_andn2_b32 s40, s47, 512
s_lshl_b32 s41, s42, 13
s_add_u32 s40, s40, s41
v_add_u32 v60, s40, v60
v_mov_b32 v16, -1
v_mov_b32 v17, -1
s_waitcnt vmcnt(5)
s_cmp_eq_u32 s32, 7
s_cbranch_scc1 L_w72_2
s_waitcnt vmcnt(4)
L_w72_2:
s_barrier
s_add_u32 m0, s45, 49152
s_mov_b32 s46, 3145728
buffer_load_dwordx4 v57, s[20:23], s46 offen  lds
v_mov_b32 v18, -1
v_mov_b32 v19, -1
s_xor_b32 s58, s37, 2
s_mul_i32 s58, s58, 12288
s_add_u32 s58, s58, 0
s_add_u32 s58, s58, s44
s_xor_b32 s59, s37, 3
s_add_u32 m0, s45, 53248
s_mov_b32 s46, 3407872
buffer_load_dwordx4 v57, s[20:23], s46 offen  lds
s_mul_i32 s59, s59, 12288
s_add_u32 s59, s59, 4096
s_add_u32 s59, s59, s44
s_xor_b32 s39, s37, 1
s_mul_i32 s39, s39, 12288
s_add_u32 s39, s39, 8192
s_add_u32 s39, s39, s44
s_add_u32 m0, s45, 57344
s_mov_b32 s46, 3670016
buffer_load_dwordx4 v57, s[20:23], s46 offen  lds
s_lshl_b32 s40, s38, 2
v_mov_b32 v20, s40
v_mov_b32 v21, 1
s_mul_i32 s40, s38, 49408
s_add_u32 s40, s40, 49152
v_mov_b32 v66, s40
s_mov_b32 s28, s12
s_add_u32 m0, s45, 61440
s_mov_b32 s46, 3932160
buffer_load_dwordx4 v57, s[20:23], s46 offen  lds
s_mov_b32 s29, s13
s_mov_b32 s30, 0x10000000
s_mov_b32 s31, 0x20000
s_add_u32 m0, s45, 65536
s_mov_b32 s46, 4194304
buffer_load_dwordx4 v57, s[20:23], s46 offen  lds
s_add_u32 m0, s45, 69632
s_mov_b32 s46, 4456448
buffer_load_dwordx4 v57, s[20:23], s46 offen  lds
s_add_u32 m0, s45, 73728
s_mov_b32 s46, 4718592
buffer_load_dwordx4 v57, s[20:23], s46 offen  lds
s_waitcnt vmcnt(7)
s_barrier
s_add_u32 m0, s45, 77824
s_mov_b32 s46, 4980736
buffer_load_dwordx4 v57, s[20:23], s46 offen  lds
s_add_u32 m0, s45, 81920
s_mov_b32 s46, 5242880
buffer_load_dwordx4 v57, s[20:23], s46 offen  lds
s_add_u32 m0, s45, 86016
s_mov_b32 s46, 5505024
buffer_load_dwordx4 v57, s[20:23], s46 offen  lds
s_add_u32 m0, s45, 90112
s_mov_b32 s46, 5767168
buffer_load_dwordx4 v57, s[20:23], s46 offen  lds
s_add_u32 m0, s45, 94208
s_mov_b32 s46, 6029312
buffer_load_dwordx4 v57, s[20:23], s46 offen  lds
s_add_u32 m0, s45, 98304
s_mov_b32 s46, 6291456
buffer_load_dwordx4 v57, s[20:23], s46 offen  lds
s_add_u32 m0, s45, 102400
s_mov_b32 s46, 6553600
buffer_load_dwordx4 v57, s[20:23], s46 offen  lds
s_waitcnt vmcnt(10)
s_barrier
s_add_u32 m0, s45, 106496
s_mov_b32 s46, 6815744
buffer_load_dwordx4 v57, s[20:23], s46 offen  lds
s_add_u32 m0, s45, 110592
s_mov_b32 s46, 7077888
buffer_load_dwordx4 v57, s[20:23], s46 offen  lds
s_add_u32 m0, s45, 0
s_mov_b32 s46, 7340032
buffer_load_dwordx4 v57, s[20:23], s46 offen  lds
s_add_u32 m0, s45, 4096
s_mov_b32 s46, 7602176
buffer_load_dwordx4 v57, s[20:23], s46 offen  lds
s_add_u32 m0, s45, 8192
s_mov_b32 s46, 7864320
buffer_load_dwordx4 v57, s[20:23], s46 offen  lds
s_add_u32 m0, s45, 12288
s_mov_b32 s46, 32768
buffer_load_dwordx4 v57, s[20:23], s46 offen  lds
s_waitcnt vmcnt(12)
s_barrier
s_cmp_lg_u32 s32, 4
s_cbranch_scc1 L_wk2_0
s_cmp_eq_u32 0, 0
s_call_b64 s[50:51], L_pgc_0
L_wk2_0:
s_cmp_lg_u32 s32, 5
s_cbranch_scc1 L_wk2_1
s_cmp_eq_u32 0, 0
s_call_b64 s[50:51], L_pgc_1
L_wk2_1:
s_cmp_lg_u32 s32, 6
s_cbranch_scc1 L_wk2_2
s_cmp_lg_u32 s37, 0
s_cbranch_scc1 L_wq2_3
s_cmp_eq_u32 0, 0
s_call_b64 s[50:51], L_pg0_0
L_wq2_3:
s_cmp_lg_u32 s37, 1
s_cbranch_scc1 L_wq2_4
s_cmp_eq_u32 0, 0
s_call_b64 s[50:51], L_pg1_0
L_wq2_4:
s_cmp_lg_u32 s37, 2
s_cbranch_scc1 L_wq2_5
s_cmp_eq_u32 0, 0
s_call_b64 s[50:51], L_pg2_0
L_wq2_5:
s_cmp_lg_u32 s37, 2
s_cbranch_scc1 L_wq2_6
s_cmp_eq_u32 0, 0
s_call_b64 s[50:51], L_pg2_1
L_wq2_6:
s_cmp_lg_u32 s37, 3
s_cbranch_scc1 L_wq2_7
s_cmp_eq_u32 0, 0
s_call_b64 s[50:51], L_pg3_0
L_wq2_7:
L_wk2_2:
s_cmp_lg_u32 s32, 7
s_cbranch_scc1 L_wk2_3
s_cmp_lg_u32 s37, 1
s_cbranch_scc1 L_wq2_8
s_cmp_eq_u32 0, 0
s_call_b64 s[50:51], L_warm1
L_wq2_8:
s_cmp_lg_u32 s37, 2
s_cbranch_scc1 L_wq2_9
s_cmp_eq_u32 0, 0
s_call_b64 s[50:51], L_warm2
L_wq2_9:
s_cmp_lg_u32 s37, 3
s_cbranch_scc1 L_wq2_10
s_cmp_eq_u32 0, 0
s_call_b64 s[50:51], L_warm3
L_wq2_10:
L_wk2_3:
buffer_load_dwordx4 v[68:71], v66, s[28:31], 0 offen sc1
v_add_u32 v48, 128, v56
v_add_u32 v49, 65664, v56
v_add_u32 v50, 131200, v56
s_add_u32 m0, s43, 20480
s_nop 0
buffer_load_dwordx4 v48, s[16:19], 0 offen lds
s_add_u32 m0, s43, 21504
s_nop 0
buffer_load_dwordx4 v49, s[16:19], 0 offen lds
s_add_u32 m0, s43, 22528
s_mov_b32 exec_hi, 0
buffer_load_dwordx4 v50, s[16:19], 0 offen lds
s_mov_b64 exec, -1
s_waitcnt vmcnt(12)
s_barrier
s_add_u32 m0, s45, 16384
s_mov_b32 s46, 294912
buffer_load_dwordx4 v57, s[20:23], s46 offen  lds
s_add_u32 m0, s45, 20480
s_mov_b32 s46, 557056
buffer_load_dwordx4 v57, s[20:23], s46 offen  lds
s_add_u32 m0, s45, 24576
s_mov_b32 s46, 819200
buffer_load_dwordx4 v57, s[20:23], s46 offen  lds
s_add_u32 m0, s45, 28672
s_mov_b32 s46, 1081344
buffer_load_dwordx4 v57, s[20:23], s46 offen  lds
v_add_u32 v48, 4224, v56
v_add_u32 v49, 69760, v56
v_add_u32 v50, 135296, v56
s_add_u32 m0, s43, 30720
s_nop 0
buffer_load_dwordx4 v48, s[16:19], 0 offen lds
s_add_u32 m0, s43, 31744
s_nop 0
buffer_load_dwordx4 v49, s[16:19], 0 offen lds
s_add_u32 m0, s43, 32768
s_mov_b32 exec_hi, 0
buffer_load_dwordx4 v50, s[16:19], 0 offen lds
s_mov_b64 exec, -1
s_waitcnt vmcnt(15)
s_barrier
s_add_u32 m0, s45, 32768
s_mov_b32 s46, 1343488
buffer_load_dwordx4 v57, s[20:23], s46 offen  lds
s_add_u32 m0, s45, 36864
s_mov_b32 s46, 1605632
buffer_load_dwordx4 v57, s[20:23], s46 offen  lds
s_add_u32 m0, s45, 40960
s_mov_b32 s46, 1867776
buffer_load_dwordx4 v57, s[20:23], s46 offen  lds
s_add_u32 m0, s45, 45056
s_mov_b32 s46, 2129920
buffer_load_dwordx4 v57, s[20:23], s46 offen  lds
s_add_u32 m0, s45, 49152
s_mov_b32 s46, 2392064
buffer_load_dwordx4 v57, s[20:23], s46 offen  lds
s_add_u32 m0, s45, 53248
s_mov_b32 s46, 2654208
buffer_load_dwordx4 v57, s[20:23], s46 offen  lds
s_add_u32 m0, s45, 57344
s_mov_b32 s46, 2916352
buffer_load_dwordx4 v57, s[20:23], s46 offen  lds
s_waitcnt vmcnt(18)
s_barrier
s_add_u32 m0, s45, 61440
s_mov_b32 s46, 3178496
buffer_load_dwordx4 v57, s[20:23], s46 offen  lds
s_add_u32 m0, s45, 65536
s_mov_b32 s46, 3440640
buffer_load_dwordx4 v57, s[20:23], s46 offen  lds
s_add_u32 m0, s45, 69632
s_mov_b32 s46, 3702784
buffer_load_dwordx4 v57, s[20:23], s46 offen  lds
s_add_u32 m0, s45, 73728
s_mov_b32 s46, 3964928
buffer_load_dwordx4 v57, s[20:23], s46 offen  lds
s_add_u32 m0, s45, 77824
s_mov_b32 s46, 4227072
buffer_load_dwordx4 v57, s[20:23], s46 offen  lds
s_add_u32 m0, s45, 81920
s_mov_b32 s46, 4489216
buffer_load_dwordx4 v57, s[20:23], s46 offen  lds
s_add_u32 m0, s45, 86016
s_mov_b32 s46, 4751360
buffer_load_dwordx4 v57, s[20:23], s46 offen  lds
s_waitcnt vmcnt(17)
s_barrier
s_add_u32 m0, s45, 90112
s_mov_b32 s46, 5013504
buffer_load_dwordx4 v57, s[20:23], s46 offen  lds
s_add_u32 m0, s45, 94208
s_mov_b32 s46, 5275648
buffer_load_dwordx4 v57, s[20:23], s46 offen  lds
s_add_u32 m0, s45, 98304
s_mov_b32 s46, 5537792
buffer_load_dwordx4 v57, s[20:23], s46 offen  lds
s_add_u32 m0, s45, 102400
s_mov_b32 s46, 5799936
buffer_load_dwordx4 v57, s[20:23], s46 offen  lds
s_add_u32 m0, s45, 106496
s_mov_b32 s46, 98304
buffer_load_dwordx4 v57, s[20:23], s46 offen  lds
s_mov_b32 exec_hi, 65535
buffer_load_dword v61, v60, s[20:23], 0 offen
s_mov_b64 exec, -1
s_cmp_lg_u32 s32, 4
s_cbranch_scc1 L_nosig2
s_mov_b64 exec, 1
global_atomic_add v20, v21, s[10:11] sc1
s_mov_b64 exec, -1
L_nosig2:
s_waitcnt vmcnt(16)
s_barrier
s_add_u32 m0, s45, 110592
s_mov_b32 s46, 6062080
buffer_load_dwordx4 v57, s[20:23], s46 offen  lds
s_waitcnt vmcnt(13)
s_barrier
s_add_u32 m0, s45, 0
s_mov_b32 s46, 6324224
buffer_load_dwordx4 v57, s[20:23], s46 offen  lds
s_waitcnt vmcnt(10)
s_barrier
s_add_u32 m0, s45, 4096
s_mov_b32 s46, 360448
buffer_load_dwordx4 v57, s[20:23], s46 offen  lds
s_add_u32 m0, s45, 8192
s_mov_b32 s46, 6586368
buffer_load_dwordx4 v57, s[20:23], s46 offen  lds
s_add_u32 m0, s45, 12288
s_mov_b32 s46, 6848512
buffer_load_dwordx4 v57, s[20:23], s46 offen  lds
s_add_u32 m0, s45, 16384
s_mov_b32 s46, 622592
buffer_load_dwordx4 v57, s[20:23], s46 offen  lds
s_add_u32 m0, s45, 20480
s_mov_b32 s46, 884736
buffer_load_dwordx4 v57, s[20:23], s46 offen  lds
s_add_u32 m0, s45, 24576
s_mov_b32 s46, 7110656
buffer_load_dwordx4 v57, s[20:23], s46 offen  lds
s_waitcnt vmcnt(12)
s_barrier
s_add_u32 m0, s45, 28672
s_mov_b32 s46, 7372800
buffer_load_dwordx4 v57, s[20:23], s46 offen  lds
s_add_u32 m0, s45, 32768
s_mov_b32 s46, 1146880
buffer_load_dwordx4 v57, s[20:23], s46 offen  lds
s_add_u32 m0, s45, 36864
s_mov_b32 s46, 7634944
buffer_load_dwordx4 v57, s[20:23], s46 offen  lds
s_add_u32 m0, s45, 40960
s_mov_b32 s46, 7897088
buffer_load_dwordx4 v57, s[20:23], s46 offen  lds
s_add_u32 m0, s45, 45056
s_mov_b32 s46, 1409024
buffer_load_dwordx4 v57, s[20:23], s46 offen  lds
s_add_u32 m0, s45, 49152
s_mov_b32 s46, 65536
buffer_load_dwordx4 v57, s[20:23], s46 offen  lds
s_add_u32 m0, s45, 53248
s_mov_b32 s46, 327680
buffer_load_dwordx4 v57, s[20:23], s46 offen  lds
s_waitcnt vmcnt(12)
s_barrier
s_add_u32 m0, s45, 57344
s_mov_b32 s46, 1671168
buffer_load_dwordx4 v57, s[20:23], s46 offen  lds
s_add_u32 m0, s45, 61440
s_mov_b32 s46, 1933312
buffer_load_dwordx4 v57, s[20:23], s46 offen  lds
s_add_u32 m0, s45, 65536
s_mov_b32 s46, 589824
buffer_load_dwordx4 v57, s[20:23], s46 offen  lds
s_add_u32 m0, s45, 69632
s_mov_b32 s46, 851968
buffer_load_dwordx4 v57, s[20:23], s46 offen  lds
s_add_u32 m0, s45, 73728
s_mov_b32 s46, 2195456
buffer_load_dwordx4 v57, s[20:23], s46 offen  lds
s_add_u32 m0, s45, 77824
s_mov_b32 s46, 1114112
buffer_load_dwordx4 v57, s[20:23], s46 offen  lds
s_add_u32 m0, s45, 81920
s_mov_b32 s46, 1376256
buffer_load_dwordx4 v57, s[20:23], s46 offen  lds
s_waitcnt vmcnt(12)
s_barrier
s_add_u32 m0, s45, 86016
s_mov_b32 s46, 2457600
buffer_load_dwordx4 v57, s[20:23], s46 offen  lds
s_add_u32 m0, s45, 90112
s_mov_b32 s46, 2719744
buffer_load_dwordx4 v57, s[20:23], s46 offen  lds
s_add_u32 m0, s45, 94208
s_mov_b32 s46, 1638400
buffer_load_dwordx4 v57, s[20:23], s46 offen  lds
s_add_u32 m0, s45, 98304
s_mov_b32 s46, 1900544
buffer_load_dwordx4 v57, s[20:23], s46 offen  lds
s_add_u32 m0, s45, 102400
s_mov_b32 s46, 2981888
buffer_load_dwordx4 v57, s[20:23], s46 offen  lds
s_add_u32 m0, s45, 106496
s_mov_b32 s46, 2162688
buffer_load_dwordx4 v57, s[20:23], s46 offen  lds
s_add_u32 m0, s45, 110592
s_mov_b32 s46, 2424832
buffer_load_dwordx4 v57, s[20:23], s46 offen  lds
s_waitcnt vmcnt(12)
s_barrier
s_add_u32 m0, s45, 0
s_mov_b32 s46, 3244032
buffer_load_dwordx4 v57, s[20:23], s46 offen  lds
s_add_u32 m0, s45, 4096
s_mov_b32 s46, 3506176
buffer_load_dwordx4 v57, s[20:23], s46 offen  lds
s_add_u32 m0, s45, 8192
s_mov_b32 s46, 2686976
buffer_load_dwordx4 v57, s[20:23], s46 offen  lds
s_add_u32 m0, s45, 12288
s_mov_b32 s46, 2949120
buffer_load_dwordx4 v57, s[20:23], s46 offen  lds
s_add_u32 m0, s45, 16384
s_mov_b32 s46, 3768320
buffer_load_dwordx4 v57, s[20:23], s46 offen  lds
s_add_u32 m0, s45, 20480
s_mov_b32 s46, 3211264
buffer_load_dwordx4 v57, s[20:23], s46 offen  lds
s_add_u32 m0, s45, 24576
s_mov_b32 s46, 3473408
buffer_load_dwordx4 v57, s[20:23], s46 offen  lds
s_waitcnt vmcnt(13)
s_barrier
s_add_u32 m0, s45, 28672
s_mov_b32 s46, 4030464
buffer_load_dwordx4 v57, s[20:23], s46 offen  lds
s_add_u32 m0, s45, 32768
s_mov_b32 s46, 3735552
buffer_load_dwordx4 v57, s[20:23], s46 offen  lds
s_add_u32 m0, s45, 36864
s_mov_b32 s46, 3997696
buffer_load_dwordx4 v57, s[20:23], s46 offen  lds
s_add_u32 m0, s45, 40960
s_mov_b32 s46, 4292608
buffer_load_dwordx4 v57, s[20:23], s46 offen  lds
s_add_u32 m0, s45, 45056
s_mov_b32 s46, 4554752
buffer_load_dwordx4 v57, s[20:23], s46 offen  lds
s_add_u32 m0, s45, 49152
s_mov_b32 s46, 4259840
buffer_load_dwordx4 v57, s[20:23], s46 offen  lds
s_add_u32 m0, s45, 53248
s_mov_b32 s46, 4521984
buffer_load_dwordx4 v57, s[20:23], s46 offen  lds
s_waitcnt vmcnt(13)
s_barrier
s_add_u32 m0, s45, 57344
s_mov_b32 s46, 4816896
buffer_load_dwordx4 v57, s[20:23], s46 offen  lds
s_add_u32 m0, s45, 61440
s_mov_b32 s46, 4784128
buffer_load_dwordx4 v57, s[20:23], s46 offen  lds
s_add_u32 m0, s45, 65536
s_mov_b32 s46, 5046272
buffer_load_dwordx4 v57, s[20:23], s46 offen  lds
s_add_u32 m0, s45, 69632
s_mov_b32 s46, 5079040
buffer_load_dwordx4 v57, s[20:23], s46 offen  lds
s_add_u32 m0, s45, 73728
s_mov_b32 s46, 5341184
buffer_load_dwordx4 v57, s[20:23], s46 offen  lds
s_add_u32 m0, s45, 77824
s_mov_b32 s46, 5308416
buffer_load_dwordx4 v57, s[20:23], s46 offen  lds
s_add_u32 m0, s45, 81920
s_mov_b32 s46, 5570560
buffer_load_dwordx4 v57, s[20:23], s46 offen  lds
s_waitcnt vmcnt(13)
s_barrier
s_add_u32 m0, s45, 86016
s_mov_b32 s46, 5603328
buffer_load_dwordx4 v57, s[20:23], s46 offen  lds
s_add_u32 m0, s45, 90112
s_mov_b32 s46, 5832704
buffer_load_dwordx4 v57, s[20:23], s46 offen  lds
s_add_u32 m0, s45, 94208
s_mov_b32 s46, 6094848
buffer_load_dwordx4 v57, s[20:23], s46 offen  lds
s_add_u32 m0, s45, 98304
s_mov_b32 s46, 5865472
buffer_load_dwordx4 v57, s[20:23], s46 offen  lds
s_add_u32 m0, s45, 102400
s_mov_b32 s46, 6356992
buffer_load_dwordx4 v57, s[20:23], s46 offen  lds
s_add_u32 m0, s45, 106496
s_mov_b32 s46, 6619136
buffer_load_dwordx4 v57, s[20:23], s46 offen  lds
s_add_u32 m0, s45, 110592
s_mov_b32 s46, 6127616
buffer_load_dwordx4 v57, s[20:23], s46 offen  lds
s_waitcnt vmcnt(13)
s_barrier
s_add_u32 m0, s45, 0
s_mov_b32 s46, 6881280
buffer_load_dwordx4 v57, s[20:23], s46 offen  lds
s_add_u32 m0, s45, 4096
s_mov_b32 s46, 7143424
buffer_load_dwordx4 v57, s[20:23], s46 offen  lds
s_add_u32 m0, s45, 8192
s_mov_b32 s46, 6389760
buffer_load_dwordx4 v57, s[20:23], s46 offen  lds
s_add_u32 m0, s45, 12288
s_mov_b32 s46, 7405568
buffer_load_dwordx4 v57, s[20:23], s46 offen  lds
s_add_u32 m0, s45, 16384
s_mov_b32 s46, 7667712
buffer_load_dwordx4 v57, s[20:23], s46 offen  lds
s_add_u32 m0, s45, 20480
s_mov_b32 s46, 6651904
buffer_load_dwordx4 v57, s[20:23], s46 offen  lds
s_add_u32 m0, s45, 24576
s_mov_b32 s46, 7929856
buffer_load_dwordx4 v57, s[20:23], s46 offen  lds
s_waitcnt vmcnt(11)
s_barrier
s_add_u32 m0, s45, 28672
s_mov_b32 s46, 6914048
buffer_load_dwordx4 v57, s[20:23], s46 offen  lds
s_add_u32 m0, s45, 32768
s_mov_b32 s46, 7176192
buffer_load_dwordx4 v57, s[20:23], s46 offen  lds
s_add_u32 m0, s45, 36864
s_mov_b32 s46, 7438336
buffer_load_dwordx4 v57, s[20:23], s46 offen  lds
s_add_u32 m0, s45, 40960
s_mov_b32 s46, 7700480
buffer_load_dwordx4 v57, s[20:23], s46 offen  lds
s_add_u32 m0, s45, 45056
s_mov_b32 s46, 7962624
buffer_load_dwordx4 v57, s[20:23], s46 offen  lds
v_mov_b32 v22, 4
s_cmp_lg_u32 s32, 4
s_cbranch_scc1 L_nopoll2
global_load_dword v22, v20, s[10:11] sc1
L_nopoll2:
buffer_store_dwordx4 v[16:19], v14, s[28:31], s58 offen sc1
buffer_store_dwordx4 v[16:19], v14, s[28:31], s59 offen sc1
buffer_store_dwordx4 v[16:19], v14, s[28:31], s39 offen sc1
s_waitcnt vmcnt(10)
s_barrier
s_waitcnt vmcnt(6)
s_barrier
s_waitcnt vmcnt(0)
L_hs2:
v_readfirstlane_b32 s40, v22
s_nop 0
s_cmp_ge_u32 s40, 4
s_cbranch_scc1 L_hsok2
s_sleep 8
global_load_dword v22, v20, s[10:11] sc1
s_waitcnt vmcnt(0)
s_branch L_hs2
L_hsok2:
s_barrier
s_cmp_lg_u32 s32, 4
s_cbranch_scc1 L_nf2
v_mov_b32 v72, v68
s_cmp_eq_u32 s37, 1
s_cselect_b64 vcc, -1, 0
v_cndmask_b32 v72, v72, v69, vcc
s_cmp_eq_u32 s37, 2
s_cselect_b64 vcc, -1, 0
v_cndmask_b32 v72, v72, v70, vcc
s_cmp_eq_u32 s37, 3
s_cselect_b64 vcc, -1, 0
v_cndmask_b32 v72, v72, v71, vcc
v_add_u32 v72, 1, v72
s_lshl_b32 s40, s37, 2
s_mov_b64 exec, 1
buffer_store_dword v72, v66, s[28:31], s40 offen sc1
s_mov_b64 exec, -1
L_nf2:
s_branch L_hend
L_hg3:
s_add_u32 m0, s45, 16384
s_mov_b32 s46, 1048576
buffer_load_dwordx4 v57, s[20:23], s46 offen  lds
s_add_u32 m0, s45, 20480
s_mov_b32 s46, 1310720
buffer_load_dwordx4 v57, s[20:23], s46 offen  lds
s_add_u32 m0, s45, 24576
s_mov_b32 s46, 1572864
buffer_load_dwordx4 v57, s[20:23], s46 offen  lds
s_add_u32 m0, s45, 28672
s_mov_b32 s46, 1835008
buffer_load_dwordx4 v57, s[20:23], s46 offen  lds
s_cmp_lg_u32 s32, 7
s_cbranch_scc1 L_ng73
s_add_u32 s54, s36, 16
s_lshl_b32 s54, s54, 18
s_cmp_eq_u32 s36, 15
s_cselect_b32 s54, 0x8000, s54
s_mov_b32 exec_hi, 0
buffer_load_dword v0, v58, s[20:23], s54 offen
s_mov_b64 exec, -1
L_ng73:
s_barrier
s_add_u32 m0, s45, 32768
s_mov_b32 s46, 2097152
buffer_load_dwordx4 v57, s[20:23], s46 offen  lds
s_and_b32 s40, s36, 3
s_lshl_b32 s40, s40, 1
s_or_b32 s40, s40, s35
v_lshrrev_b32 v62, 4, v1
v_mul_u32_u24 v62, 8, v62
v_add_u32 v62, s40, v62
v_min_u32 v62, 22, v62
s_add_u32 m0, s45, 36864
s_mov_b32 s46, 2359296
buffer_load_dwordx4 v57, s[20:23], s46 offen  lds
v_add_u32 v60, 82, v62
v_cmp_le_u32 vcc, 11, v62
v_add_u32 v63, 101, v62
s_nop 0
v_cndmask_b32 v60, v60, v63, vcc
v_mul_u32_u24 v63, 2115, v60
v_lshrrev_b32 v63, 16, v63
s_add_u32 m0, s45, 40960
s_mov_b32 s46, 2621440
buffer_load_dwordx4 v57, s[20:23], s46 offen  lds
v_mul_u32_u24 v64, 31, v63
v_sub_u32 v60, v60, v64
v_lshlrev_b32 v60, 18, v60
v_lshl_add_u32 v60, v63, 15, v60
v_and_b32 v62, 7, v1
v_lshl_add_u32 v60, v62, 10, v60
v_bfe_u32 v62, v1, 3, 1
s_waitcnt vmcnt(8)
s_cmp_eq_u32 s32, 7
s_cbranch_scc1 L_w73_1
s_waitcnt vmcnt(7)
L_w73_1:
s_barrier
s_add_u32 m0, s45, 45056
s_mov_b32 s46, 2883584
buffer_load_dwordx4 v57, s[20:23], s46 offen  lds
v_lshl_add_u32 v60, v62, 9, v60
s_andn2_b32 s40, s47, 512
s_lshl_b32 s41, s42, 13
s_add_u32 s40, s40, s41
v_add_u32 v60, s40, v60
v_mov_b32 v16, -1
v_mov_b32 v17, -1
s_waitcnt vmcnt(5)
s_cmp_eq_u32 s32, 7
s_cbranch_scc1 L_w73_2
s_waitcnt vmcnt(4)
L_w73_2:
s_barrier
s_add_u32 m0, s45, 49152
s_mov_b32 s46, 3145728
buffer_load_dwordx4 v57, s[20:23], s46 offen  lds
v_mov_b32 v18, -1
v_mov_b32 v19, -1
s_xor_b32 s58, s37, 2
s_mul_i32 s58, s58, 12288
s_add_u32 s58, s58, 0
s_add_u32 s58, s58, s44
s_xor_b32 s59, s37, 3
s_add_u32 m0, s45, 53248
s_mov_b32 s46, 3407872
buffer_load_dwordx4 v57, s[20:23], s46 offen  lds
s_mul_i32 s59, s59, 12288
s_add_u32 s59, s59, 4096
s_add_u32 s59, s59, s44
s_xor_b32 s39, s37, 1
s_mul_i32 s39, s39, 12288
s_add_u32 s39, s39, 8192
s_add_u32 s39, s39, s44
s_add_u32 m0, s45, 57344
s_mov_b32 s46, 3670016
buffer_load_dwordx4 v57, s[20:23], s46 offen  lds
s_lshl_b32 s40, s38, 2
v_mov_b32 v20, s40
v_mov_b32 v21, 1
s_mul_i32 s40, s38, 49408
s_add_u32 s40, s40, 49152
v_mov_b32 v66, s40
s_mov_b32 s28, s12
s_add_u32 m0, s45, 61440
s_mov_b32 s46, 3932160
buffer_load_dwordx4 v57, s[20:23], s46 offen  lds
s_mov_b32 s29, s13
s_mov_b32 s30, 0x10000000
s_mov_b32 s31, 0x20000
s_add_u32 m0, s45, 65536
s_mov_b32 s46, 4194304
buffer_load_dwordx4 v57, s[20:23], s46 offen  lds
s_add_u32 m0, s45, 69632
s_mov_b32 s46, 4456448
buffer_load_dwordx4 v57, s[20:23], s46 offen  lds
s_add_u32 m0, s45, 73728
s_mov_b32 s46, 4718592
buffer_load_dwordx4 v57, s[20:23], s46 offen  lds
s_waitcnt vmcnt(7)
s_barrier
s_add_u32 m0, s45, 77824
s_mov_b32 s46, 4980736
buffer_load_dwordx4 v57, s[20:23], s46 offen  lds
s_add_u32 m0, s45, 81920
s_mov_b32 s46, 5242880
buffer_load_dwordx4 v57, s[20:23], s46 offen  lds
s_add_u32 m0, s45, 86016
s_mov_b32 s46, 5505024
buffer_load_dwordx4 v57, s[20:23], s46 offen  lds
s_add_u32 m0, s45, 90112
s_mov_b32 s46, 5767168
buffer_load_dwordx4 v57, s[20:23], s46 offen  lds
s_add_u32 m0, s45, 94208
s_mov_b32 s46, 6029312
buffer_load_dwordx4 v57, s[20:23], s46 offen  lds
s_add_u32 m0, s45, 98304
s_mov_b32 s46, 6291456
buffer_load_dwordx4 v57, s[20:23], s46 offen  lds
s_add_u32 m0, s45, 102400
s_mov_b32 s46, 6553600
buffer_load_dwordx4 v57, s[20:23], s46 offen  lds
s_waitcnt vmcnt(10)
s_barrier
s_add_u32 m0, s45, 106496
s_mov_b32 s46, 6815744
buffer_load_dwordx4 v57, s[20:23], s46 offen  lds
s_add_u32 m0, s45, 110592
s_mov_b32 s46, 7077888
buffer_load_dwordx4 v57, s[20:23], s46 offen  lds
s_add_u32 m0, s45, 0
s_mov_b32 s46, 7340032
buffer_load_dwordx4 v57, s[20:23], s46 offen  lds
s_add_u32 m0, s45, 4096
s_mov_b32 s46, 7602176
buffer_load_dwordx4 v57, s[20:23], s46 offen  lds
s_add_u32 m0, s45, 8192
s_mov_b32 s46, 7864320
buffer_load_dwordx4 v57, s[20:23], s46 offen  lds
s_add_u32 m0, s45, 12288
s_mov_b32 s46, 32768
buffer_load_dwordx4 v57, s[20:23], s46 offen  lds
s_waitcnt vmcnt(12)
s_barrier
s_cmp_lg_u32 s32, 4
s_cbranch_scc1 L_wk3_0
s_cmp_eq_u32 0, 0
s_call_b64 s[50:51], L_pgc_0
L_wk3_0:
s_cmp_lg_u32 s32, 5
s_cbranch_scc1 L_wk3_1
s_cmp_eq_u32 0, 0
s_call_b64 s[50:51], L_pgc_1
L_wk3_1:
s_cmp_lg_u32 s32, 6
s_cbranch_scc1 L_wk3_2
s_cmp_lg_u32 s37, 0
s_cbranch_scc1 L_wq3_3
s_cmp_eq_u32 0, 0
s_call_b64 s[50:51], L_pg0_0
L_wq3_3:
s_cmp_lg_u32 s37, 1
s_cbranch_scc1 L_wq3_4
s_cmp_eq_u32 0, 0
s_call_b64 s[50:51], L_pg1_0
L_wq3_4:
s_cmp_lg_u32 s37, 2
s_cbranch_scc1 L_wq3_5
s_cmp_eq_u32 0, 0
s_call_b64 s[50:51], L_pg2_0
L_wq3_5:
s_cmp_lg_u32 s37, 2
s_cbranch_scc1 L_wq3_6
s_cmp_eq_u32 0, 0
s_call_b64 s[50:51], L_pg2_1
L_wq3_6:
s_cmp_lg_u32 s37, 3
s_cbranch_scc1 L_wq3_7
s_cmp_eq_u32 0, 0
s_call_b64 s[50:51], L_pg3_0
L_wq3_7:
L_wk3_2:
s_cmp_lg_u32 s32, 7
s_cbranch_scc1 L_wk3_3
s_cmp_lg_u32 s37, 1
s_cbranch_scc1 L_wq3_8
s_cmp_eq_u32 0, 0
s_call_b64 s[50:51], L_warm1
L_wq3_8:
s_cmp_lg_u32 s37, 2
s_cbranch_scc1 L_wq3_9
s_cmp_eq_u32 0, 0
s_call_b64 s[50:51], L_warm2
L_wq3_9:
s_cmp_lg_u32 s37, 3
s_cbranch_scc1 L_wq3_10
s_cmp_eq_u32 0, 0
s_call_b64 s[50:51], L_warm3
L_wq3_10:
L_wk3_3:
buffer_load_dwordx4 v[68:71], v66, s[28:31], 0 offen sc1
v_add_u32 v48, 128, v56
v_add_u32 v49, 65664, v56
v_add_u32 v50, 131200, v56
s_add_u32 m0, s43, 20480
s_nop 0
buffer_load_dwordx4 v48, s[16:19], 0 offen lds
s_add_u32 m0, s43, 21504
s_nop 0
buffer_load_dwordx4 v49, s[16:19], 0 offen lds
s_add_u32 m0, s43, 22528
s_mov_b32 exec_hi, 0
buffer_load_dwordx4 v50, s[16:19], 0 offen lds
s_mov_b64 exec, -1
s_waitcnt vmcnt(12)
s_barrier
s_add_u32 m0, s45, 16384
s_mov_b32 s46, 294912
buffer_load_dwordx4 v57, s[20:23], s46 offen  lds
s_add_u32 m0, s45, 20480
s_mov_b32 s46, 557056
buffer_load_dwordx4 v57, s[20:23], s46 offen  lds
s_add_u32 m0, s45, 24576
s_mov_b32 s46, 819200
buffer_load_dwordx4 v57, s[20:23], s46 offen  lds
s_add_u32 m0, s45, 28672
s_mov_b32 s46, 1081344
buffer_load_dwordx4 v57, s[20:23], s46 offen  lds
v_add_u32 v48, 4224, v56
v_add_u32 v49, 69760, v56
v_add_u32 v50, 135296, v56
s_add_u32 m0, s43, 30720
s_nop 0
buffer_load_dwordx4 v48, s[16:19], 0 offen lds
s_add_u32 m0, s43, 31744
s_nop 0
buffer_load_dwordx4 v49, s[16:19], 0 offen lds
s_add_u32 m0, s43, 32768
s_mov_b32 exec_hi, 0
buffer_load_dwordx4 v50, s[16:19], 0 offen lds
s_mov_b64 exec, -1
s_waitcnt vmcnt(15)
s_barrier
s_add_u32 m0, s45, 32768
s_mov_b32 s46, 1343488
buffer_load_dwordx4 v57, s[20:23], s46 offen  lds
s_add_u32 m0, s45, 36864
s_mov_b32 s46, 1605632
buffer_load_dwordx4 v57, s[20:23], s46 offen  lds
s_add_u32 m0, s45, 40960
s_mov_b32 s46, 1867776
buffer_load_dwordx4 v57, s[20:23], s46 offen  lds
s_add_u32 m0, s45, 45056
s_mov_b32 s46, 2129920
buffer_load_dwordx4 v57, s[20:23], s46 offen  lds
s_add_u32 m0, s45, 49152
s_mov_b32 s46, 2392064
buffer_load_dwordx4 v57, s[20:23], s46 offen  lds
s_add_u32 m0, s45, 53248
s_mov_b32 s46, 2654208
buffer_load_dwordx4 v57, s[20:23], s46 offen  lds
s_add_u32 m0, s45, 57344
s_mov_b32 s46, 2916352
buffer_load_dwordx4 v57, s[20:23], s46 offen  lds
s_waitcnt vmcnt(18)
s_barrier
s_add_u32 m0, s45, 61440
s_mov_b32 s46, 3178496
buffer_load_dwordx4 v57, s[20:23], s46 offen  lds
s_add_u32 m0, s45, 65536
s_mov_b32 s46, 3440640
buffer_load_dwordx4 v57, s[20:23], s46 offen  lds
s_add_u32 m0, s45, 69632
s_mov_b32 s46, 3702784
buffer_load_dwordx4 v57, s[20:23], s46 offen  lds
s_add_u32 m0, s45, 73728
s_mov_b32 s46, 3964928
buffer_load_dwordx4 v57, s[20:23], s46 offen  lds
s_add_u32 m0, s45, 77824
s_mov_b32 s46, 4227072
buffer_load_dwordx4 v57, s[20:23], s46 offen  lds
s_add_u32 m0, s45, 81920
s_mov_b32 s46, 4489216
buffer_load_dwordx4 v57, s[20:23], s46 offen  lds
s_add_u32 m0, s45, 86016
s_mov_b32 s46, 4751360
buffer_load_dwordx4 v57, s[20:23], s46 offen  lds
s_waitcnt vmcnt(17)
s_barrier
s_add_u32 m0, s45, 90112
s_mov_b32 s46, 5013504
buffer_load_dwordx4 v57, s[20:23], s46 offen  lds
s_add_u32 m0, s45, 94208
s_mov_b32 s46, 5275648
buffer_load_dwordx4 v57, s[20:23], s46 offen  lds
s_add_u32 m0, s45, 98304
s_mov_b32 s46, 5537792
buffer_load_dwordx4 v57, s[20:23], s46 offen  lds
s_add_u32 m0, s45, 102400
s_mov_b32 s46, 5799936
buffer_load_dwordx4 v57, s[20:23], s46 offen  lds
s_add_u32 m0, s45, 106496
s_mov_b32 s46, 98304
buffer_load_dwordx4 v57, s[20:23], s46 offen  lds
s_waitcnt vmcnt(15)
s_barrier
s_add_u32 m0, s45, 110592
s_mov_b32 s46, 6062080
buffer_load_dwordx4 v57, s[20:23], s46 offen  lds
s_add_u32 m0, s45, 0
s_mov_b32 s46, 6324224
buffer_load_dwordx4 v57, s[20:23], s46 offen  lds
s_add_u32 m0, s45, 4096
s_mov_b32 s46, 360448
buffer_load_dwordx4 v57, s[20:23], s46 offen  lds
s_add_u32 m0, s45, 8192
s_mov_b32 s46, 6586368
buffer_load_dwordx4 v57, s[20:23], s46 offen  lds
s_add_u32 m0, s45, 12288
s_mov_b32 s46, 6848512
buffer_load_dwordx4 v57, s[20:23], s46 offen  lds
s_add_u32 m0, s45, 16384
s_mov_b32 s46, 622592
buffer_load_dwordx4 v57, s[20:23], s46 offen  lds
s_waitcnt vmcnt(17)
s_barrier
s_add_u32 m0, s45, 20480
s_mov_b32 s46, 884736
buffer_load_dwordx4 v57, s[20:23], s46 offen  lds
s_add_u32 m0, s45, 24576
s_mov_b32 s46, 7110656
buffer_load_dwordx4 v57, s[20:23], s46 offen  lds
s_add_u32 m0, s45, 28672
s_mov_b32 s46, 7372800
buffer_load_dwordx4 v57, s[20:23], s46 offen  lds
s_add_u32 m0, s45, 32768
s_mov_b32 s46, 1146880
buffer_load_dwordx4 v57, s[20:23], s46 offen  lds
s_add_u32 m0, s45, 36864
s_mov_b32 s46, 7634944
buffer_load_dwordx4 v57, s[20:23], s46 offen  lds
s_add_u32 m0, s45, 40960
s_mov_b32 s46, 7897088
buffer_load_dwordx4 v57, s[20:23], s46 offen  lds
s_add_u32 m0, s45, 45056
s_mov_b32 s46, 1409024
buffer_load_dwordx4 v57, s[20:23], s46 offen  lds
s_mov_b32 exec_hi, 65535
buffer_load_dword v61, v60, s[20:23], 0 offen
s_mov_b64 exec, -1
s_cmp_lg_u32 s32, 4
s_cbranch_scc1 L_nosig3
s_mov_b64 exec, 1
global_atomic_add v20, v21, s[10:11] sc1
s_mov_b64 exec, -1
L_nosig3:
s_waitcnt vmcnt(21)
s_barrier
s_add_u32 m0, s45, 49152
s_mov_b32 s46, 65536
buffer_load_dwordx4 v57, s[20:23], s46 offen  lds
s_waitcnt vmcnt(18)
s_barrier
s_add_u32 m0, s45, 53248
s_mov_b32 s46, 327680
buffer_load_dwordx4 v57, s[20:23], s46 offen  lds
s_waitcnt vmcnt(13)
s_barrier
s_add_u32 m0, s45, 57344
s_mov_b32 s46, 1671168
buffer_load_dwordx4 v57, s[20:23], s46 offen  lds
s_add_u32 m0, s45, 61440
s_mov_b32 s46, 1933312
buffer_load_dwordx4 v57, s[20:23], s46 offen  lds
s_add_u32 m0, s45, 65536
s_mov_b32 s46, 589824
buffer_load_dwordx4 v57, s[20:23], s46 offen  lds
s_add_u32 m0, s45, 69632
s_mov_b32 s46, 851968
buffer_load_dwordx4 v57, s[20:23], s46 offen  lds
s_add_u32 m0, s45, 73728
s_mov_b32 s46, 2195456
buffer_load_dwordx4 v57, s[20:23], s46 offen  lds
s_add_u32 m0, s45, 77824
s_mov_b32 s46, 1114112
buffer_load_dwordx4 v57, s[20:23], s46 offen  lds
s_waitcnt vmcnt(12)
s_barrier
s_add_u32 m0, s45, 81920
s_mov_b32 s46, 1376256
buffer_load_dwordx4 v57, s[20:23], s46 offen  lds
s_add_u32 m0, s45, 86016
s_mov_b32 s46, 2457600
buffer_load_dwordx4 v57, s[20:23], s46 offen  lds
s_add_u32 m0, s45, 90112
s_mov_b32 s46, 2719744
buffer_load_dwordx4 v57, s[20:23], s46 offen  lds
s_add_u32 m0, s45, 94208
s_mov_b32 s46, 1638400
buffer_load_dwordx4 v57, s[20:23], s46 offen  lds
s_add_u32 m0, s45, 98304
s_mov_b32 s46, 1900544
buffer_load_dwordx4 v57, s[20:23], s46 offen  lds
s_add_u32 m0, s45, 102400
s_mov_b32 s46, 2981888
buffer_load_dwordx4 v57, s[20:23], s46 offen  lds
s_add_u32 m0, s45, 106496
s_mov_b32 s46, 2162688
buffer_load_dwordx4 v57, s[20:23], s46 offen  lds
s_waitcnt vmcnt(11)
s_barrier
s_add_u32 m0, s45, 110592
s_mov_b32 s46, 2424832
buffer_load_dwordx4 v57, s[20:23], s46 offen  lds
s_add_u32 m0, s45, 0
s_mov_b32 s46, 3244032
buffer_load_dwordx4 v57, s[20:23], s46 offen  lds
s_add_u32 m0, s45, 4096
s_mov_b32 s46, 3506176
buffer_load_dwordx4 v57, s[20:23], s46 offen  lds
s_add_u32 m0, s45, 8192
s_mov_b32 s46, 2686976
buffer_load_dwordx4 v57, s[20:23], s46 offen  lds
s_add_u32 m0, s45, 12288
s_mov_b32 s46, 2949120
buffer_load_dwordx4 v57, s[20:23], s46 offen  lds
s_add_u32 m0, s45, 16384
s_mov_b32 s46, 3768320
buffer_load_dwordx4 v57, s[20:23], s46 offen  lds
s_add_u32 m0, s45, 20480
s_mov_b32 s46, 3211264
buffer_load_dwordx4 v57, s[20:23], s46 offen  lds
s_waitcnt vmcnt(12)
s_barrier
s_add_u32 m0, s45, 24576
s_mov_b32 s46, 3473408
buffer_load_dwordx4 v57, s[20:23], s46 offen  lds
s_add_u32 m0, s45, 28672
s_mov_b32 s46, 4030464
buffer_load_dwordx4 v57, s[20:23], s46 offen  lds
s_add_u32 m0, s45, 32768
s_mov_b32 s46, 3735552
buffer_load_dwordx4 v57, s[20:23], s46 offen  lds
s_add_u32 m0, s45, 36864
s_mov_b32 s46, 3997696
buffer_load_dwordx4 v57, s[20:23], s46 offen  lds
s_add_u32 m0, s45, 40960
s_mov_b32 s46, 4292608
buffer_load_dwordx4 v57, s[20:23], s46 offen  lds
s_add_u32 m0, s45, 45056
s_mov_b32 s46, 4554752
buffer_load_dwordx4 v57, s[20:23], s46 offen  lds
s_add_u32 m0, s45, 49152
s_mov_b32 s46, 4259840
buffer_load_dwordx4 v57, s[20:23], s46 offen  lds
s_waitcnt vmcnt(12)
s_barrier
s_add_u32 m0, s45, 53248
s_mov_b32 s46, 4521984
buffer_load_dwordx4 v57, s[20:23], s46 offen  lds
s_add_u32 m0, s45, 57344
s_mov_b32 s46, 4816896
buffer_load_dwordx4 v57, s[20:23], s46 offen  lds
s_add_u32 m0, s45, 61440
s_mov_b32 s46, 4784128
buffer_load_dwordx4 v57, s[20:23], s46 offen  lds
s_add_u32 m0, s45, 65536
s_mov_b32 s46, 5046272
buffer_load_dwordx4 v57, s[20:23], s46 offen  lds
s_add_u32 m0, s45, 69632
s_mov_b32 s46, 5079040
buffer_load_dwordx4 v57, s[20:23], s46 offen  lds
s_add_u32 m0, s45, 73728
s_mov_b32 s46, 5341184
buffer_load_dwordx4 v57, s[20:23], s46 offen  lds
s_add_u32 m0, s45, 77824
s_mov_b32 s46, 5308416
buffer_load_dwordx4 v57, s[20:23], s46 offen  lds
s_waitcnt vmcnt(12)
s_barrier
s_add_u32 m0, s45, 81920
s_mov_b32 s46, 5570560
buffer_load_dwordx4 v57, s[20:23], s46 offen  lds
s_add_u32 m0, s45, 86016
s_mov_b32 s46, 5603328
buffer_load_dwordx4 v57, s[20:23], s46 offen  lds
s_add_u32 m0, s45, 90112
s_mov_b32 s46, 5832704
buffer_load_dwordx4 v57, s[20:23], s46 offen  lds
s_add_u32 m0, s45, 94208
s_mov_b32 s46, 6094848
buffer_load_dwordx4 v57, s[20:23], s46 offen  lds
s_add_u32 m0, s45, 98304
s_mov_b32 s46, 5865472
buffer_load_dwordx4 v57, s[20:23], s46 offen  lds
s_add_u32 m0, s45, 102400
s_mov_b32 s46, 6356992
buffer_load_dwordx4 v57, s[20:23], s46 offen  lds
s_add_u32 m0, s45, 106496
s_mov_b32 s46, 6619136
buffer_load_dwordx4 v57, s[20:23], s46 offen  lds
s_waitcnt vmcnt(12)
s_barrier
s_add_u32 m0, s45, 110592
s_mov_b32 s46, 6127616
buffer_load_dwordx4 v57, s[20:23], s46 offen  lds
s_add_u32 m0, s45, 0
s_mov_b32 s46, 6881280
buffer_load_dwordx4 v57, s[20:23], s46 offen  lds
s_add_u32 m0, s45, 4096
s_mov_b32 s46, 7143424
buffer_load_dwordx4 v57, s[20:23], s46 offen  lds
s_add_u32 m0, s45, 8192
s_mov_b32 s46, 6389760
buffer_load_dwordx4 v57, s[20:23], s46 offen  lds
s_add_u32 m0, s45, 12288
s_mov_b32 s46, 7405568
buffer_load_dwordx4 v57, s[20:23], s46 offen  lds
s_add_u32 m0, s45, 16384
s_mov_b32 s46, 7667712
buffer_load_dwordx4 v57, s[20:23], s46 offen  lds
s_add_u32 m0, s45, 20480
s_mov_b32 s46, 6651904
buffer_load_dwordx4 v57, s[20:23], s46 offen  lds
s_waitcnt vmcnt(10)
s_barrier
s_add_u32 m0, s45, 24576
s_mov_b32 s46, 7929856
buffer_load_dwordx4 v57, s[20:23], s46 offen  lds
s_add_u32 m0, s45, 28672
s_mov_b32 s46, 6914048
buffer_load_dwordx4 v57, s[20:23], s46 offen  lds
s_add_u32 m0, s45, 32768
s_mov_b32 s46, 7176192
buffer_load_dwordx4 v57, s[20:23], s46 offen  lds
s_add_u32 m0, s45, 36864
s_mov_b32 s46, 7438336
buffer_load_dwordx4 v57, s[20:23], s46 offen  lds
s_add_u32 m0, s45, 40960
s_mov_b32 s46, 7700480
buffer_load_dwordx4 v57, s[20:23], s46 offen  lds
s_add_u32 m0, s45, 45056
s_mov_b32 s46, 7962624
buffer_load_dwordx4 v57, s[20:23], s46 offen  lds
v_mov_b32 v22, 4
s_cmp_lg_u32 s32, 4
s_cbranch_scc1 L_nopoll3
global_load_dword v22, v20, s[10:11] sc1
L_nopoll3:
buffer_store_dwordx4 v[16:19], v14, s[28:31], s58 offen sc1
buffer_store_dwordx4 v[16:19], v14, s[28:31], s59 offen sc1
buffer_store_dwordx4 v[16:19], v14, s[28:31], s39 offen sc1
s_waitcnt vmcnt(10)
s_barrier
s_waitcnt vmcnt(6)
s_barrier
s_waitcnt vmcnt(0)
L_hs3:
v_readfirstlane_b32 s40, v22
s_nop 0
s_cmp_ge_u32 s40, 4
s_cbranch_scc1 L_hsok3
s_sleep 8
global_load_dword v22, v20, s[10:11] sc1
s_waitcnt vmcnt(0)
s_branch L_hs3
L_hsok3:
s_barrier
s_cmp_lg_u32 s32, 4
s_cbranch_scc1 L_nf3
v_mov_b32 v72, v68
s_cmp_eq_u32 s37, 1
s_cselect_b64 vcc, -1, 0
v_cndmask_b32 v72, v72, v69, vcc
s_cmp_eq_u32 s37, 2
s_cselect_b64 vcc, -1, 0
v_cndmask_b32 v72, v72, v70, vcc
s_cmp_eq_u32 s37, 3
s_cselect_b64 vcc, -1, 0
v_cndmask_b32 v72, v72, v71, vcc
v_add_u32 v72, 1, v72
s_lshl_b32 s40, s37, 2
s_mov_b64 exec, 1
buffer_store_dword v72, v66, s[28:31], s40 offen sc1
s_mov_b64 exec, -1
L_nf3:
L_hend:
s_cmp_lg_u32 s32, 4
s_cbranch_scc1 L_go
s_mov_b64 exec, 1
L_fl:
buffer_load_dwordx4 v[76:79], v66, s[28:31], 0 offen sc1
s_waitcnt vmcnt(0)
v_cmp_eq_u32 vcc, v68, v76
v_cmp_eq_u32 s[52:53], v69, v77
s_or_b64 vcc, vcc, s[52:53]
v_cmp_eq_u32 s[52:53], v70, v78
s_or_b64 vcc, vcc, s[52:53]
v_cmp_eq_u32 s[52:53], v71, v79
s_or_b64 vcc, vcc, s[52:53]
s_cbranch_vccnz L_fl
s_mov_b64 exec, -1
L_go:
s_mul_i32 s40, s37, 12288
s_add_u32 s52, s44, s40
s_add_u32 s53, s52, 4096
s_add_u32 s54, s52, 16384
s_lshl_b32 s40, s42, 12
v_add_u32 v65, s40, v14
s_mov_b32 s45, 0x4038aa3b
s_mov_b32 s46, 0xbfb8aa3b
s_cmp_lt_u32 s37, 2
s_cselect_b32 s55, s45, s46
s_cselect_b32 s56, s46, s45
s_barrier
buffer_load_dwordx4 v[96:99], v14, s[28:31], s52 offen sc1
s_barrier
buffer_load_dwordx4 v[100:103], v14, s[28:31], s53 offen sc1
s_waitcnt vmcnt(1)
L_ra:
v_max3_u32 v67, v96, v97, v98
v_max_u32 v67, v67, v99
v_cmp_eq_u32 vcc, -1, v67
s_cbranch_vccz L_rok
buffer_load_dwordx4 v[96:99], v14, s[28:31], s52 offen sc1
s_waitcnt vmcnt(0)
s_branch L_ra
L_rok:
v_lshlrev_b32 v80, 16, v96
v_and_b32 v81, 0xffff0000, v96
v_lshlrev_b32 v82, 16, v97
v_and_b32 v83, 0xffff0000, v97
v_lshlrev_b32 v84, 16, v98
v_and_b32 v85, 0xffff0000, v98
v_lshlrev_b32 v86, 16, v99
v_and_b32 v87, 0xffff0000, v99
v_mul_f32 v80, s56, v80
v_mul_f32 v81, s56, v81
v_mul_f32 v82, s56, v82
v_mul_f32 v83, s56, v83
v_mul_f32 v84, s56, v84
v_mul_f32 v85, s56, v85
v_mul_f32 v86, s56, v86
v_mul_f32 v87, s56, v87
L_rb:
s_waitcnt vmcnt(0)
v_max3_u32 v67, v100, v101, v102
v_max_u32 v67, v67, v103
v_cmp_eq_u32 vcc, -1, v67
s_cbranch_vccz L_rok2
buffer_load_dwordx4 v[100:103], v14, s[28:31], s53 offen sc1
s_branch L_rb
L_rok2:
v_lshlrev_b32 v88, 16, v100
v_and_b32 v89, 0xffff0000, v100
v_lshlrev_b32 v90, 16, v101
v_and_b32 v91, 0xffff0000, v101
v_lshlrev_b32 v92, 16, v102
v_and_b32 v93, 0xffff0000, v102
v_lshlrev_b32 v94, 16, v103
v_and_b32 v95, 0xffff0000, v103
v_fma_f32 v80, v88, s56, v80
v_fma_f32 v81, v89, s56, v81
v_fma_f32 v82, v90, s56, v82
v_fma_f32 v83, v91, s56, v83
v_fma_f32 v84, v92, s56, v84
v_fma_f32 v85, v93, s56, v85
v_fma_f32 v86, v94, s56, v86
v_fma_f32 v87, v95, s56, v87
v_exp_f32 v80, v80
v_exp_f32 v81, v81
v_exp_f32 v82, v82
v_exp_f32 v83, v83
v_exp_f32 v84, v84
v_exp_f32 v85, v85
v_exp_f32 v86, v86
v_exp_f32 v87, v87
v_add_f32 v80, 1.0, v80
v_add_f32 v81, 1.0, v81
v_add_f32 v82, 1.0, v82
v_add_f32 v83, 1.0, v83
v_add_f32 v84, 1.0, v84
v_add_f32 v85, 1.0, v85
v_add_f32 v86, 1.0, v86
v_add_f32 v87, 1.0, v87
v_rcp_f32 v80, v80
v_rcp_f32 v81, v81
v_rcp_f32 v82, v82
v_rcp_f32 v83, v83
v_rcp_f32 v84, v84
v_rcp_f32 v85, v85
v_rcp_f32 v86, v86
v_rcp_f32 v87, v87
s_cmp_lt_u32 s37, 2
s_cbranch_scc1 L_sg
v_fma_f32 v80, v80, -2.0, 1.0
v_fma_f32 v81, v81, -2.0, 1.0
v_fma_f32 v82, v82, -2.0, 1.0
v_fma_f32 v83, v83, -2.0, 1.0
v_fma_f32 v84, v84, -2.0, 1.0
v_fma_f32 v85, v85, -2.0, 1.0
v_fma_f32 v86, v86, -2.0, 1.0
v_fma_f32 v87, v87, -2.0, 1.0
L_sg:
s_nop 0
ds_write_b128 v65, v[80:83]
ds_write_b128 v65, v[84:87] offset:1024
s_waitcnt lgkmcnt(0)
s_barrier
s_endpgm
L_end:
s_endpgm
L_codeend:
.section .rodata,"a"
.p2align 6
.amdhsa_kernel standalone__autoregressive_conv_wavernn__speech_kernel
  .amdhsa_next_free_vgpr 256
  .amdhsa_next_free_sgpr 102
  .amdhsa_accum_offset 256
  .amdhsa_group_segment_fixed_size 0
  .amdhsa_kernarg_size 40
  .amdhsa_user_sgpr_count 2
  .amdhsa_user_sgpr_kernarg_segment_ptr 1
  .amdhsa_system_sgpr_workgroup_id_x 1
.end_amdhsa_kernel
```
